```python
import torch

def _softmax(x, axis=-1):
    return torch.softmax(x, dim=axis)
def _gelu(x):
    return torch.nn.functional.gelu(x, approximate="tanh")
def _silu(x):
    return torch.nn.functional.silu(x)
def _sigmoid(x):
    return torch.sigmoid(x)
def _layernorm(x, axis=-1, eps=1e-5):
    m = x.mean(dim=axis, keepdim=True)
    v = x.var(dim=axis, keepdim=True, unbiased=False)
    return (x - m) / torch.sqrt(v + eps)
def _scatter_add(tgt, idx, src, axis=0):
    return tgt.clone().index_add_(axis, idx, src)
def _segment_sum(src, seg, n):
    out = torch.zeros((n,) + src.shape[1:], dtype=src.dtype)
    return out.index_add_(0, seg, src)
def _pad(x, pw):
    flat = tuple(v for pair in reversed(pw) for v in pair)
    return torch.nn.functional.pad(x, flat)

kernel_name = 'parallel_sum__ssm_conv_s5__glu_gated_bilinear__prompt'

def setup_inputs():

    _w = (lambda a: (lambda t: t.to(torch.bfloat16) if t.is_floating_point() else t)(torch.as_tensor(a)))
    def _A_setup():
        B, S, D = 1, 2048, 576
        P = D
        Lambda_re = -0.5 * (lambda _x: torch.exp(torch.as_tensor(_x)))((lambda *s: torch.randn(*s, dtype=torch.bfloat16) * 0.2)(P))
        Lambda_im = (lambda *s: torch.randn(*s, dtype=torch.bfloat16) * 0.8)(P) * 1.0
        B_re = (lambda *s: torch.randn(*s, dtype=torch.bfloat16) * 0.2)(P, D) * (D ** -0.5)
        B_im = (lambda *s: torch.randn(*s, dtype=torch.bfloat16) * 0.2)(P, D) * (D ** -0.5)
        C_re = (lambda *s: torch.randn(*s, dtype=torch.bfloat16) * 0.2)(D, P) * (P ** -0.5)
        C_im = (lambda *s: torch.randn(*s, dtype=torch.bfloat16) * 0.2)(D, P) * (P ** -0.5)
        log_dt = (lambda *s: torch.randn(*s, dtype=torch.bfloat16) * 0.2)(P) * 0.3 - 2.0
        Dskip = (lambda *s: torch.randn(*s, dtype=torch.bfloat16) * 0.05)(D)
        return {
            "x": _w((lambda *s: torch.randn(*s, dtype=torch.bfloat16) * 0.05)(B, S, D)),
            "Lambda_re": _w(Lambda_re),
            "Lambda_im": _w(Lambda_im),
            "B_re": _w(B_re),
            "B_im": _w(B_im),
            "C_re": _w(C_re),
            "C_im": _w(C_im),
            "log_dt": _w(log_dt),
            "Dskip": _w(Dskip),
        }
    _A_in = _A_setup()

    def _B_setup():
        B, S, D, F = 1, 2048, 576, 4608
        return {
            "x": _w((lambda *s: torch.randn(*s, dtype=torch.bfloat16) * 0.05)(B, S, D)),
            "w_gate": _w((lambda *s: torch.randn(*s, dtype=torch.bfloat16) * 0.4)(D, F) * (D ** -0.5)),
            "w_up": _w((lambda *s: torch.randn(*s, dtype=torch.bfloat16) * 0.4)(D, F) * (D ** -0.5)),
            "w_down": _w((lambda *s: torch.randn(*s, dtype=torch.bfloat16) * 0.4)(F, D) * (F ** -0.5)),
        }
    _B_in = _B_setup()

    return {
        "A_x": _A_in["x"],
        "A_Lambda_re": _A_in["Lambda_re"],
        "A_Lambda_im": _A_in["Lambda_im"],
        "A_B_re": _A_in["B_re"],
        "A_B_im": _A_in["B_im"],
        "A_C_re": _A_in["C_re"],
        "A_C_im": _A_in["C_im"],
        "A_log_dt": _A_in["log_dt"],
        "A_Dskip": _A_in["Dskip"],
        "B_x": _B_in["x"],
        "B_w_gate": _B_in["w_gate"],
        "B_w_up": _B_in["w_up"],
        "B_w_down": _B_in["w_down"],
    }

def reference(A_x, A_Lambda_re, A_Lambda_im, A_B_re, A_B_im, A_C_re, A_C_im, A_log_dt, A_Dskip, B_x, B_w_gate, B_w_up, B_w_down):
    def _A_ref(x, Lambda_re, Lambda_im, B_re, B_im, C_re, C_im, log_dt, Dskip):
        Bsz, L, H = x.shape
        Lam = Lambda_re + 1j * Lambda_im
        Bmat = B_re + 1j * B_im
        Cmat = C_re + 1j * C_im
        dt = torch.exp(log_dt)
        Lam_bar = torch.exp(dt * Lam)
        B_bar = ((Lam_bar - 1.0) / Lam)[:, None] * Bmat
        Bu = torch.einsum("bld,pd->blp", x + 0j, B_bar)
        h = torch.zeros_like(Bu[:, 0, :])
        hs = []
        for t in range(L):
            h = Lam_bar[None, :] * h + Bu[:, t, :]
            hs.append(h)
        hseq = torch.stack(hs, 1)
        y = 2.0 * torch.einsum("blp,dp->bld", hseq, Cmat).real + x * Dskip[None, None, :]
        return y

    def _B_ref(x, w_gate, w_up, w_down):
        g = torch.einsum("bsd,df->bsf", x, w_gate)
        u = torch.einsum("bsd,df->bsf", x, w_up)
        h = g * u
        return torch.einsum("bsf,fd->bsd", h, w_down)

    x = A_x
    xn = _layernorm(x, axis=-1)
    return x + _A_ref(xn, A_Lambda_re, A_Lambda_im, A_B_re, A_B_im, A_C_re, A_C_im, A_log_dt, A_Dskip) + _B_ref(xn, B_w_gate, B_w_up, B_w_down)
```

```asm
; @launch grid=(256,1,1) block=(512,1,1) lds=163840
.amdgcn_target "amdgcn-amd-amdhsa--gfx950"
.text
.globl parallel_sum__ssm_conv_s5__glu_gated_bilinear__prompt_kernel
.p2align 8
.type parallel_sum__ssm_conv_s5__glu_gated_bilinear__prompt_kernel,@function
parallel_sum__ssm_conv_s5__glu_gated_bilinear__prompt_kernel:
    s_cmp_ge_u32 s2, 256
    s_cbranch_scc1 K1_end
    s_load_dwordx2 s[48:49], s[0:1], 0
    s_load_dwordx4 s[20:23], s[0:1], 112
    s_load_dwordx4 s[52:55], s[0:1], 80
    s_load_dwordx4 s[28:31], s[0:1], 24
    s_load_dwordx2 s[58:59], s[0:1], 96
    v_lshrrev_b32 v1, 6, v0
    v_and_b32 v0, 63, v0
    v_readfirstlane_b32 s16, v1
    s_and_b32 s3, s2, 7
    s_lshr_b32 s18, s2, 3
    s_and_b32 s17, s18, 7
    s_lshr_b32 s18, s18, 3
    v_lshlrev_b32 v1, 4, v0
    s_getpc_b64 s[60:61]
CP_pc:
    s_sub_u32 s60, s60, CP_pc-parallel_sum__ssm_conv_s5__glu_gated_bilinear__prompt_kernel
    s_subb_u32 s61, s61, 0
    s_mov_b32 s62, CODE_END-parallel_sum__ssm_conv_s5__glu_gated_bilinear__prompt_kernel
    s_mov_b32 s63, 0x20000
    s_lshr_b32 s40, s2, 3
    s_lshl_b32 s40, s40, 3
    s_add_u32 s40, s40, s16
    s_lshl_b32 s40, s40, 8
    s_mul_i32 s41, s40, 3
    s_lshr_b32 s41, s41, 1
    v_lshlrev_b32 v95, 3, v1
    s_mov_b32 m0, 157696
    s_mov_b64 exec, 7
    buffer_load_dword v95, s[60:63], s41 offen lds
    s_mov_b64 exec, -1
    s_lshl_b32 s40, s3, 2
    s_add_u32 s40, s40, s18
    s_lshr_b32 s41, s40, 1
    s_lshl_b32 s44, s17, 4
    s_add_u32 s44, s44, s41
    s_and_b32 s45, s40, 1
    s_lshl_b32 s47, s45, 3
    s_add_u32 s47, s47, s16
    s_lshr_b32 s50, s44, 1
    s_lshl_b32 s50, s50, 5
    s_and_b32 s51, s44, 1
    s_lshl_b32 s51, s51, 2
    s_add_u32 s50, s50, s51
    s_lshr_b32 s51, s47, 2
    s_lshl_b32 s51, s51, 3
    s_add_u32 s50, s50, s51
    s_and_b32 s51, s47, 3
    s_add_u32 s50, s50, s51
    s_mul_i32 s50, s50, 1152
    v_cmp_gt_u32 vcc, 36, v0
    v_mov_b32 v88, 0x7ffffff0
    s_mul_i32 s100, s44, 18432
    s_lshl_b32 s45, s45, 7
    v_cndmask_b32 v89, v88, v1, vcc
    s_add_u32 s100, s100, s45
    s_lshl_b32 s101, s17, 5
    s_add_u32 s101, s101, s40
    s_waitcnt lgkmcnt(0)
    s_mov_b32 s8, s48
    s_mov_b32 s9, s49
    s_mov_b32 s10, 2359296
    s_mov_b32 s11, 0x20000
    buffer_load_dwordx4 v[48:51], v89, s[8:11], s50 offen
    buffer_load_dwordx4 v[52:55], v89, s[8:11], s50 offen offset:576
    s_lshl_b32 s19, s17, 3
    s_add_u32 s19, s19, s16
    s_mul_i32 s32, s19, 36864
    s_add_u32 s33, s32, 18432
    s_mul_i32 s34, s19, 368640
    s_add_u32 s34, s34, 2359296
    s_lshl_b32 s35, s16, 10
    s_add_u32 s35, s35, 2048
    s_mul_i32 s56, s19, 640
    s_add_u32 s56, s56, 42717184
    v_mov_b32 v94, 0
    s_lshl_b32 s46, s16, 8
    s_mov_b32 s4, s22
    s_mov_b32 s5, s23
    s_mov_b32 s6, 268435456
    s_mov_b32 s7, 0x20000
    s_mov_b32 s24, s20
    s_mov_b32 s25, s21
    s_mov_b32 s26, 256
    s_mov_b32 s27, 0x20000
    s_or_b32 s40, s2, s16
    s_cmp_lg_u32 s40, 0
    s_cbranch_scc1 NONCE_done
    s_memrealtime s[40:41]
    s_waitcnt lgkmcnt(0)
    s_or_b32 s41, s41, 0x80000000
    v_mov_b32 v92, s40
    v_mov_b32 v93, s41
    s_mov_b64 exec, 1
    buffer_store_dwordx2 v[92:93], v1, s[24:27], 0 offen sc1
    s_mov_b64 exec, -1
NONCE_done:
    s_cmp_eq_u32 s18, 3
    s_cbranch_scc1 Z_ssm
    s_mul_i32 s39, s3, 3
    s_add_u32 s39, s39, s18
    s_lshl_b32 s40, s39, 2
    s_add_u32 s56, s56, s40
    s_lshr_b32 s97, s3, 1
    s_mul_i32 s40, s97, 104
    s_add_u32 s56, s56, s40
    s_and_b32 s98, s3, 1
    s_lshl_b32 s98, s98, 3
    s_add_u32 s98, s98, s17
    s_mov_b32 s99, s18
    s_mov_b32 s41, 0x7ff00000
    s_mov_b32 s8, s52
    s_mov_b32 s9, s53
    s_mov_b32 s12, s54
    s_mov_b32 s13, s55
    s_mov_b32 s10, 5308416
    s_mul_i32 s36, s19, 9216
    s_mul_i32 s37, s39, 384
    s_add_u32 s36, s36, s37
    v_mul_u32_u24 v19, 589824, v0
    s_mov_b32 s37, 31
    s_branch Z_go
Z_ssm:
    s_lshl_b32 s40, s3, 2
    s_add_u32 s56, s56, s40
    s_add_u32 s56, s56, 512
    s_cmp_ge_u32 s17, 3
    s_cselect_b32 s40, 1, 0
    s_lshl_b32 s98, s3, 1
    s_add_u32 s98, s98, s40
    s_mul_i32 s40, s40, 3
    s_sub_u32 s99, s17, s40
    s_mov_b32 s97, 4
    s_mul_i32 s57, s3, 5
    s_add_u32 s41, s57, s16
    s_lshl_b32 s41, s41, 11
    s_lshl_b32 s47, s17, 8
    s_add_u32 s41, s41, s47
    s_add_u32 s41, s41, 30707712
    s_cmp_lt_u32 s16, 5
    s_cselect_b32 s41, s41, 0x7ff00000
    s_mov_b32 s8, s28
    s_mov_b32 s9, s29
    s_mov_b32 s12, s30
    s_mov_b32 s13, s31
    s_mov_b32 s10, 663552
    s_lshl_b32 s36, s57, 4
    s_add_u32 s36, s36, s19
    s_mul_i32 s36, s36, 1152
    v_lshrrev_b32 v19, 4, v0
    v_mul_u32_u24 v19, 73728, v19
    v_and_b32 v20, 15, v0
    v_lshl_add_u32 v19, v20, 7, v19
    s_mov_b32 s37, 31
    s_cmp_lt_u32 s19, 32
    s_cselect_b32 s37, 2031647, s37
Z_go:
    s_mov_b32 s14, s10
    s_mov_b32 s11, 0x20000
    s_mov_b32 s15, 0x20000
    s_mov_b32 m0, 157696
    s_mov_b32 exec_lo, s37
    s_mov_b32 exec_hi, 0
    buffer_load_dword v19, s[8:11], s36 offen lds
    buffer_load_dword v19, s[12:15], s36 offen lds
    s_mov_b64 exec, -1
    s_mul_i32 s40, s98, 3
    s_add_u32 s40, s40, s99
    s_lshl_b32 s40, s40, 10
    s_lshl_b32 s47, s97, 2
    s_add_u32 s40, s40, s47
    s_add_u32 s40, s40, 42651648
    s_cmp_lt_u32 s99, 3
    s_cselect_b32 s40, s40, 0x7ff00000
    s_cmp_eq_u32 s16, 0
    s_cselect_b32 s40, s40, 0x7ff00000
    v_lshrrev_b32 v18, 2, v1
    buffer_store_dword v94, v18, s[4:7], s41 offen sc1
    s_mov_b64 exec, 1
    buffer_store_dword v94, v1, s[4:7], s56 offen sc1
    buffer_store_dword v94, v1, s[4:7], s40 offen sc1
    s_mov_b64 exec, -1
    v_mov_b32 v90, 0xffff0000
    v_cmp_gt_u32 vcc, 36, v0
    v_and_b32 v106, 7, v0
    v_xor_b32 v104, s16, v106
    v_lshlrev_b32 v104, 4, v104
    v_lshl_add_u32 v104, v0, 7, v104
    v_add_u32 v104, 133120, v104
    v_xor_b32 v105, 64, v104
    v_lshrrev_b32 v93, 3, v0
    v_xor_b32 v92, v93, v106
    v_lshlrev_b32 v92, 4, v92
    v_lshl_add_u32 v92, v93, 7, v92
    s_lshl_b32 s40, s16, 10
    s_add_u32 s40, s40, 133120
    v_add_u32 v91, s40, v92
    v_add_u32 v92, 141312, v92
    v_lshlrev_b32 v93, 8, v93
    v_lshl_add_u32 v93, v106, 4, v93
    v_mov_b32 v97, 0
    s_lshr_b32 s45, s16, 1
    s_lshl_b32 s45, s45, 8
    s_waitcnt vmcnt(5)
    v_lshlrev_b32 v56, 16, v48
    v_and_b32 v57, v90, v48
    v_lshlrev_b32 v58, 16, v49
    v_and_b32 v59, v90, v49
    v_lshlrev_b32 v60, 16, v50
    v_and_b32 v61, v90, v50
    v_lshlrev_b32 v62, 16, v51
    v_and_b32 v63, v90, v51
    v_lshlrev_b32 v64, 16, v52
    v_and_b32 v65, v90, v52
    v_lshlrev_b32 v66, 16, v53
    v_and_b32 v67, v90, v53
    v_lshlrev_b32 v68, 16, v54
    v_and_b32 v69, v90, v54
    v_lshlrev_b32 v70, 16, v55
    v_and_b32 v71, v90, v55
    v_add_f32 v72, v56, v60
    v_add_f32 v73, v57, v61
    v_add_f32 v74, v58, v62
    v_add_f32 v75, v59, v63
    v_add_f32 v72, v72, v64
    v_add_f32 v73, v73, v65
    v_add_f32 v74, v74, v66
    v_add_f32 v75, v75, v67
    v_add_f32 v72, v72, v68
    v_add_f32 v73, v73, v69
    v_add_f32 v74, v74, v70
    v_add_f32 v75, v75, v71
    v_add_f32 v72, v72, v73
    v_add_f32 v74, v74, v75
    v_add_f32 v72, v72, v74
    s_nop 1
    v_add_f32_dpp v73, v72, v72 quad_perm:[1,0,3,2] row_mask:0xf bank_mask:0xf
    s_nop 1
    v_add_f32_dpp v72, v73, v73 quad_perm:[2,3,0,1] row_mask:0xf bank_mask:0xf
    s_nop 1
    v_add_f32_dpp v73, v72, v72 row_half_mirror row_mask:0xf bank_mask:0xf
    s_nop 1
    v_add_f32_dpp v72, v73, v73 row_mirror row_mask:0xf bank_mask:0xf
    s_nop 0
    v_mov_b32 v73, v72
    s_nop 1
    v_permlane16_swap_b32 v72, v73
    s_nop 1
    v_add_f32 v72, v72, v73
    s_nop 0
    v_mov_b32 v73, v72
    s_nop 1
    v_permlane32_swap_b32 v72, v73
    s_nop 1
    v_add_f32 v72, v72, v73
    v_mul_f32 v72, 0x3ae38e39, v72
    v_sub_f32 v80, v56, v72
    v_mul_f32 v76, v80, v80
    v_sub_f32 v81, v57, v72
    v_mul_f32 v77, v81, v81
    v_sub_f32 v82, v58, v72
    v_mul_f32 v78, v82, v82
    v_sub_f32 v83, v59, v72
    v_mul_f32 v79, v83, v83
    v_sub_f32 v80, v60, v72
    v_fmac_f32 v76, v80, v80
    v_sub_f32 v81, v61, v72
    v_fmac_f32 v77, v81, v81
    v_sub_f32 v82, v62, v72
    v_fmac_f32 v78, v82, v82
    v_sub_f32 v83, v63, v72
    v_fmac_f32 v79, v83, v83
    v_sub_f32 v80, v64, v72
    v_fmac_f32 v76, v80, v80
    v_sub_f32 v81, v65, v72
    v_fmac_f32 v77, v81, v81
    v_sub_f32 v82, v66, v72
    v_fmac_f32 v78, v82, v82
    v_sub_f32 v83, v67, v72
    v_fmac_f32 v79, v83, v83
    v_sub_f32 v80, v68, v72
    v_fmac_f32 v76, v80, v80
    v_sub_f32 v81, v69, v72
    v_fmac_f32 v77, v81, v81
    v_sub_f32 v82, v70, v72
    v_fmac_f32 v78, v82, v82
    v_sub_f32 v83, v71, v72
    v_fmac_f32 v79, v83, v83
    v_add_f32 v76, v76, v77
    v_add_f32 v78, v78, v79
    v_add_f32 v76, v76, v78
    v_cndmask_b32 v76, 0, v76, vcc
    s_nop 1
    v_add_f32_dpp v77, v76, v76 quad_perm:[1,0,3,2] row_mask:0xf bank_mask:0xf
    s_nop 1
    v_add_f32_dpp v76, v77, v77 quad_perm:[2,3,0,1] row_mask:0xf bank_mask:0xf
    s_nop 1
    v_add_f32_dpp v77, v76, v76 row_half_mirror row_mask:0xf bank_mask:0xf
    s_nop 1
    v_add_f32_dpp v76, v77, v77 row_mirror row_mask:0xf bank_mask:0xf
    s_nop 0
    v_mov_b32 v77, v76
    s_nop 1
    v_permlane16_swap_b32 v76, v77
    s_nop 1
    v_add_f32 v76, v76, v77
    s_nop 0
    v_mov_b32 v77, v76
    s_nop 1
    v_permlane32_swap_b32 v76, v77
    s_nop 1
    v_add_f32 v76, v76, v77
    v_mul_f32 v76, 0x3ae38e39, v76
    v_cvt_pk_bf16_f32 v74, v72, v76
    v_lshlrev_b32 v72, 16, v74
    v_and_b32 v76, v90, v74
    v_add_f32 v76, 0x3727c5ac, v76
    v_cvt_pk_bf16_f32 v76, v76, v76
    v_and_b32 v76, v90, v76
    v_sqrt_f32 v76, v76
    s_lshl_b32 s40, s16, 4
    v_cvt_pk_bf16_f32 v76, v76, v76
    v_and_b32 v76, v90, v76
    v_rcp_f32 v76, v76
    v_sub_f32 v56, v56, v72
    v_sub_f32 v57, v57, v72
    v_sub_f32 v58, v58, v72
    v_sub_f32 v59, v59, v72
    v_sub_f32 v60, v60, v72
    v_sub_f32 v61, v61, v72
    v_sub_f32 v62, v62, v72
    v_sub_f32 v63, v63, v72
    v_sub_f32 v64, v64, v72
    v_sub_f32 v65, v65, v72
    v_sub_f32 v66, v66, v72
    v_sub_f32 v67, v67, v72
    v_sub_f32 v68, v68, v72
    v_sub_f32 v69, v69, v72
    v_sub_f32 v70, v70, v72
    v_sub_f32 v71, v71, v72
    buffer_load_dwordx2 v[98:99], v97, s[24:27], s45 offen sc1
    v_cvt_pk_bf16_f32 v80, v56, v57
    v_cvt_pk_bf16_f32 v81, v58, v59
    v_cvt_pk_bf16_f32 v82, v60, v61
    v_cvt_pk_bf16_f32 v83, v62, v63
    v_cvt_pk_bf16_f32 v84, v64, v65
    v_cvt_pk_bf16_f32 v85, v66, v67
    v_cvt_pk_bf16_f32 v86, v68, v69
    v_cvt_pk_bf16_f32 v87, v70, v71
    v_lshlrev_b32 v56, 16, v80
    v_and_b32 v57, v90, v80
    v_lshlrev_b32 v58, 16, v81
    v_and_b32 v59, v90, v81
    v_lshlrev_b32 v60, 16, v82
    v_and_b32 v61, v90, v82
    v_lshlrev_b32 v62, 16, v83
    v_and_b32 v63, v90, v83
    v_lshlrev_b32 v64, 16, v84
    v_and_b32 v65, v90, v84
    v_lshlrev_b32 v66, 16, v85
    v_and_b32 v67, v90, v85
    v_lshlrev_b32 v68, 16, v86
    v_and_b32 v69, v90, v86
    v_lshlrev_b32 v70, 16, v87
    v_and_b32 v71, v90, v87
    v_mul_f32 v56, v56, v76
    v_mul_f32 v57, v57, v76
    v_mul_f32 v58, v58, v76
    v_mul_f32 v59, v59, v76
    v_mul_f32 v60, v60, v76
    v_mul_f32 v61, v61, v76
    v_mul_f32 v62, v62, v76
    v_mul_f32 v63, v63, v76
    v_mul_f32 v64, v64, v76
    v_mul_f32 v65, v65, v76
    v_mul_f32 v66, v66, v76
    v_mul_f32 v67, v67, v76
    v_mul_f32 v68, v68, v76
    v_mul_f32 v69, v69, v76
    v_mul_f32 v70, v70, v76
    v_mul_f32 v71, v71, v76
    v_cvt_pk_bf16_f32 v80, v56, v57
    v_cvt_pk_bf16_f32 v81, v58, v59
    v_cvt_pk_bf16_f32 v82, v60, v61
    v_cvt_pk_bf16_f32 v83, v62, v63
    v_cvt_pk_bf16_f32 v84, v64, v65
    v_cvt_pk_bf16_f32 v85, v66, v67
    v_cvt_pk_bf16_f32 v86, v68, v69
    v_cvt_pk_bf16_f32 v87, v70, v71
    s_mov_b32 exec_hi, 15
    ds_write_b128 v104, v[80:83]
    ds_write_b128 v105, v[84:87] offset:4608
    s_mov_b64 exec, -1
    s_lshl_b32 s40, s16, 11
    s_add_u32 s40, s40, s100
    s_add_u32 s41, s100, 16384
    s_cmp_eq_u32 s16, 0
    s_cselect_b32 s41, s41, 0x7ff00000
    s_waitcnt lgkmcnt(0)
    s_barrier
    ds_read_b128 v[48:51], v91
    ds_read_b128 v[52:55], v92
    s_waitcnt lgkmcnt(1)
    buffer_store_dwordx4 v[48:51], v93, s[4:7], s40 offen sc1
    s_waitcnt lgkmcnt(0)
    buffer_store_dwordx4 v[52:55], v93, s[4:7], s41 offen sc1
    s_cmp_eq_u32 s18, 3
    s_cbranch_scc1 K1_ssm
    s_mov_b32 s8, s52
    s_mov_b32 s9, s53
    s_mov_b32 s10, 5308416
    s_mov_b32 s11, 0x20000
    s_mov_b32 s12, s54
    s_mov_b32 s13, s55
    s_mov_b32 s14, 5308416
    s_mov_b32 s15, 0x20000
    s_mul_i32 s39, s39, 3
    s_lshl_b32 s38, s39, 7
    s_lshl_b32 s39, s39, 11
    s_add_u32 s39, s39, s34
    v_lshrrev_b32 v16, 3, v0
    s_lshl_b32 s40, s16, 3
    v_add_u32 v16, s40, v16
    v_mul_u32_u24 v16, 9216, v16
    v_bfe_u32 v17, v0, 4, 1
    s_and_b32 s40, s16, 1
    s_lshl_b32 s40, s40, 1
    v_or_b32 v17, s40, v17
    v_lshlrev_b32 v17, 1, v17
    v_and_b32 v18, 7, v0
    v_xor_b32 v17, v17, v18
    v_lshl_add_u32 v6, v17, 4, v16
    v_lshrrev_b32 v15, 4, v0
    v_lshlrev_b32 v15, 10, v15
    v_bfe_u32 v17, v0, 2, 2
    v_lshl_add_u32 v15, v17, 7, v15
    v_bfe_u32 v17, v0, 3, 2
    v_lshl_add_u32 v15, v17, 5, v15
    v_and_b32 v17, 3, v0
    v_lshl_add_u32 v15, v17, 3, v15
    v_add_u32 v15, 2048, v15
    v_lshlrev_b32 v14, 7, v0
    v_xor_b32 v2, 0, v15
    v_xor_b32 v3, 32, v15
    v_xor_b32 v4, 64, v15
    v_xor_b32 v5, 96, v15
    s_lshl_b32 s46, s16, 8
    v_mov_b32 v7, 0
    s_mov_b32 m0, s46
    v_and_b32 v9, 7, v0
    v_mul_u32_u24 v9, 260, v9
    ds_write_addtid_b32 v7
    s_lshl_b32 s41, s101, 7
    s_add_u32 s41, s41, 42618880
    v_and_b32 v100, 31, v0
    v_lshlrev_b32 v100, 7, v100
    s_lshl_b32 s40, s17, 12
    s_add_u32 s40, s40, 42618880
    s_waitcnt vmcnt(0)
    s_cmp_ge_u32 s16, 2
    s_cbranch_scc1 LNnn_5
    s_mov_b32 s47, 0
NCl_7:
    v_cmp_eq_u32 vcc, 0, v99
    s_cbranch_vccz NCs_6
    buffer_load_dwordx2 v[98:99], v97, s[24:27], 0 offen sc1
    s_waitcnt vmcnt(0)
    s_add_u32 s47, s47, 1
    s_cmp_lt_u32 s47, 0x40000
    s_cbranch_scc1 NCl_7
NCs_6:
LNnn_5:
    s_barrier
    s_cmp_lg_u32 s16, 0
    s_cbranch_scc1 LNw1_4
    v_lshrrev_b32 v100, 1, v1
    s_mov_b64 exec, 0xffff
    buffer_store_dwordx2 v[98:99], v100, s[4:7], s41 offen sc1
    s_mov_b64 exec, -1
LNw1_4:
    s_add_u32 m0, s35, 0
    s_add_u32 s41, s38, 0
    buffer_load_dwordx4 v6, s[8:11], s41 offen lds
    s_add_u32 m0, s35, 8192
    s_add_u32 s41, s38, 0
    buffer_load_dwordx4 v6, s[12:15], s41 offen lds
    s_add_u32 m0, s35, 16384
    s_add_u32 s41, s38, 589824
    buffer_load_dwordx4 v6, s[8:11], s41 offen lds
    s_add_u32 m0, s35, 24576
    s_add_u32 s41, s38, 589824
    buffer_load_dwordx4 v6, s[12:15], s41 offen lds
    s_cmp_lg_u32 s16, 1
    s_cbranch_scc1 LNgo_1
    s_mov_b32 s47, 0
    s_sleep 8
    buffer_load_dwordx2 v[102:103], v100, s[4:7], s40 offen sc1
    s_sleep 4
    buffer_load_dwordx2 v[104:105], v100, s[4:7], s40 offen sc1
    s_sleep 4
    buffer_load_dwordx2 v[106:107], v100, s[4:7], s40 offen sc1
    s_sleep 4
LNp_2:
    buffer_load_dwordx2 v[108:109], v100, s[4:7], s40 offen sc1
    s_waitcnt vmcnt(3)
    v_cmp_ne_u64 vcc, v[98:99], v[102:103]
    s_cbranch_vccz LNok_3
    buffer_load_dwordx2 v[102:103], v100, s[4:7], s40 offen sc1
    s_waitcnt vmcnt(3)
    v_cmp_ne_u64 vcc, v[98:99], v[104:105]
    s_cbranch_vccz LNok_3
    buffer_load_dwordx2 v[104:105], v100, s[4:7], s40 offen sc1
    s_waitcnt vmcnt(3)
    v_cmp_ne_u64 vcc, v[98:99], v[106:107]
    s_cbranch_vccz LNok_3
    buffer_load_dwordx2 v[106:107], v100, s[4:7], s40 offen sc1
    s_waitcnt vmcnt(3)
    v_cmp_ne_u64 vcc, v[98:99], v[108:109]
    s_cbranch_vccz LNok_3
    s_add_u32 s47, s47, 1
    s_cmp_lt_u32 s47, 0x20000
    s_cbranch_scc1 LNp_2
LNok_3:
    s_and_b32 s40, s101, 31
    s_cmp_lg_u32 s40, 0
    s_cbranch_scc1 LNgo_1
    s_lshl_b32 s40, s17, 2
    v_mov_b32 v100, 1
    s_mov_b64 exec, 1
    buffer_store_dword v100, v1, s[24:27], s40 offen offset:128 sc1
    s_mov_b64 exec, -1
LNgo_1:
    s_waitcnt vmcnt(2)
    s_waitcnt lgkmcnt(0)
    s_barrier
    s_add_u32 s36, s32, 0
    buffer_load_dwordx4 v[112:115], v1, s[4:7], s36 offen offset:0 sc1
    buffer_load_dwordx4 v[120:123], v1, s[4:7], s36 offen offset:1024 sc1
    s_add_u32 s37, s33, 0
    buffer_load_dwordx4 v[116:119], v1, s[4:7], s37 offen offset:0 sc1
    buffer_load_dwordx4 v[124:127], v1, s[4:7], s37 offen offset:1024 sc1
    s_add_u32 s36, s32, 2048
    buffer_load_dwordx4 v[128:131], v1, s[4:7], s36 offen offset:0 sc1
    buffer_load_dwordx4 v[136:139], v1, s[4:7], s36 offen offset:1024 sc1
    s_add_u32 s37, s33, 2048
    buffer_load_dwordx4 v[132:135], v1, s[4:7], s37 offen offset:0 sc1
    buffer_load_dwordx4 v[140:143], v1, s[4:7], s37 offen offset:1024 sc1
    ds_read_b64_tr_b16 v[16:17], v2 offset:0
    ds_read_b64_tr_b16 v[18:19], v2 offset:512
    ds_read_b64_tr_b16 v[20:21], v2 offset:4096
    ds_read_b64_tr_b16 v[22:23], v2 offset:4608
    ds_read_b64_tr_b16 v[24:25], v2 offset:8192
    ds_read_b64_tr_b16 v[26:27], v2 offset:8704
    ds_read_b64_tr_b16 v[28:29], v2 offset:12288
    ds_read_b64_tr_b16 v[30:31], v2 offset:12800
    ds_read_b64_tr_b16 v[32:33], v3 offset:0
    ds_read_b64_tr_b16 v[34:35], v3 offset:512
    ds_read_b64_tr_b16 v[36:37], v3 offset:4096
    ds_read_b64_tr_b16 v[38:39], v3 offset:4608
    s_waitcnt vmcnt(4)
    s_waitcnt lgkmcnt(8)
    v_mfma_f32_16x16x32_bf16 v[48:51], v[16:19], v[112:115], 0
    ds_read_b64_tr_b16 v[40:41], v3 offset:8192
    v_mfma_f32_16x16x32_bf16 v[48:51], v[20:23], v[120:123], v[48:51]
    ds_read_b64_tr_b16 v[42:43], v3 offset:8704
    s_add_u32 s36, s32, 4096
    buffer_load_dwordx4 v[144:147], v1, s[4:7], s36 offen offset:0 sc1
    v_mfma_f32_16x16x32_bf16 v[52:55], v[16:19], v[116:119], 0
    ds_read_b64_tr_b16 v[44:45], v3 offset:12288
    v_mfma_f32_16x16x32_bf16 v[52:55], v[20:23], v[124:127], v[52:55]
    ds_read_b64_tr_b16 v[46:47], v3 offset:12800
    buffer_load_dwordx4 v[152:155], v1, s[4:7], s36 offen offset:1024 sc1
    s_mov_b32 m0, s46
    v_add_u32 v7, 1, v7
    ds_write_addtid_b32 v7
    s_setprio 0
    s_waitcnt lgkmcnt(9)
    v_mfma_f32_16x16x32_bf16 v[56:59], v[24:27], v[112:115], 0
    ds_read_b64_tr_b16 v[16:17], v4 offset:0
    v_mfma_f32_16x16x32_bf16 v[56:59], v[28:31], v[120:123], v[56:59]
    ds_read_b64_tr_b16 v[18:19], v4 offset:512
    s_add_u32 s37, s33, 4096
    buffer_load_dwordx4 v[148:151], v1, s[4:7], s37 offen offset:0 sc1
    v_mfma_f32_16x16x32_bf16 v[60:63], v[24:27], v[116:119], 0
    ds_read_b64_tr_b16 v[20:21], v4 offset:4096
    v_mfma_f32_16x16x32_bf16 v[60:63], v[28:31], v[124:127], v[60:63]
    ds_read_b64_tr_b16 v[22:23], v4 offset:4608
    buffer_load_dwordx4 v[156:159], v1, s[4:7], s37 offen offset:1024 sc1
    s_waitcnt lgkmcnt(9)
    v_mfma_f32_16x16x32_bf16 v[64:67], v[32:35], v[112:115], 0
    ds_read_b64_tr_b16 v[24:25], v4 offset:8192
    v_mfma_f32_16x16x32_bf16 v[64:67], v[36:39], v[120:123], v[64:67]
    ds_read_b64_tr_b16 v[26:27], v4 offset:8704
    v_mfma_f32_16x16x32_bf16 v[68:71], v[32:35], v[116:119], 0
    ds_read_b64_tr_b16 v[28:29], v4 offset:12288
    v_mfma_f32_16x16x32_bf16 v[68:71], v[36:39], v[124:127], v[68:71]
    ds_read_b64_tr_b16 v[30:31], v4 offset:12800
    ds_read_b32 v8, v9
    s_waitcnt lgkmcnt(10)
    v_mfma_f32_16x16x32_bf16 v[72:75], v[40:43], v[112:115], 0
    ds_read_b64_tr_b16 v[32:33], v5 offset:0
    v_mfma_f32_16x16x32_bf16 v[72:75], v[44:47], v[120:123], v[72:75]
    ds_read_b64_tr_b16 v[34:35], v5 offset:512
    s_add_u32 m0, s35, 32768
    s_add_u32 s41, s38, 1179648
    buffer_load_dwordx4 v6, s[8:11], s41 offen lds
    v_mfma_f32_16x16x32_bf16 v[76:79], v[40:43], v[116:119], 0
    ds_read_b64_tr_b16 v[36:37], v5 offset:4096
    v_mfma_f32_16x16x32_bf16 v[76:79], v[44:47], v[124:127], v[76:79]
    ds_read_b64_tr_b16 v[38:39], v5 offset:4608
    s_add_u32 m0, s35, 40960
    s_add_u32 s41, s38, 1179648
    buffer_load_dwordx4 v6, s[12:15], s41 offen lds
    s_waitcnt lgkmcnt(9)
    v_mfma_f32_16x16x32_bf16 v[80:83], v[16:19], v[112:115], 0
    ds_read_b64_tr_b16 v[40:41], v5 offset:8192
    v_mfma_f32_16x16x32_bf16 v[80:83], v[20:23], v[120:123], v[80:83]
    ds_read_b64_tr_b16 v[42:43], v5 offset:8704
    v_mfma_f32_16x16x32_bf16 v[84:87], v[16:19], v[116:119], 0
    ds_read_b64_tr_b16 v[44:45], v5 offset:12288
    v_mfma_f32_16x16x32_bf16 v[84:87], v[20:23], v[124:127], v[84:87]
    ds_read_b64_tr_b16 v[46:47], v5 offset:12800
    s_waitcnt lgkmcnt(8)
    v_cmp_gt_i32 vcc, v7, v8
    s_cbranch_vccnz SBs_8
SBb_9:
    s_setprio 1
    v_mfma_f32_16x16x32_bf16 v[88:91], v[24:27], v[112:115], 0
    ds_read_b64_tr_b16 v[16:17], v2 offset:16384
    v_mfma_f32_16x16x32_bf16 v[88:91], v[28:31], v[120:123], v[88:91]
    ds_read_b64_tr_b16 v[18:19], v2 offset:16896
    v_mfma_f32_16x16x32_bf16 v[92:95], v[24:27], v[116:119], 0
    ds_read_b64_tr_b16 v[20:21], v2 offset:20480
    v_mfma_f32_16x16x32_bf16 v[92:95], v[28:31], v[124:127], v[92:95]
    ds_read_b64_tr_b16 v[22:23], v2 offset:20992
    s_waitcnt lgkmcnt(8)
    v_mfma_f32_16x16x32_bf16 v[96:99], v[32:35], v[112:115], 0
    ds_read_b64_tr_b16 v[24:25], v2 offset:24576
    v_mfma_f32_16x16x32_bf16 v[96:99], v[36:39], v[120:123], v[96:99]
    ds_read_b64_tr_b16 v[26:27], v2 offset:25088
    s_add_u32 m0, s35, 49152
    s_add_u32 s41, s38, 1769472
    buffer_load_dwordx4 v6, s[8:11], s41 offen lds
    v_mfma_f32_16x16x32_bf16 v[100:103], v[32:35], v[116:119], 0
    ds_read_b64_tr_b16 v[28:29], v2 offset:28672
    v_mfma_f32_16x16x32_bf16 v[100:103], v[36:39], v[124:127], v[100:103]
    ds_read_b64_tr_b16 v[30:31], v2 offset:29184
    s_add_u32 m0, s35, 57344
    s_add_u32 s41, s38, 1769472
    buffer_load_dwordx4 v6, s[12:15], s41 offen lds
    s_waitcnt lgkmcnt(8)
    v_mfma_f32_16x16x32_bf16 v[104:107], v[40:43], v[112:115], 0
    ds_read_b64_tr_b16 v[32:33], v3 offset:16384
    v_mfma_f32_16x16x32_bf16 v[104:107], v[44:47], v[120:123], v[104:107]
    ds_read_b64_tr_b16 v[34:35], v3 offset:16896
    v_mfma_f32_16x16x32_bf16 v[108:111], v[40:43], v[116:119], 0
    ds_read_b64_tr_b16 v[36:37], v3 offset:20480
    v_mfma_f32_16x16x32_bf16 v[108:111], v[44:47], v[124:127], v[108:111]
    ds_read_b64_tr_b16 v[38:39], v3 offset:20992
    s_waitcnt vmcnt(8)
    s_waitcnt lgkmcnt(8)
    v_mfma_f32_16x16x32_bf16 v[48:51], v[16:19], v[128:131], v[48:51]
    ds_read_b64_tr_b16 v[40:41], v3 offset:24576
    v_mfma_f32_16x16x32_bf16 v[48:51], v[20:23], v[136:139], v[48:51]
    ds_read_b64_tr_b16 v[42:43], v3 offset:25088
    s_add_u32 s36, s32, 6144
    buffer_load_dwordx4 v[160:163], v1, s[4:7], s36 offen offset:0 sc1
    v_mfma_f32_16x16x32_bf16 v[52:55], v[16:19], v[132:135], v[52:55]
    ds_read_b64_tr_b16 v[44:45], v3 offset:28672
    v_mfma_f32_16x16x32_bf16 v[52:55], v[20:23], v[140:143], v[52:55]
    ds_read_b64_tr_b16 v[46:47], v3 offset:29184
    buffer_load_dwordx4 v[168:171], v1, s[4:7], s36 offen offset:1024 sc1
    s_waitcnt vmcnt(4)
    s_mov_b32 m0, s46
    v_add_u32 v7, 1, v7
    ds_write_addtid_b32 v7
    s_setprio 0
    s_waitcnt lgkmcnt(9)
    v_mfma_f32_16x16x32_bf16 v[56:59], v[24:27], v[128:131], v[56:59]
    ds_read_b64_tr_b16 v[16:17], v4 offset:16384
    v_mfma_f32_16x16x32_bf16 v[56:59], v[28:31], v[136:139], v[56:59]
    ds_read_b64_tr_b16 v[18:19], v4 offset:16896
    s_add_u32 s37, s33, 6144
    buffer_load_dwordx4 v[164:167], v1, s[4:7], s37 offen offset:0 sc1
    v_mfma_f32_16x16x32_bf16 v[60:63], v[24:27], v[132:135], v[60:63]
    ds_read_b64_tr_b16 v[20:21], v4 offset:20480
    v_mfma_f32_16x16x32_bf16 v[60:63], v[28:31], v[140:143], v[60:63]
    ds_read_b64_tr_b16 v[22:23], v4 offset:20992
    buffer_load_dwordx4 v[172:175], v1, s[4:7], s37 offen offset:1024 sc1
    s_waitcnt lgkmcnt(9)
    v_mfma_f32_16x16x32_bf16 v[64:67], v[32:35], v[128:131], v[64:67]
    ds_read_b64_tr_b16 v[24:25], v4 offset:24576
    v_mfma_f32_16x16x32_bf16 v[64:67], v[36:39], v[136:139], v[64:67]
    ds_read_b64_tr_b16 v[26:27], v4 offset:25088
    v_mfma_f32_16x16x32_bf16 v[68:71], v[32:35], v[132:135], v[68:71]
    ds_read_b64_tr_b16 v[28:29], v4 offset:28672
    v_mfma_f32_16x16x32_bf16 v[68:71], v[36:39], v[140:143], v[68:71]
    ds_read_b64_tr_b16 v[30:31], v4 offset:29184
    ds_read_b32 v8, v9
    s_waitcnt lgkmcnt(10)
    v_mfma_f32_16x16x32_bf16 v[72:75], v[40:43], v[128:131], v[72:75]
    ds_read_b64_tr_b16 v[32:33], v5 offset:16384
    v_mfma_f32_16x16x32_bf16 v[72:75], v[44:47], v[136:139], v[72:75]
    ds_read_b64_tr_b16 v[34:35], v5 offset:16896
    s_add_u32 m0, s35, 65536
    s_add_u32 s41, s38, 2359296
    buffer_load_dwordx4 v6, s[8:11], s41 offen lds
    v_mfma_f32_16x16x32_bf16 v[76:79], v[40:43], v[132:135], v[76:79]
    ds_read_b64_tr_b16 v[36:37], v5 offset:20480
    v_mfma_f32_16x16x32_bf16 v[76:79], v[44:47], v[140:143], v[76:79]
    ds_read_b64_tr_b16 v[38:39], v5 offset:20992
    s_add_u32 m0, s35, 73728
    s_add_u32 s41, s38, 2359296
    buffer_load_dwordx4 v6, s[12:15], s41 offen lds
    s_waitcnt lgkmcnt(9)
    v_mfma_f32_16x16x32_bf16 v[80:83], v[16:19], v[128:131], v[80:83]
    ds_read_b64_tr_b16 v[40:41], v5 offset:24576
    v_mfma_f32_16x16x32_bf16 v[80:83], v[20:23], v[136:139], v[80:83]
    ds_read_b64_tr_b16 v[42:43], v5 offset:25088
    v_mfma_f32_16x16x32_bf16 v[84:87], v[16:19], v[132:135], v[84:87]
    ds_read_b64_tr_b16 v[44:45], v5 offset:28672
    v_mfma_f32_16x16x32_bf16 v[84:87], v[20:23], v[140:143], v[84:87]
    ds_read_b64_tr_b16 v[46:47], v5 offset:29184
    s_waitcnt lgkmcnt(8)
    v_cmp_gt_i32 vcc, v7, v8
    s_cbranch_vccnz SBs_10
SBb_11:
    s_setprio 1
    v_mfma_f32_16x16x32_bf16 v[88:91], v[24:27], v[128:131], v[88:91]
    ds_read_b64_tr_b16 v[16:17], v2 offset:32768
    v_mfma_f32_16x16x32_bf16 v[88:91], v[28:31], v[136:139], v[88:91]
    ds_read_b64_tr_b16 v[18:19], v2 offset:33280
    v_mfma_f32_16x16x32_bf16 v[92:95], v[24:27], v[132:135], v[92:95]
    ds_read_b64_tr_b16 v[20:21], v2 offset:36864
    v_mfma_f32_16x16x32_bf16 v[92:95], v[28:31], v[140:143], v[92:95]
    ds_read_b64_tr_b16 v[22:23], v2 offset:37376
    s_waitcnt lgkmcnt(8)
    v_mfma_f32_16x16x32_bf16 v[96:99], v[32:35], v[128:131], v[96:99]
    ds_read_b64_tr_b16 v[24:25], v2 offset:40960
    v_mfma_f32_16x16x32_bf16 v[96:99], v[36:39], v[136:139], v[96:99]
    ds_read_b64_tr_b16 v[26:27], v2 offset:41472
    v_mfma_f32_16x16x32_bf16 v[100:103], v[32:35], v[132:135], v[100:103]
    ds_read_b64_tr_b16 v[28:29], v2 offset:45056
    v_mfma_f32_16x16x32_bf16 v[100:103], v[36:39], v[140:143], v[100:103]
    ds_read_b64_tr_b16 v[30:31], v2 offset:45568
    v_add_u32 v2, 49152, v2
    s_waitcnt lgkmcnt(8)
    v_mfma_f32_16x16x32_bf16 v[104:107], v[40:43], v[128:131], v[104:107]
    ds_read_b64_tr_b16 v[32:33], v3 offset:32768
    v_mfma_f32_16x16x32_bf16 v[104:107], v[44:47], v[136:139], v[104:107]
    ds_read_b64_tr_b16 v[34:35], v3 offset:33280
    v_mfma_f32_16x16x32_bf16 v[108:111], v[40:43], v[132:135], v[108:111]
    ds_read_b64_tr_b16 v[36:37], v3 offset:36864
    v_mfma_f32_16x16x32_bf16 v[108:111], v[44:47], v[140:143], v[108:111]
    ds_read_b64_tr_b16 v[38:39], v3 offset:37376
    s_waitcnt lgkmcnt(8)
    v_mfma_f32_16x16x32_bf16 v[48:51], v[16:19], v[144:147], v[48:51]
    ds_read_b64_tr_b16 v[40:41], v3 offset:40960
    s_add_u32 s36, s32, 8192
    buffer_load_dwordx4 v[176:179], v1, s[4:7], s36 offen offset:0 sc1
    v_mfma_f32_16x16x32_bf16 v[48:51], v[20:23], v[152:155], v[48:51]
    ds_read_b64_tr_b16 v[42:43], v3 offset:41472
    buffer_load_dwordx4 v[184:187], v1, s[4:7], s36 offen offset:1024 sc1
    v_mfma_f32_16x16x32_bf16 v[52:55], v[16:19], v[148:151], v[52:55]
    ds_read_b64_tr_b16 v[44:45], v3 offset:45056
    s_and_b32 s23, s16, 3
    v_mfma_f32_16x16x32_bf16 v[52:55], v[20:23], v[156:159], v[52:55]
    ds_read_b64_tr_b16 v[46:47], v3 offset:45568
    v_add_u32 v3, 49152, v3
    s_lshr_b32 s42, s16, 2
    s_waitcnt vmcnt(8)
    s_mov_b32 m0, s46
    v_add_u32 v7, 1, v7
    ds_write_addtid_b32 v7
    s_setprio 0
    s_waitcnt lgkmcnt(9)
    v_mfma_f32_16x16x32_bf16 v[56:59], v[24:27], v[144:147], v[56:59]
    ds_read_b64_tr_b16 v[16:17], v4 offset:32768
    s_add_u32 s37, s33, 8192
    buffer_load_dwordx4 v[180:183], v1, s[4:7], s37 offen offset:0 sc1
    v_mfma_f32_16x16x32_bf16 v[56:59], v[28:31], v[152:155], v[56:59]
    ds_read_b64_tr_b16 v[18:19], v4 offset:33280
    buffer_load_dwordx4 v[188:191], v1, s[4:7], s37 offen offset:1024 sc1
    v_mfma_f32_16x16x32_bf16 v[60:63], v[24:27], v[148:151], v[60:63]
    ds_read_b64_tr_b16 v[20:21], v4 offset:36864
    s_lshl_b32 s30, s98, 2
    v_mfma_f32_16x16x32_bf16 v[60:63], v[28:31], v[156:159], v[60:63]
    ds_read_b64_tr_b16 v[22:23], v4 offset:37376
    s_add_u32 s30, s30, s23
    s_waitcnt lgkmcnt(9)
    v_mfma_f32_16x16x32_bf16 v[64:67], v[32:35], v[144:147], v[64:67]
    ds_read_b64_tr_b16 v[24:25], v4 offset:40960
    v_mfma_f32_16x16x32_bf16 v[64:67], v[36:39], v[152:155], v[64:67]
    ds_read_b64_tr_b16 v[26:27], v4 offset:41472
    s_mul_i32 s30, s30, 360
    v_mfma_f32_16x16x32_bf16 v[68:71], v[32:35], v[148:151], v[68:71]
    ds_read_b64_tr_b16 v[28:29], v4 offset:45056
    v_mfma_f32_16x16x32_bf16 v[68:71], v[36:39], v[156:159], v[68:71]
    ds_read_b64_tr_b16 v[30:31], v4 offset:45568
    v_add_u32 v4, 49152, v4
    s_mul_i32 s31, s97, 36
    ds_read_b32 v8, v9
    s_waitcnt lgkmcnt(10)
    v_mfma_f32_16x16x32_bf16 v[72:75], v[40:43], v[144:147], v[72:75]
    ds_read_b64_tr_b16 v[32:33], v5 offset:32768
    s_add_u32 m0, s35, 81920
    s_add_u32 s41, s38, 2949120
    buffer_load_dwordx4 v6, s[8:11], s41 offen lds
    v_mfma_f32_16x16x32_bf16 v[72:75], v[44:47], v[152:155], v[72:75]
    ds_read_b64_tr_b16 v[34:35], v5 offset:33280
    s_add_u32 m0, s35, 90112
    s_add_u32 s41, s38, 2949120
    buffer_load_dwordx4 v6, s[12:15], s41 offen lds
    v_mfma_f32_16x16x32_bf16 v[76:79], v[40:43], v[148:151], v[76:79]
    ds_read_b64_tr_b16 v[36:37], v5 offset:36864
    s_add_u32 s30, s30, s31
    v_mfma_f32_16x16x32_bf16 v[76:79], v[44:47], v[156:159], v[76:79]
    ds_read_b64_tr_b16 v[38:39], v5 offset:37376
    s_add_u32 s30, s30, s42
    s_lshl_b32 s30, s30, 10
    s_waitcnt lgkmcnt(9)
    v_mfma_f32_16x16x32_bf16 v[80:83], v[16:19], v[144:147], v[80:83]
    ds_read_b64_tr_b16 v[40:41], v5 offset:40960
    v_mfma_f32_16x16x32_bf16 v[80:83], v[20:23], v[152:155], v[80:83]
    ds_read_b64_tr_b16 v[42:43], v5 offset:41472
    s_add_u32 s30, s30, 2359296
    v_mfma_f32_16x16x32_bf16 v[84:87], v[16:19], v[148:151], v[84:87]
    ds_read_b64_tr_b16 v[44:45], v5 offset:45056
    v_mfma_f32_16x16x32_bf16 v[84:87], v[20:23], v[156:159], v[84:87]
    ds_read_b64_tr_b16 v[46:47], v5 offset:45568
    v_add_u32 v5, 49152, v5
    s_add_u32 s31, s30, 184320
    s_waitcnt lgkmcnt(8)
    v_cmp_gt_i32 vcc, v7, v8
    s_cbranch_vccnz SBs_12
SBb_13:
    s_setprio 1
    v_mfma_f32_16x16x32_bf16 v[88:91], v[24:27], v[144:147], v[88:91]
    ds_read_b64_tr_b16 v[16:17], v2 offset:0
    v_mfma_f32_16x16x32_bf16 v[88:91], v[28:31], v[152:155], v[88:91]
    ds_read_b64_tr_b16 v[18:19], v2 offset:512
    s_lshl_b32 s57, s98, 2
    v_mfma_f32_16x16x32_bf16 v[92:95], v[24:27], v[148:151], v[92:95]
    ds_read_b64_tr_b16 v[20:21], v2 offset:4096
    v_mfma_f32_16x16x32_bf16 v[92:95], v[28:31], v[156:159], v[92:95]
    ds_read_b64_tr_b16 v[22:23], v2 offset:4608
    s_add_u32 s57, s57, s23
    s_waitcnt lgkmcnt(8)
    v_mfma_f32_16x16x32_bf16 v[96:99], v[32:35], v[144:147], v[96:99]
    ds_read_b64_tr_b16 v[24:25], v2 offset:8192
    v_mfma_f32_16x16x32_bf16 v[96:99], v[36:39], v[152:155], v[96:99]
    ds_read_b64_tr_b16 v[26:27], v2 offset:8704
    s_mul_i32 s57, s57, 640
    v_mfma_f32_16x16x32_bf16 v[100:103], v[32:35], v[148:151], v[100:103]
    ds_read_b64_tr_b16 v[28:29], v2 offset:12288
    v_mfma_f32_16x16x32_bf16 v[100:103], v[36:39], v[156:159], v[100:103]
    ds_read_b64_tr_b16 v[30:31], v2 offset:12800
    s_lshl_b32 s47, s97, 7
    s_waitcnt lgkmcnt(8)
    v_mfma_f32_16x16x32_bf16 v[104:107], v[40:43], v[144:147], v[104:107]
    ds_read_b64_tr_b16 v[32:33], v3 offset:0
    v_mfma_f32_16x16x32_bf16 v[104:107], v[44:47], v[152:155], v[104:107]
    ds_read_b64_tr_b16 v[34:35], v3 offset:512
    s_add_u32 s57, s57, s47
    v_mfma_f32_16x16x32_bf16 v[108:111], v[40:43], v[148:151], v[108:111]
    ds_read_b64_tr_b16 v[36:37], v3 offset:4096
    s_add_u32 s57, s57, 42717184
    v_mfma_f32_16x16x32_bf16 v[108:111], v[44:47], v[156:159], v[108:111]
    ds_read_b64_tr_b16 v[38:39], v3 offset:4608
    s_mul_i32 s43, s98, 3
    s_waitcnt vmcnt(8)
    s_waitcnt lgkmcnt(8)
    v_mfma_f32_16x16x32_bf16 v[48:51], v[16:19], v[160:163], v[48:51]
    ds_read_b64_tr_b16 v[40:41], v3 offset:8192
    s_add_u32 s36, s32, 10240
    buffer_load_dwordx4 v[192:195], v1, s[4:7], s36 offen offset:0 sc1
    v_mfma_f32_16x16x32_bf16 v[48:51], v[20:23], v[168:171], v[48:51]
    ds_read_b64_tr_b16 v[42:43], v3 offset:8704
    buffer_load_dwordx4 v[200:203], v1, s[4:7], s36 offen offset:1024 sc1
    v_mfma_f32_16x16x32_bf16 v[52:55], v[16:19], v[164:167], v[52:55]
    ds_read_b64_tr_b16 v[44:45], v3 offset:12288
    s_add_u32 s43, s43, s99
    v_mfma_f32_16x16x32_bf16 v[52:55], v[20:23], v[172:175], v[52:55]
    ds_read_b64_tr_b16 v[46:47], v3 offset:12800
    s_add_u32 s49, s97, 10
    s_waitcnt vmcnt(8)
    s_mov_b32 m0, s46
    v_add_u32 v7, 1, v7
    ds_write_addtid_b32 v7
    s_setprio 0
    s_waitcnt lgkmcnt(9)
    v_mfma_f32_16x16x32_bf16 v[56:59], v[24:27], v[160:163], v[56:59]
    ds_read_b64_tr_b16 v[16:17], v4 offset:0
    s_add_u32 s37, s33, 10240
    buffer_load_dwordx4 v[196:199], v1, s[4:7], s37 offen offset:0 sc1
    v_mfma_f32_16x16x32_bf16 v[56:59], v[28:31], v[168:171], v[56:59]
    ds_read_b64_tr_b16 v[18:19], v4 offset:512
    buffer_load_dwordx4 v[204:207], v1, s[4:7], s37 offen offset:1024 sc1
    v_mfma_f32_16x16x32_bf16 v[60:63], v[24:27], v[164:167], v[60:63]
    ds_read_b64_tr_b16 v[20:21], v4 offset:4096
    s_sub_u32 s49, s49, s16
    v_mfma_f32_16x16x32_bf16 v[60:63], v[28:31], v[172:175], v[60:63]
    ds_read_b64_tr_b16 v[22:23], v4 offset:4608
    s_mul_i32 s47, s49, 52
    s_waitcnt lgkmcnt(9)
    v_mfma_f32_16x16x32_bf16 v[64:67], v[32:35], v[160:163], v[64:67]
    ds_read_b64_tr_b16 v[24:25], v4 offset:8192
    v_mfma_f32_16x16x32_bf16 v[64:67], v[36:39], v[168:171], v[64:67]
    ds_read_b64_tr_b16 v[26:27], v4 offset:8704
    s_lshr_b32 s47, s47, 8
    v_mfma_f32_16x16x32_bf16 v[68:71], v[32:35], v[164:167], v[68:71]
    ds_read_b64_tr_b16 v[28:29], v4 offset:12288
    v_mfma_f32_16x16x32_bf16 v[68:71], v[36:39], v[172:175], v[68:71]
    ds_read_b64_tr_b16 v[30:31], v4 offset:12800
    s_mul_i32 s47, s47, 5
    ds_read_b32 v8, v9
    s_waitcnt lgkmcnt(10)
    v_mfma_f32_16x16x32_bf16 v[72:75], v[40:43], v[160:163], v[72:75]
    ds_read_b64_tr_b16 v[32:33], v5 offset:0
    s_add_u32 m0, s35, 98304
    s_add_u32 s41, s38, 3538944
    buffer_load_dwordx4 v6, s[8:11], s41 offen lds
    v_mfma_f32_16x16x32_bf16 v[72:75], v[44:47], v[168:171], v[72:75]
    ds_read_b64_tr_b16 v[34:35], v5 offset:512
    s_add_u32 m0, s35, 106496
    s_add_u32 s41, s38, 3538944
    buffer_load_dwordx4 v6, s[12:15], s41 offen lds
    v_mfma_f32_16x16x32_bf16 v[76:79], v[40:43], v[164:167], v[76:79]
    ds_read_b64_tr_b16 v[36:37], v5 offset:4096
    s_sub_u32 s49, s49, s47
    v_mfma_f32_16x16x32_bf16 v[76:79], v[44:47], v[172:175], v[76:79]
    ds_read_b64_tr_b16 v[38:39], v5 offset:4608
    s_lshl_b32 s47, s98, 7
    s_lshl_b32 s50, s23, 5
    s_waitcnt lgkmcnt(9)
    v_mfma_f32_16x16x32_bf16 v[80:83], v[16:19], v[160:163], v[80:83]
    ds_read_b64_tr_b16 v[40:41], v5 offset:8192
    v_mfma_f32_16x16x32_bf16 v[80:83], v[20:23], v[168:171], v[80:83]
    ds_read_b64_tr_b16 v[42:43], v5 offset:8704
    s_add_u32 s47, s47, s50
    v_mfma_f32_16x16x32_bf16 v[84:87], v[16:19], v[164:167], v[84:87]
    ds_read_b64_tr_b16 v[44:45], v5 offset:12288
    v_mfma_f32_16x16x32_bf16 v[84:87], v[20:23], v[172:175], v[84:87]
    ds_read_b64_tr_b16 v[46:47], v5 offset:12800
    s_mul_i32 s47, s47, 2304
    s_waitcnt lgkmcnt(8)
    v_cmp_gt_i32 vcc, v7, v8
    s_cbranch_vccnz SBs_14
SBb_15:
    s_setprio 1
    v_mfma_f32_16x16x32_bf16 v[88:91], v[24:27], v[160:163], v[88:91]
    ds_read_b64_tr_b16 v[16:17], v2 offset:16384
    v_mfma_f32_16x16x32_bf16 v[88:91], v[28:31], v[168:171], v[88:91]
    ds_read_b64_tr_b16 v[18:19], v2 offset:16896
    s_mul_i32 s50, s99, 768
    v_mfma_f32_16x16x32_bf16 v[92:95], v[24:27], v[164:167], v[92:95]
    ds_read_b64_tr_b16 v[20:21], v2 offset:20480
    v_mfma_f32_16x16x32_bf16 v[92:95], v[28:31], v[172:175], v[92:95]
    ds_read_b64_tr_b16 v[22:23], v2 offset:20992
    s_add_u32 s47, s47, s50
    s_waitcnt lgkmcnt(8)
    v_mfma_f32_16x16x32_bf16 v[96:99], v[32:35], v[160:163], v[96:99]
    ds_read_b64_tr_b16 v[24:25], v2 offset:24576
    v_mfma_f32_16x16x32_bf16 v[96:99], v[36:39], v[168:171], v[96:99]
    ds_read_b64_tr_b16 v[26:27], v2 offset:25088
    s_lshl_b32 s50, s42, 8
    v_mfma_f32_16x16x32_bf16 v[100:103], v[32:35], v[164:167], v[100:103]
    ds_read_b64_tr_b16 v[28:29], v2 offset:28672
    v_mfma_f32_16x16x32_bf16 v[100:103], v[36:39], v[172:175], v[100:103]
    ds_read_b64_tr_b16 v[30:31], v2 offset:29184
    s_add_u32 s60, s47, s50
    s_waitcnt lgkmcnt(8)
    v_mfma_f32_16x16x32_bf16 v[104:107], v[40:43], v[160:163], v[104:107]
    ds_read_b64_tr_b16 v[32:33], v3 offset:16384
    v_mfma_f32_16x16x32_bf16 v[104:107], v[44:47], v[168:171], v[104:107]
    ds_read_b64_tr_b16 v[34:35], v3 offset:16896
    s_and_b32 s50, s49, 1
    v_mfma_f32_16x16x32_bf16 v[108:111], v[40:43], v[164:167], v[108:111]
    ds_read_b64_tr_b16 v[36:37], v3 offset:20480
    s_mul_i32 s50, s50, 9216
    v_mfma_f32_16x16x32_bf16 v[108:111], v[44:47], v[172:175], v[108:111]
    ds_read_b64_tr_b16 v[38:39], v3 offset:20992
    s_add_u32 s60, s60, s50
    s_waitcnt vmcnt(8)
    s_waitcnt lgkmcnt(8)
    v_mfma_f32_16x16x32_bf16 v[48:51], v[16:19], v[176:179], v[48:51]
    ds_read_b64_tr_b16 v[40:41], v3 offset:24576
    s_add_u32 s36, s32, 12288
    buffer_load_dwordx4 v[208:211], v1, s[4:7], s36 offen offset:0 sc1
    v_mfma_f32_16x16x32_bf16 v[48:51], v[20:23], v[184:187], v[48:51]
    ds_read_b64_tr_b16 v[42:43], v3 offset:25088
    buffer_load_dwordx4 v[216:219], v1, s[4:7], s36 offen offset:1024 sc1
    v_mfma_f32_16x16x32_bf16 v[52:55], v[16:19], v[180:183], v[52:55]
    ds_read_b64_tr_b16 v[44:45], v3 offset:28672
    s_lshr_b32 s50, s49, 1
    v_mfma_f32_16x16x32_bf16 v[52:55], v[20:23], v[188:191], v[52:55]
    ds_read_b64_tr_b16 v[46:47], v3 offset:29184
    s_lshl_b32 s50, s50, 7
    s_waitcnt vmcnt(8)
    s_mov_b32 m0, s46
    v_add_u32 v7, 1, v7
    ds_write_addtid_b32 v7
    s_setprio 0
    s_waitcnt lgkmcnt(9)
    v_mfma_f32_16x16x32_bf16 v[56:59], v[24:27], v[176:179], v[56:59]
    ds_read_b64_tr_b16 v[16:17], v4 offset:16384
    s_add_u32 s37, s33, 12288
    buffer_load_dwordx4 v[212:215], v1, s[4:7], s37 offen offset:0 sc1
    v_mfma_f32_16x16x32_bf16 v[56:59], v[28:31], v[184:187], v[56:59]
    ds_read_b64_tr_b16 v[18:19], v4 offset:16896
    buffer_load_dwordx4 v[220:223], v1, s[4:7], s37 offen offset:1024 sc1
    v_mfma_f32_16x16x32_bf16 v[60:63], v[24:27], v[180:183], v[60:63]
    ds_read_b64_tr_b16 v[20:21], v4 offset:20480
    s_add_u32 s60, s60, s50
    v_mfma_f32_16x16x32_bf16 v[60:63], v[28:31], v[188:191], v[60:63]
    ds_read_b64_tr_b16 v[22:23], v4 offset:20992
    s_lshl_b32 s50, s42, 7
    s_waitcnt lgkmcnt(9)
    v_mfma_f32_16x16x32_bf16 v[64:67], v[32:35], v[176:179], v[64:67]
    ds_read_b64_tr_b16 v[24:25], v4 offset:24576
    v_mfma_f32_16x16x32_bf16 v[64:67], v[36:39], v[184:187], v[64:67]
    ds_read_b64_tr_b16 v[26:27], v4 offset:25088
    s_add_u32 s61, s47, s50
    v_mfma_f32_16x16x32_bf16 v[68:71], v[32:35], v[180:183], v[68:71]
    ds_read_b64_tr_b16 v[28:29], v4 offset:28672
    s_add_u32 s61, s61, 512
    v_mfma_f32_16x16x32_bf16 v[68:71], v[36:39], v[188:191], v[68:71]
    ds_read_b64_tr_b16 v[30:31], v4 offset:29184
    s_cmp_eq_u32 s49, 0
    s_cselect_b32 s50, 9216, 0
    ds_read_b32 v8, v9
    s_waitcnt lgkmcnt(10)
    v_mfma_f32_16x16x32_bf16 v[72:75], v[40:43], v[176:179], v[72:75]
    ds_read_b64_tr_b16 v[32:33], v5 offset:16384
    s_add_u32 m0, s35, 114688
    s_add_u32 s41, s38, 4128768
    buffer_load_dwordx4 v6, s[8:11], s41 offen lds
    v_mfma_f32_16x16x32_bf16 v[72:75], v[44:47], v[184:187], v[72:75]
    ds_read_b64_tr_b16 v[34:35], v5 offset:16896
    s_add_u32 m0, s35, 122880
    s_add_u32 s41, s38, 4128768
    buffer_load_dwordx4 v6, s[12:15], s41 offen lds
    v_mfma_f32_16x16x32_bf16 v[76:79], v[40:43], v[180:183], v[76:79]
    ds_read_b64_tr_b16 v[36:37], v5 offset:20480
    s_add_u32 s61, s61, s50
    v_mfma_f32_16x16x32_bf16 v[76:79], v[44:47], v[188:191], v[76:79]
    ds_read_b64_tr_b16 v[38:39], v5 offset:20992
    s_lshl_b32 s47, s43, 3
    s_waitcnt lgkmcnt(9)
    v_mfma_f32_16x16x32_bf16 v[80:83], v[16:19], v[176:179], v[80:83]
    ds_read_b64_tr_b16 v[40:41], v5 offset:24576
    v_mfma_f32_16x16x32_bf16 v[80:83], v[20:23], v[184:187], v[80:83]
    ds_read_b64_tr_b16 v[42:43], v5 offset:25088
    s_add_u32 s47, s47, s16
    v_mfma_f32_16x16x32_bf16 v[84:87], v[16:19], v[180:183], v[84:87]
    ds_read_b64_tr_b16 v[44:45], v5 offset:28672
    v_mfma_f32_16x16x32_bf16 v[84:87], v[20:23], v[188:191], v[84:87]
    ds_read_b64_tr_b16 v[46:47], v5 offset:29184
    s_mul_i32 s47, s47, 6144
    s_waitcnt lgkmcnt(8)
    v_cmp_gt_i32 vcc, v7, v8
    s_cbranch_vccnz SBs_16
SBb_17:
    s_setprio 1
    v_mfma_f32_16x16x32_bf16 v[88:91], v[24:27], v[176:179], v[88:91]
    ds_read_b64_tr_b16 v[16:17], v2 offset:32768
    v_mfma_f32_16x16x32_bf16 v[88:91], v[28:31], v[184:187], v[88:91]
    ds_read_b64_tr_b16 v[18:19], v2 offset:33280
    s_add_u32 s47, s47, 30789632
    v_mfma_f32_16x16x32_bf16 v[92:95], v[24:27], v[180:183], v[92:95]
    ds_read_b64_tr_b16 v[20:21], v2 offset:36864
    s_mul_i32 s54, s97, 2359296
    v_mfma_f32_16x16x32_bf16 v[92:95], v[28:31], v[188:191], v[92:95]
    ds_read_b64_tr_b16 v[22:23], v2 offset:37376
    s_add_u32 s54, s54, s47
    s_waitcnt lgkmcnt(8)
    v_mfma_f32_16x16x32_bf16 v[96:99], v[32:35], v[176:179], v[96:99]
    ds_read_b64_tr_b16 v[24:25], v2 offset:40960
    v_mfma_f32_16x16x32_bf16 v[96:99], v[36:39], v[184:187], v[96:99]
    ds_read_b64_tr_b16 v[26:27], v2 offset:41472
    s_add_u32 s55, s54, 3072
    v_mfma_f32_16x16x32_bf16 v[100:103], v[32:35], v[180:183], v[100:103]
    ds_read_b64_tr_b16 v[28:29], v2 offset:45056
    v_mfma_f32_16x16x32_bf16 v[100:103], v[36:39], v[188:191], v[100:103]
    ds_read_b64_tr_b16 v[30:31], v2 offset:45568
    v_add_u32 v2, 49152, v2
    s_lshl_b32 s50, s49, 10
    s_waitcnt lgkmcnt(8)
    v_mfma_f32_16x16x32_bf16 v[104:107], v[40:43], v[176:179], v[104:107]
    ds_read_b64_tr_b16 v[32:33], v3 offset:32768
    v_mfma_f32_16x16x32_bf16 v[104:107], v[44:47], v[184:187], v[104:107]
    ds_read_b64_tr_b16 v[34:35], v3 offset:33280
    s_add_u32 s62, s47, s50
    v_mfma_f32_16x16x32_bf16 v[108:111], v[40:43], v[180:183], v[108:111]
    ds_read_b64_tr_b16 v[36:37], v3 offset:36864
    s_cmp_eq_u32 s49, 0
    s_mov_b32 s50, 4096
    s_cselect_b32 s50, 5120, s50
    v_mfma_f32_16x16x32_bf16 v[108:111], v[44:47], v[188:191], v[108:111]
    ds_read_b64_tr_b16 v[38:39], v3 offset:37376
    s_add_u32 s63, s47, s50
    s_waitcnt vmcnt(8)
    s_waitcnt lgkmcnt(8)
    v_mfma_f32_16x16x32_bf16 v[48:51], v[16:19], v[192:195], v[48:51]
    ds_read_b64_tr_b16 v[40:41], v3 offset:40960
    s_add_u32 s36, s32, 14336
    buffer_load_dwordx4 v[224:227], v1, s[4:7], s36 offen offset:0 sc1
    v_mfma_f32_16x16x32_bf16 v[48:51], v[20:23], v[200:203], v[48:51]
    ds_read_b64_tr_b16 v[42:43], v3 offset:41472
    buffer_load_dwordx4 v[232:235], v1, s[4:7], s36 offen offset:1024 sc1
    v_mfma_f32_16x16x32_bf16 v[52:55], v[16:19], v[196:199], v[52:55]
    ds_read_b64_tr_b16 v[44:45], v3 offset:45056
    s_cmp_lt_u32 s49, 4
    s_cselect_b32 s60, s60, 0x7ff00000
    s_cselect_b32 s62, s62, 0x7ff00000
    v_mfma_f32_16x16x32_bf16 v[52:55], v[20:23], v[204:207], v[52:55]
    ds_read_b64_tr_b16 v[46:47], v3 offset:45568
    v_add_u32 v3, 49152, v3
    s_and_b32 s50, s49, 3
    s_waitcnt vmcnt(8)
    s_mov_b32 m0, s46
    v_add_u32 v7, 1, v7
    ds_write_addtid_b32 v7
    s_setprio 0
    s_waitcnt lgkmcnt(9)
    v_mfma_f32_16x16x32_bf16 v[56:59], v[24:27], v[192:195], v[56:59]
    ds_read_b64_tr_b16 v[16:17], v4 offset:32768
    s_add_u32 s37, s33, 14336
    buffer_load_dwordx4 v[228:231], v1, s[4:7], s37 offen offset:0 sc1
    v_mfma_f32_16x16x32_bf16 v[56:59], v[28:31], v[200:203], v[56:59]
    ds_read_b64_tr_b16 v[18:19], v4 offset:33280
    buffer_load_dwordx4 v[236:239], v1, s[4:7], s37 offen offset:1024 sc1
    v_mfma_f32_16x16x32_bf16 v[60:63], v[24:27], v[196:199], v[60:63]
    ds_read_b64_tr_b16 v[20:21], v4 offset:36864
    s_cmp_eq_u32 s50, 0
    s_cselect_b32 s61, s61, 0x7ff00000
    s_cselect_b32 s63, s63, 0x7ff00000
    v_mfma_f32_16x16x32_bf16 v[60:63], v[28:31], v[204:207], v[60:63]
    ds_read_b64_tr_b16 v[22:23], v4 offset:37376
    s_lshl_b32 s47, s43, 3
    s_waitcnt lgkmcnt(9)
    v_mfma_f32_16x16x32_bf16 v[64:67], v[32:35], v[192:195], v[64:67]
    ds_read_b64_tr_b16 v[24:25], v4 offset:40960
    v_mfma_f32_16x16x32_bf16 v[64:67], v[36:39], v[200:203], v[64:67]
    ds_read_b64_tr_b16 v[26:27], v4 offset:41472
    s_add_u32 s47, s47, 0
    v_mfma_f32_16x16x32_bf16 v[68:71], v[32:35], v[196:199], v[68:71]
    ds_read_b64_tr_b16 v[28:29], v4 offset:45056
    v_mfma_f32_16x16x32_bf16 v[68:71], v[36:39], v[204:207], v[68:71]
    ds_read_b64_tr_b16 v[30:31], v4 offset:45568
    v_add_u32 v4, 49152, v4
    s_lshl_b32 s47, s47, 7
    ds_read_b32 v8, v9
    s_waitcnt lgkmcnt(10)
    v_mfma_f32_16x16x32_bf16 v[72:75], v[40:43], v[192:195], v[72:75]
    ds_read_b64_tr_b16 v[32:33], v5 offset:32768
    s_add_u32 m0, s35, 131072
    s_add_u32 s41, s38, 4718592
    buffer_load_dwordx4 v6, s[8:11], s41 offen lds
    v_mfma_f32_16x16x32_bf16 v[72:75], v[44:47], v[200:203], v[72:75]
    ds_read_b64_tr_b16 v[34:35], v5 offset:33280
    s_add_u32 m0, s35, 139264
    s_add_u32 s41, s38, 4718592
    buffer_load_dwordx4 v6, s[12:15], s41 offen lds
    v_mfma_f32_16x16x32_bf16 v[76:79], v[40:43], v[196:199], v[76:79]
    ds_read_b64_tr_b16 v[36:37], v5 offset:36864
    s_add_u32 s48, s47, 42651648
    v_mfma_f32_16x16x32_bf16 v[76:79], v[44:47], v[204:207], v[76:79]
    ds_read_b64_tr_b16 v[38:39], v5 offset:37376
    v_bfe_u32 v10, v0, 2, 2
    v_lshlrev_b32 v10, 3, v10
    s_waitcnt lgkmcnt(9)
    v_mfma_f32_16x16x32_bf16 v[80:83], v[16:19], v[192:195], v[80:83]
    ds_read_b64_tr_b16 v[40:41], v5 offset:40960
    v_mfma_f32_16x16x32_bf16 v[80:83], v[20:23], v[200:203], v[80:83]
    ds_read_b64_tr_b16 v[42:43], v5 offset:41472
    v_and_b32 v15, 3, v0
    v_mfma_f32_16x16x32_bf16 v[84:87], v[16:19], v[196:199], v[84:87]
    ds_read_b64_tr_b16 v[44:45], v5 offset:45056
    v_mfma_f32_16x16x32_bf16 v[84:87], v[20:23], v[204:207], v[84:87]
    ds_read_b64_tr_b16 v[46:47], v5 offset:45568
    v_add_u32 v5, 49152, v5
    v_add_u32 v10, v10, v15
    s_waitcnt lgkmcnt(8)
    v_cmp_gt_i32 vcc, v7, v8
    s_cbranch_vccnz SBs_18
SBb_19:
    s_setprio 1
    v_mfma_f32_16x16x32_bf16 v[88:91], v[24:27], v[192:195], v[88:91]
    ds_read_b64_tr_b16 v[16:17], v2 offset:0
    v_mfma_f32_16x16x32_bf16 v[88:91], v[28:31], v[200:203], v[88:91]
    ds_read_b64_tr_b16 v[18:19], v2 offset:512
    v_mul_u32_u24 v10, 2304, v10
    v_mfma_f32_16x16x32_bf16 v[92:95], v[24:27], v[196:199], v[92:95]
    ds_read_b64_tr_b16 v[20:21], v2 offset:4096
    v_mfma_f32_16x16x32_bf16 v[92:95], v[28:31], v[204:207], v[92:95]
    ds_read_b64_tr_b16 v[22:23], v2 offset:4608
    v_lshrrev_b32 v15, 4, v0
    s_waitcnt lgkmcnt(8)
    v_mfma_f32_16x16x32_bf16 v[96:99], v[32:35], v[192:195], v[96:99]
    ds_read_b64_tr_b16 v[24:25], v2 offset:8192
    v_mfma_f32_16x16x32_bf16 v[96:99], v[36:39], v[200:203], v[96:99]
    ds_read_b64_tr_b16 v[26:27], v2 offset:8704
    v_lshl_add_u32 v10, v15, 4, v10
    v_mfma_f32_16x16x32_bf16 v[100:103], v[32:35], v[196:199], v[100:103]
    ds_read_b64_tr_b16 v[28:29], v2 offset:12288
    v_mfma_f32_16x16x32_bf16 v[100:103], v[36:39], v[204:207], v[100:103]
    ds_read_b64_tr_b16 v[30:31], v2 offset:12800
    s_lshl_b32 s47, s16, 13
    s_waitcnt lgkmcnt(8)
    v_mfma_f32_16x16x32_bf16 v[104:107], v[40:43], v[192:195], v[104:107]
    ds_read_b64_tr_b16 v[32:33], v3 offset:0
    v_mfma_f32_16x16x32_bf16 v[104:107], v[44:47], v[200:203], v[104:107]
    ds_read_b64_tr_b16 v[34:35], v3 offset:512
    s_add_u32 s47, s47, 92160
    v_mfma_f32_16x16x32_bf16 v[108:111], v[40:43], v[196:199], v[108:111]
    ds_read_b64_tr_b16 v[36:37], v3 offset:4096
    v_add_u32 v11, s47, v1
    v_mfma_f32_16x16x32_bf16 v[108:111], v[44:47], v[204:207], v[108:111]
    ds_read_b64_tr_b16 v[38:39], v3 offset:4608
    s_xor_b32 s50, s16, 4
    s_waitcnt vmcnt(8)
    s_waitcnt lgkmcnt(8)
    v_mfma_f32_16x16x32_bf16 v[48:51], v[16:19], v[208:211], v[48:51]
    ds_read_b64_tr_b16 v[40:41], v3 offset:8192
    s_add_u32 s36, s32, 16384
    buffer_load_dwordx4 v[240:243], v1, s[4:7], s36 offen offset:0 sc1
    v_mfma_f32_16x16x32_bf16 v[48:51], v[20:23], v[216:219], v[48:51]
    ds_read_b64_tr_b16 v[42:43], v3 offset:8704
    buffer_load_dwordx4 v[248:251], v1, s[4:7], s36 offen offset:1024 sc1
    v_mfma_f32_16x16x32_bf16 v[52:55], v[16:19], v[212:215], v[52:55]
    ds_read_b64_tr_b16 v[44:45], v3 offset:12288
    s_lshl_b32 s50, s50, 13
    v_mfma_f32_16x16x32_bf16 v[52:55], v[20:23], v[220:223], v[52:55]
    ds_read_b64_tr_b16 v[46:47], v3 offset:12800
    s_add_u32 s50, s50, 92160
    s_waitcnt vmcnt(8)
    s_mov_b32 m0, s46
    v_add_u32 v7, 1, v7
    ds_write_addtid_b32 v7
    s_setprio 0
    s_waitcnt lgkmcnt(9)
    v_mfma_f32_16x16x32_bf16 v[56:59], v[24:27], v[208:211], v[56:59]
    ds_read_b64_tr_b16 v[16:17], v4 offset:0
    s_add_u32 s37, s33, 16384
    buffer_load_dwordx4 v[244:247], v1, s[4:7], s37 offen offset:0 sc1
    v_mfma_f32_16x16x32_bf16 v[56:59], v[28:31], v[216:219], v[56:59]
    ds_read_b64_tr_b16 v[18:19], v4 offset:512
    buffer_load_dwordx4 v[252:255], v1, s[4:7], s37 offen offset:1024 sc1
    v_mfma_f32_16x16x32_bf16 v[60:63], v[24:27], v[212:215], v[60:63]
    ds_read_b64_tr_b16 v[20:21], v4 offset:4096
    v_add_u32 v12, s50, v1
    v_mfma_f32_16x16x32_bf16 v[60:63], v[28:31], v[220:223], v[60:63]
    ds_read_b64_tr_b16 v[22:23], v4 offset:4608
    v_min_u32 v13, 5, v0
    s_waitcnt lgkmcnt(9)
    v_mfma_f32_16x16x32_bf16 v[64:67], v[32:35], v[208:211], v[64:67]
    ds_read_b64_tr_b16 v[24:25], v4 offset:8192
    v_mfma_f32_16x16x32_bf16 v[64:67], v[36:39], v[216:219], v[64:67]
    ds_read_b64_tr_b16 v[26:27], v4 offset:8704
    v_lshlrev_b32 v13, 2, v13
    v_mfma_f32_16x16x32_bf16 v[68:71], v[32:35], v[212:215], v[68:71]
    ds_read_b64_tr_b16 v[28:29], v4 offset:12288
    s_mul_i32 s51, s97, 1327104
    v_mfma_f32_16x16x32_bf16 v[68:71], v[36:39], v[220:223], v[68:71]
    ds_read_b64_tr_b16 v[30:31], v4 offset:12800
    s_mul_i32 s50, s99, 384
    ds_read_b32 v8, v9
    s_waitcnt lgkmcnt(10)
    v_mfma_f32_16x16x32_bf16 v[72:75], v[40:43], v[208:211], v[72:75]
    ds_read_b64_tr_b16 v[32:33], v5 offset:0
    s_add_u32 m0, s35, 0
    s_add_u32 s41, s38, 128
    buffer_load_dwordx4 v6, s[8:11], s41 offen lds
    v_mfma_f32_16x16x32_bf16 v[72:75], v[44:47], v[216:219], v[72:75]
    ds_read_b64_tr_b16 v[34:35], v5 offset:512
    s_add_u32 m0, s35, 8192
    s_add_u32 s41, s38, 128
    buffer_load_dwordx4 v6, s[12:15], s41 offen lds
    v_mfma_f32_16x16x32_bf16 v[76:79], v[40:43], v[212:215], v[76:79]
    ds_read_b64_tr_b16 v[36:37], v5 offset:4096
    s_add_u32 s28, s51, s50
    v_mfma_f32_16x16x32_bf16 v[76:79], v[44:47], v[220:223], v[76:79]
    ds_read_b64_tr_b16 v[38:39], v5 offset:4608
    s_lshl_b32 s50, s18, 3
    s_waitcnt lgkmcnt(9)
    v_mfma_f32_16x16x32_bf16 v[80:83], v[16:19], v[208:211], v[80:83]
    ds_read_b64_tr_b16 v[40:41], v5 offset:8192
    v_mfma_f32_16x16x32_bf16 v[80:83], v[20:23], v[216:219], v[80:83]
    ds_read_b64_tr_b16 v[42:43], v5 offset:8704
    s_add_u32 s50, s50, s17
    v_mfma_f32_16x16x32_bf16 v[84:87], v[16:19], v[212:215], v[84:87]
    ds_read_b64_tr_b16 v[44:45], v5 offset:12288
    v_mfma_f32_16x16x32_bf16 v[84:87], v[20:23], v[220:223], v[84:87]
    ds_read_b64_tr_b16 v[46:47], v5 offset:12800
    s_lshl_b32 s50, s50, 3
    s_waitcnt lgkmcnt(8)
    v_cmp_gt_i32 vcc, v7, v8
    s_cbranch_vccnz SBs_20
SBb_21:
    s_setprio 1
    v_mfma_f32_16x16x32_bf16 v[88:91], v[24:27], v[208:211], v[88:91]
    ds_read_b64_tr_b16 v[16:17], v2 offset:16384
    v_mfma_f32_16x16x32_bf16 v[88:91], v[28:31], v[216:219], v[88:91]
    ds_read_b64_tr_b16 v[18:19], v2 offset:16896
    s_add_u32 s50, s50, s16
    v_mfma_f32_16x16x32_bf16 v[92:95], v[24:27], v[212:215], v[92:95]
    ds_read_b64_tr_b16 v[20:21], v2 offset:20480
    s_min_u32 s50, s50, 161
    v_mfma_f32_16x16x32_bf16 v[92:95], v[28:31], v[220:223], v[92:95]
    ds_read_b64_tr_b16 v[22:23], v2 offset:20992
    s_lshl_b32 s50, s50, 13
    s_waitcnt lgkmcnt(8)
    v_mfma_f32_16x16x32_bf16 v[96:99], v[32:35], v[208:211], v[96:99]
    ds_read_b64_tr_b16 v[24:25], v2 offset:24576
    s_add_u32 m0, s35, 16384
    s_add_u32 s41, s38, 589952
    buffer_load_dwordx4 v6, s[8:11], s41 offen lds
    v_mfma_f32_16x16x32_bf16 v[96:99], v[36:39], v[216:219], v[96:99]
    ds_read_b64_tr_b16 v[26:27], v2 offset:25088
    s_add_u32 m0, s35, 24576
    s_add_u32 s41, s38, 589952
    buffer_load_dwordx4 v6, s[12:15], s41 offen lds
    v_mfma_f32_16x16x32_bf16 v[100:103], v[32:35], v[212:215], v[100:103]
    ds_read_b64_tr_b16 v[28:29], v2 offset:28672
    s_add_u32 s29, s51, s50
    v_mfma_f32_16x16x32_bf16 v[100:103], v[36:39], v[220:223], v[100:103]
    ds_read_b64_tr_b16 v[30:31], v2 offset:29184
    s_mov_b32 s20, s58
    s_waitcnt lgkmcnt(8)
    v_mfma_f32_16x16x32_bf16 v[104:107], v[40:43], v[208:211], v[104:107]
    ds_read_b64_tr_b16 v[32:33], v3 offset:16384
    v_mfma_f32_16x16x32_bf16 v[104:107], v[44:47], v[216:219], v[104:107]
    ds_read_b64_tr_b16 v[34:35], v3 offset:16896
    s_mov_b32 s21, s59
    v_mfma_f32_16x16x32_bf16 v[108:111], v[40:43], v[212:215], v[108:111]
    ds_read_b64_tr_b16 v[36:37], v3 offset:20480
    s_mov_b32 s22, 5308416
    v_mfma_f32_16x16x32_bf16 v[108:111], v[44:47], v[220:223], v[108:111]
    ds_read_b64_tr_b16 v[38:39], v3 offset:20992
    s_mov_b32 s23, 0x20000
    s_waitcnt vmcnt(10)
    s_waitcnt lgkmcnt(8)
    v_mfma_f32_16x16x32_bf16 v[48:51], v[16:19], v[224:227], v[48:51]
    ds_read_b64_tr_b16 v[40:41], v3 offset:24576
    v_mfma_f32_16x16x32_bf16 v[48:51], v[20:23], v[232:235], v[48:51]
    ds_read_b64_tr_b16 v[42:43], v3 offset:25088
    v_mfma_f32_16x16x32_bf16 v[52:55], v[16:19], v[228:231], v[52:55]
    ds_read_b64_tr_b16 v[44:45], v3 offset:28672
    v_mfma_f32_16x16x32_bf16 v[52:55], v[20:23], v[236:239], v[52:55]
    ds_read_b64_tr_b16 v[46:47], v3 offset:29184
    s_waitcnt vmcnt(8)
    s_mov_b32 m0, s46
    v_add_u32 v7, 1, v7
    ds_write_addtid_b32 v7
    s_setprio 0
    s_waitcnt lgkmcnt(9)
    v_mfma_f32_16x16x32_bf16 v[56:59], v[24:27], v[224:227], v[56:59]
    ds_read_b64_tr_b16 v[16:17], v4 offset:16384
    v_mfma_f32_16x16x32_bf16 v[56:59], v[28:31], v[232:235], v[56:59]
    ds_read_b64_tr_b16 v[18:19], v4 offset:16896
    v_mfma_f32_16x16x32_bf16 v[60:63], v[24:27], v[228:231], v[60:63]
    ds_read_b64_tr_b16 v[20:21], v4 offset:20480
    v_mfma_f32_16x16x32_bf16 v[60:63], v[28:31], v[236:239], v[60:63]
    ds_read_b64_tr_b16 v[22:23], v4 offset:20992
    s_waitcnt lgkmcnt(9)
    v_mfma_f32_16x16x32_bf16 v[64:67], v[32:35], v[224:227], v[64:67]
    ds_read_b64_tr_b16 v[24:25], v4 offset:24576
    v_mfma_f32_16x16x32_bf16 v[64:67], v[36:39], v[232:235], v[64:67]
    ds_read_b64_tr_b16 v[26:27], v4 offset:25088
    v_mfma_f32_16x16x32_bf16 v[68:71], v[32:35], v[228:231], v[68:71]
    ds_read_b64_tr_b16 v[28:29], v4 offset:28672
    v_mfma_f32_16x16x32_bf16 v[68:71], v[36:39], v[236:239], v[68:71]
    ds_read_b64_tr_b16 v[30:31], v4 offset:29184
    ds_read_b32 v8, v9
    s_waitcnt lgkmcnt(10)
    v_mfma_f32_16x16x32_bf16 v[72:75], v[40:43], v[224:227], v[72:75]
    ds_read_b64_tr_b16 v[32:33], v5 offset:16384
    v_mfma_f32_16x16x32_bf16 v[72:75], v[44:47], v[232:235], v[72:75]
    ds_read_b64_tr_b16 v[34:35], v5 offset:16896
    s_add_u32 m0, s35, 32768
    s_add_u32 s41, s38, 1179776
    buffer_load_dwordx4 v6, s[8:11], s41 offen lds
    v_mfma_f32_16x16x32_bf16 v[76:79], v[40:43], v[228:231], v[76:79]
    ds_read_b64_tr_b16 v[36:37], v5 offset:20480
    v_mfma_f32_16x16x32_bf16 v[76:79], v[44:47], v[236:239], v[76:79]
    ds_read_b64_tr_b16 v[38:39], v5 offset:20992
    s_add_u32 m0, s35, 40960
    s_add_u32 s41, s38, 1179776
    buffer_load_dwordx4 v6, s[12:15], s41 offen lds
    s_waitcnt lgkmcnt(9)
    v_mfma_f32_16x16x32_bf16 v[80:83], v[16:19], v[224:227], v[80:83]
    ds_read_b64_tr_b16 v[40:41], v5 offset:24576
    v_mfma_f32_16x16x32_bf16 v[80:83], v[20:23], v[232:235], v[80:83]
    ds_read_b64_tr_b16 v[42:43], v5 offset:25088
    v_mfma_f32_16x16x32_bf16 v[84:87], v[16:19], v[228:231], v[84:87]
    ds_read_b64_tr_b16 v[44:45], v5 offset:28672
    v_mfma_f32_16x16x32_bf16 v[84:87], v[20:23], v[236:239], v[84:87]
    ds_read_b64_tr_b16 v[46:47], v5 offset:29184
    s_waitcnt lgkmcnt(8)
    v_cmp_gt_i32 vcc, v7, v8
    s_cbranch_vccnz SBs_22
SBb_23:
    s_setprio 1
    v_mfma_f32_16x16x32_bf16 v[88:91], v[24:27], v[224:227], v[88:91]
    ds_read_b64_tr_b16 v[16:17], v2 offset:32768
    v_mfma_f32_16x16x32_bf16 v[88:91], v[28:31], v[232:235], v[88:91]
    ds_read_b64_tr_b16 v[18:19], v2 offset:33280
    v_mfma_f32_16x16x32_bf16 v[92:95], v[24:27], v[228:231], v[92:95]
    ds_read_b64_tr_b16 v[20:21], v2 offset:36864
    v_mfma_f32_16x16x32_bf16 v[92:95], v[28:31], v[236:239], v[92:95]
    ds_read_b64_tr_b16 v[22:23], v2 offset:37376
    s_waitcnt lgkmcnt(8)
    v_mfma_f32_16x16x32_bf16 v[96:99], v[32:35], v[224:227], v[96:99]
    ds_read_b64_tr_b16 v[24:25], v2 offset:40960
    v_mfma_f32_16x16x32_bf16 v[96:99], v[36:39], v[232:235], v[96:99]
    ds_read_b64_tr_b16 v[26:27], v2 offset:41472
    s_add_u32 m0, s35, 49152
    s_add_u32 s41, s38, 1769600
    buffer_load_dwordx4 v6, s[8:11], s41 offen lds
    v_mfma_f32_16x16x32_bf16 v[100:103], v[32:35], v[228:231], v[100:103]
    ds_read_b64_tr_b16 v[28:29], v2 offset:45056
    v_mfma_f32_16x16x32_bf16 v[100:103], v[36:39], v[236:239], v[100:103]
    ds_read_b64_tr_b16 v[30:31], v2 offset:45568
    v_subrev_u32 v2, 98304, v2
    s_add_u32 m0, s35, 57344
    s_add_u32 s41, s38, 1769600
    buffer_load_dwordx4 v6, s[12:15], s41 offen lds
    s_waitcnt lgkmcnt(8)
    v_mfma_f32_16x16x32_bf16 v[104:107], v[40:43], v[224:227], v[104:107]
    ds_read_b64_tr_b16 v[32:33], v3 offset:32768
    v_mfma_f32_16x16x32_bf16 v[104:107], v[44:47], v[232:235], v[104:107]
    ds_read_b64_tr_b16 v[34:35], v3 offset:33280
    v_mfma_f32_16x16x32_bf16 v[108:111], v[40:43], v[228:231], v[108:111]
    ds_read_b64_tr_b16 v[36:37], v3 offset:36864
    v_mfma_f32_16x16x32_bf16 v[108:111], v[44:47], v[236:239], v[108:111]
    ds_read_b64_tr_b16 v[38:39], v3 offset:37376
    s_waitcnt vmcnt(8)
    s_waitcnt lgkmcnt(8)
    v_mfma_f32_16x16x32_bf16 v[48:51], v[16:19], v[240:243], v[48:51]
    ds_read_b64_tr_b16 v[40:41], v3 offset:40960
    v_mfma_f32_16x16x32_bf16 v[48:51], v[20:23], v[248:251], v[48:51]
    ds_read_b64_tr_b16 v[42:43], v3 offset:41472
    v_mfma_f32_16x16x32_bf16 v[52:55], v[16:19], v[244:247], v[52:55]
    ds_read_b64_tr_b16 v[44:45], v3 offset:45056
    v_mfma_f32_16x16x32_bf16 v[52:55], v[20:23], v[252:255], v[52:55]
    ds_read_b64_tr_b16 v[46:47], v3 offset:45568
    v_subrev_u32 v3, 98304, v3
    s_waitcnt vmcnt(6)
    s_mov_b32 m0, s46
    v_add_u32 v7, 1, v7
    ds_write_addtid_b32 v7
    s_setprio 0
    s_waitcnt lgkmcnt(9)
    v_mfma_f32_16x16x32_bf16 v[56:59], v[24:27], v[240:243], v[56:59]
    ds_read_b64_tr_b16 v[16:17], v4 offset:32768
    v_mfma_f32_16x16x32_bf16 v[56:59], v[28:31], v[248:251], v[56:59]
    ds_read_b64_tr_b16 v[18:19], v4 offset:33280
    v_mfma_f32_16x16x32_bf16 v[60:63], v[24:27], v[244:247], v[60:63]
    ds_read_b64_tr_b16 v[20:21], v4 offset:36864
    v_mfma_f32_16x16x32_bf16 v[60:63], v[28:31], v[252:255], v[60:63]
    ds_read_b64_tr_b16 v[22:23], v4 offset:37376
    s_waitcnt lgkmcnt(9)
    v_mfma_f32_16x16x32_bf16 v[64:67], v[32:35], v[240:243], v[64:67]
    ds_read_b64_tr_b16 v[24:25], v4 offset:40960
    v_mfma_f32_16x16x32_bf16 v[64:67], v[36:39], v[248:251], v[64:67]
    ds_read_b64_tr_b16 v[26:27], v4 offset:41472
    v_mfma_f32_16x16x32_bf16 v[68:71], v[32:35], v[244:247], v[68:71]
    ds_read_b64_tr_b16 v[28:29], v4 offset:45056
    v_mfma_f32_16x16x32_bf16 v[68:71], v[36:39], v[252:255], v[68:71]
    ds_read_b64_tr_b16 v[30:31], v4 offset:45568
    v_subrev_u32 v4, 98304, v4
    ds_read_b32 v8, v9
    s_waitcnt lgkmcnt(10)
    v_mfma_f32_16x16x32_bf16 v[72:75], v[40:43], v[240:243], v[72:75]
    ds_read_b64_tr_b16 v[32:33], v5 offset:32768
    v_mfma_f32_16x16x32_bf16 v[72:75], v[44:47], v[248:251], v[72:75]
    ds_read_b64_tr_b16 v[34:35], v5 offset:33280
    s_add_u32 m0, s35, 65536
    s_add_u32 s41, s38, 2359424
    buffer_load_dwordx4 v6, s[8:11], s41 offen lds
    v_mfma_f32_16x16x32_bf16 v[76:79], v[40:43], v[244:247], v[76:79]
    ds_read_b64_tr_b16 v[36:37], v5 offset:36864
    v_mfma_f32_16x16x32_bf16 v[76:79], v[44:47], v[252:255], v[76:79]
    ds_read_b64_tr_b16 v[38:39], v5 offset:37376
    s_add_u32 m0, s35, 73728
    s_add_u32 s41, s38, 2359424
    buffer_load_dwordx4 v6, s[12:15], s41 offen lds
    s_waitcnt lgkmcnt(9)
    v_mfma_f32_16x16x32_bf16 v[80:83], v[16:19], v[240:243], v[80:83]
    ds_read_b64_tr_b16 v[40:41], v5 offset:40960
    v_mfma_f32_16x16x32_bf16 v[80:83], v[20:23], v[248:251], v[80:83]
    ds_read_b64_tr_b16 v[42:43], v5 offset:41472
    v_mfma_f32_16x16x32_bf16 v[84:87], v[16:19], v[244:247], v[84:87]
    ds_read_b64_tr_b16 v[44:45], v5 offset:45056
    v_mfma_f32_16x16x32_bf16 v[84:87], v[20:23], v[252:255], v[84:87]
    ds_read_b64_tr_b16 v[46:47], v5 offset:45568
    v_subrev_u32 v5, 98304, v5
    s_waitcnt lgkmcnt(8)
    v_cmp_gt_i32 vcc, v7, v8
    s_cbranch_vccnz SBs_24
SBb_25:
    s_setprio 1
    v_mfma_f32_16x16x32_bf16 v[88:91], v[24:27], v[240:243], v[88:91]
    ds_read_b64_tr_b16 v[16:17], v2 offset:0
    v_mul_f32 v48, v48, v56
    v_mul_f32 v49, v49, v57
    v_mfma_f32_16x16x32_bf16 v[88:91], v[28:31], v[248:251], v[88:91]
    ds_read_b64_tr_b16 v[18:19], v2 offset:512
    v_mul_f32 v50, v50, v58
    v_mul_f32 v51, v51, v59
    v_mfma_f32_16x16x32_bf16 v[92:95], v[24:27], v[244:247], v[92:95]
    ds_read_b64_tr_b16 v[20:21], v2 offset:4096
    v_mul_f32 v64, v64, v72
    v_mul_f32 v65, v65, v73
    v_mfma_f32_16x16x32_bf16 v[92:95], v[28:31], v[252:255], v[92:95]
    ds_read_b64_tr_b16 v[22:23], v2 offset:4608
    v_mul_f32 v66, v66, v74
    v_mul_f32 v67, v67, v75
    s_waitcnt lgkmcnt(8)
    v_mfma_f32_16x16x32_bf16 v[96:99], v[32:35], v[240:243], v[96:99]
    ds_read_b64_tr_b16 v[24:25], v2 offset:8192
    v_cvt_pk_bf16_f32 v56, v48, v49
    v_cvt_pk_bf16_f32 v57, v50, v51
    v_mfma_f32_16x16x32_bf16 v[96:99], v[36:39], v[248:251], v[96:99]
    ds_read_b64_tr_b16 v[26:27], v2 offset:8704
    v_cvt_pk_bf16_f32 v58, v64, v65
    v_cvt_pk_bf16_f32 v59, v66, v67
    v_mfma_f32_16x16x32_bf16 v[100:103], v[32:35], v[244:247], v[100:103]
    ds_read_b64_tr_b16 v[28:29], v2 offset:12288
    s_add_u32 s45, s39, 0
    buffer_store_dwordx4 v[56:59], v1, s[4:7], s45 offen offset:0 sc1
    v_mul_f32 v52, v52, v60
    v_mfma_f32_16x16x32_bf16 v[100:103], v[36:39], v[252:255], v[100:103]
    ds_read_b64_tr_b16 v[30:31], v2 offset:12800
    v_mul_f32 v53, v53, v61
    v_mul_f32 v54, v54, v62
    v_mul_f32 v55, v55, v63
    s_waitcnt lgkmcnt(8)
    v_mfma_f32_16x16x32_bf16 v[104:107], v[40:43], v[240:243], v[104:107]
    ds_read_b64_tr_b16 v[32:33], v3 offset:0
    v_mul_f32 v68, v68, v76
    v_mul_f32 v69, v69, v77
    v_mfma_f32_16x16x32_bf16 v[104:107], v[44:47], v[248:251], v[104:107]
    ds_read_b64_tr_b16 v[34:35], v3 offset:512
    v_mul_f32 v70, v70, v78
    v_mul_f32 v71, v71, v79
    v_mfma_f32_16x16x32_bf16 v[108:111], v[40:43], v[244:247], v[108:111]
    ds_read_b64_tr_b16 v[36:37], v3 offset:4096
    v_cvt_pk_bf16_f32 v60, v52, v53
    v_cvt_pk_bf16_f32 v61, v54, v55
    v_mfma_f32_16x16x32_bf16 v[108:111], v[44:47], v[252:255], v[108:111]
    ds_read_b64_tr_b16 v[38:39], v3 offset:4608
    v_cvt_pk_bf16_f32 v62, v68, v69
    v_cvt_pk_bf16_f32 v63, v70, v71
    s_add_u32 s45, s39, 184320
    buffer_store_dwordx4 v[60:63], v1, s[4:7], s45 offen offset:0 sc1
    s_waitcnt lgkmcnt(8)
    v_mfma_f32_16x16x32_bf16 v[48:51], v[16:19], v[112:115], 0
    ds_read_b64_tr_b16 v[40:41], v3 offset:8192
    v_mul_f32 v80, v80, v88
    v_mul_f32 v81, v81, v89
    v_mfma_f32_16x16x32_bf16 v[48:51], v[20:23], v[120:123], v[48:51]
    ds_read_b64_tr_b16 v[42:43], v3 offset:8704
    v_mul_f32 v82, v82, v90
    v_mul_f32 v83, v83, v91
    v_mfma_f32_16x16x32_bf16 v[52:55], v[16:19], v[116:119], 0
    ds_read_b64_tr_b16 v[44:45], v3 offset:12288
    v_mul_f32 v96, v96, v104
    v_mul_f32 v97, v97, v105
    v_mfma_f32_16x16x32_bf16 v[52:55], v[20:23], v[124:127], v[52:55]
    ds_read_b64_tr_b16 v[46:47], v3 offset:12800
    v_mul_f32 v98, v98, v106
    v_mul_f32 v99, v99, v107
    s_waitcnt vmcnt(8)
    s_mov_b32 m0, s46
    v_add_u32 v7, 1, v7
    ds_write_addtid_b32 v7
    s_setprio 0
    s_waitcnt lgkmcnt(9)
    v_mfma_f32_16x16x32_bf16 v[56:59], v[24:27], v[112:115], 0
    ds_read_b64_tr_b16 v[16:17], v4 offset:0
    v_cvt_pk_bf16_f32 v88, v80, v81
    v_cvt_pk_bf16_f32 v89, v82, v83
    v_mfma_f32_16x16x32_bf16 v[56:59], v[28:31], v[120:123], v[56:59]
    ds_read_b64_tr_b16 v[18:19], v4 offset:512
    v_cvt_pk_bf16_f32 v90, v96, v97
    v_cvt_pk_bf16_f32 v91, v98, v99
    v_mfma_f32_16x16x32_bf16 v[60:63], v[24:27], v[116:119], 0
    ds_read_b64_tr_b16 v[20:21], v4 offset:4096
    s_add_u32 s45, s39, 0
    buffer_store_dwordx4 v[88:91], v1, s[4:7], s45 offen offset:1024 sc1
    v_mul_f32 v84, v84, v92
    v_mfma_f32_16x16x32_bf16 v[60:63], v[28:31], v[124:127], v[60:63]
    ds_read_b64_tr_b16 v[22:23], v4 offset:4608
    v_mul_f32 v85, v85, v93
    v_mul_f32 v86, v86, v94
    v_mul_f32 v87, v87, v95
    s_waitcnt lgkmcnt(9)
    v_mfma_f32_16x16x32_bf16 v[64:67], v[32:35], v[112:115], 0
    ds_read_b64_tr_b16 v[24:25], v4 offset:8192
    v_mul_f32 v100, v100, v108
    v_mul_f32 v101, v101, v109
    v_mfma_f32_16x16x32_bf16 v[64:67], v[36:39], v[120:123], v[64:67]
    ds_read_b64_tr_b16 v[26:27], v4 offset:8704
    v_mul_f32 v102, v102, v110
    v_mul_f32 v103, v103, v111
    v_mfma_f32_16x16x32_bf16 v[68:71], v[32:35], v[116:119], 0
    ds_read_b64_tr_b16 v[28:29], v4 offset:12288
    v_cvt_pk_bf16_f32 v92, v84, v85
    v_cvt_pk_bf16_f32 v93, v86, v87
    v_mfma_f32_16x16x32_bf16 v[68:71], v[36:39], v[124:127], v[68:71]
    ds_read_b64_tr_b16 v[30:31], v4 offset:12800
    v_cvt_pk_bf16_f32 v94, v100, v101
    v_cvt_pk_bf16_f32 v95, v102, v103
    s_add_u32 s45, s39, 184320
    buffer_store_dwordx4 v[92:95], v1, s[4:7], s45 offen offset:1024 sc1
    ds_read_b32 v8, v9
    s_waitcnt lgkmcnt(10)
    v_mfma_f32_16x16x32_bf16 v[72:75], v[40:43], v[112:115], 0
    ds_read_b64_tr_b16 v[32:33], v5 offset:0
    v_mfma_f32_16x16x32_bf16 v[72:75], v[44:47], v[120:123], v[72:75]
    ds_read_b64_tr_b16 v[34:35], v5 offset:512
    s_add_u32 m0, s35, 81920
    s_add_u32 s41, s38, 2949248
    buffer_load_dwordx4 v6, s[8:11], s41 offen lds
    v_mfma_f32_16x16x32_bf16 v[76:79], v[40:43], v[116:119], 0
    ds_read_b64_tr_b16 v[36:37], v5 offset:4096
    v_mfma_f32_16x16x32_bf16 v[76:79], v[44:47], v[124:127], v[76:79]
    ds_read_b64_tr_b16 v[38:39], v5 offset:4608
    s_add_u32 m0, s35, 90112
    s_add_u32 s41, s38, 2949248
    buffer_load_dwordx4 v6, s[12:15], s41 offen lds
    s_waitcnt lgkmcnt(9)
    v_mfma_f32_16x16x32_bf16 v[80:83], v[16:19], v[112:115], 0
    ds_read_b64_tr_b16 v[40:41], v5 offset:8192
    v_mfma_f32_16x16x32_bf16 v[80:83], v[20:23], v[120:123], v[80:83]
    ds_read_b64_tr_b16 v[42:43], v5 offset:8704
    v_mfma_f32_16x16x32_bf16 v[84:87], v[16:19], v[116:119], 0
    ds_read_b64_tr_b16 v[44:45], v5 offset:12288
    v_mfma_f32_16x16x32_bf16 v[84:87], v[20:23], v[124:127], v[84:87]
    ds_read_b64_tr_b16 v[46:47], v5 offset:12800
    s_mov_b32 m0, 157696
    s_mov_b64 exec, 0xffff
    buffer_load_dword v14, s[20:23], s29 offen lds
    s_mov_b64 exec, -1
    s_add_u32 s29, s29, 2048
    s_waitcnt lgkmcnt(8)
    v_cmp_gt_i32 vcc, v7, v8
    s_cbranch_vccnz SBs_26
SBb_27:
    s_setprio 1
    v_mfma_f32_16x16x32_bf16 v[88:91], v[24:27], v[112:115], 0
    ds_read_b64_tr_b16 v[16:17], v2 offset:16384
    v_mfma_f32_16x16x32_bf16 v[88:91], v[28:31], v[120:123], v[88:91]
    ds_read_b64_tr_b16 v[18:19], v2 offset:16896
    v_mfma_f32_16x16x32_bf16 v[92:95], v[24:27], v[116:119], 0
    ds_read_b64_tr_b16 v[20:21], v2 offset:20480
    v_mfma_f32_16x16x32_bf16 v[92:95], v[28:31], v[124:127], v[92:95]
    ds_read_b64_tr_b16 v[22:23], v2 offset:20992
    s_waitcnt lgkmcnt(8)
    v_mfma_f32_16x16x32_bf16 v[96:99], v[32:35], v[112:115], 0
    ds_read_b64_tr_b16 v[24:25], v2 offset:24576
    v_mfma_f32_16x16x32_bf16 v[96:99], v[36:39], v[120:123], v[96:99]
    ds_read_b64_tr_b16 v[26:27], v2 offset:25088
    v_mfma_f32_16x16x32_bf16 v[100:103], v[32:35], v[116:119], 0
    ds_read_b64_tr_b16 v[28:29], v2 offset:28672
    v_mfma_f32_16x16x32_bf16 v[100:103], v[36:39], v[124:127], v[100:103]
    ds_read_b64_tr_b16 v[30:31], v2 offset:29184
    s_waitcnt lgkmcnt(8)
    v_mfma_f32_16x16x32_bf16 v[104:107], v[40:43], v[112:115], 0
    ds_read_b64_tr_b16 v[32:33], v3 offset:16384
    v_mfma_f32_16x16x32_bf16 v[104:107], v[44:47], v[120:123], v[104:107]
    ds_read_b64_tr_b16 v[34:35], v3 offset:16896
    v_mfma_f32_16x16x32_bf16 v[108:111], v[40:43], v[116:119], 0
    ds_read_b64_tr_b16 v[36:37], v3 offset:20480
    v_mfma_f32_16x16x32_bf16 v[108:111], v[44:47], v[124:127], v[108:111]
    ds_read_b64_tr_b16 v[38:39], v3 offset:20992
    s_waitcnt lgkmcnt(8)
    v_mfma_f32_16x16x32_bf16 v[48:51], v[16:19], v[128:131], v[48:51]
    ds_read_b64_tr_b16 v[40:41], v3 offset:24576
    v_mfma_f32_16x16x32_bf16 v[48:51], v[20:23], v[136:139], v[48:51]
    ds_read_b64_tr_b16 v[42:43], v3 offset:25088
    v_mfma_f32_16x16x32_bf16 v[52:55], v[16:19], v[132:135], v[52:55]
    ds_read_b64_tr_b16 v[44:45], v3 offset:28672
    v_mfma_f32_16x16x32_bf16 v[52:55], v[20:23], v[140:143], v[52:55]
    ds_read_b64_tr_b16 v[46:47], v3 offset:29184
    s_waitcnt vmcnt(11)
    s_mov_b32 m0, s46
    v_add_u32 v7, 1, v7
    ds_write_addtid_b32 v7
    s_setprio 0
    s_waitcnt lgkmcnt(9)
    v_mfma_f32_16x16x32_bf16 v[56:59], v[24:27], v[128:131], v[56:59]
    ds_read_b64_tr_b16 v[16:17], v4 offset:16384
    v_mfma_f32_16x16x32_bf16 v[56:59], v[28:31], v[136:139], v[56:59]
    ds_read_b64_tr_b16 v[18:19], v4 offset:16896
    v_mfma_f32_16x16x32_bf16 v[60:63], v[24:27], v[132:135], v[60:63]
    ds_read_b64_tr_b16 v[20:21], v4 offset:20480
    v_mfma_f32_16x16x32_bf16 v[60:63], v[28:31], v[140:143], v[60:63]
    ds_read_b64_tr_b16 v[22:23], v4 offset:20992
    s_waitcnt lgkmcnt(9)
    v_mfma_f32_16x16x32_bf16 v[64:67], v[32:35], v[128:131], v[64:67]
    ds_read_b64_tr_b16 v[24:25], v4 offset:24576
    v_mfma_f32_16x16x32_bf16 v[64:67], v[36:39], v[136:139], v[64:67]
    ds_read_b64_tr_b16 v[26:27], v4 offset:25088
    v_mfma_f32_16x16x32_bf16 v[68:71], v[32:35], v[132:135], v[68:71]
    ds_read_b64_tr_b16 v[28:29], v4 offset:28672
    v_mfma_f32_16x16x32_bf16 v[68:71], v[36:39], v[140:143], v[68:71]
    ds_read_b64_tr_b16 v[30:31], v4 offset:29184
    ds_read_b32 v8, v9
    s_waitcnt lgkmcnt(10)
    v_mfma_f32_16x16x32_bf16 v[72:75], v[40:43], v[128:131], v[72:75]
    ds_read_b64_tr_b16 v[32:33], v5 offset:16384
    v_mfma_f32_16x16x32_bf16 v[72:75], v[44:47], v[136:139], v[72:75]
    ds_read_b64_tr_b16 v[34:35], v5 offset:16896
    s_add_u32 m0, s35, 98304
    s_add_u32 s41, s38, 3539072
    buffer_load_dwordx4 v6, s[8:11], s41 offen lds
    v_mfma_f32_16x16x32_bf16 v[76:79], v[40:43], v[132:135], v[76:79]
    ds_read_b64_tr_b16 v[36:37], v5 offset:20480
    v_mfma_f32_16x16x32_bf16 v[76:79], v[44:47], v[140:143], v[76:79]
    ds_read_b64_tr_b16 v[38:39], v5 offset:20992
    s_add_u32 m0, s35, 106496
    s_add_u32 s41, s38, 3539072
    buffer_load_dwordx4 v6, s[12:15], s41 offen lds
    s_waitcnt lgkmcnt(9)
    v_mfma_f32_16x16x32_bf16 v[80:83], v[16:19], v[128:131], v[80:83]
    ds_read_b64_tr_b16 v[40:41], v5 offset:24576
    v_mfma_f32_16x16x32_bf16 v[80:83], v[20:23], v[136:139], v[80:83]
    ds_read_b64_tr_b16 v[42:43], v5 offset:25088
    v_mfma_f32_16x16x32_bf16 v[84:87], v[16:19], v[132:135], v[84:87]
    ds_read_b64_tr_b16 v[44:45], v5 offset:28672
    v_mfma_f32_16x16x32_bf16 v[84:87], v[20:23], v[140:143], v[84:87]
    ds_read_b64_tr_b16 v[46:47], v5 offset:29184
    s_waitcnt lgkmcnt(8)
    v_cmp_gt_i32 vcc, v7, v8
    s_cbranch_vccnz SBs_28
SBb_29:
    s_setprio 1
    v_mfma_f32_16x16x32_bf16 v[88:91], v[24:27], v[128:131], v[88:91]
    ds_read_b64_tr_b16 v[16:17], v2 offset:32768
    v_mfma_f32_16x16x32_bf16 v[88:91], v[28:31], v[136:139], v[88:91]
    ds_read_b64_tr_b16 v[18:19], v2 offset:33280
    v_mfma_f32_16x16x32_bf16 v[92:95], v[24:27], v[132:135], v[92:95]
    ds_read_b64_tr_b16 v[20:21], v2 offset:36864
    v_mfma_f32_16x16x32_bf16 v[92:95], v[28:31], v[140:143], v[92:95]
    ds_read_b64_tr_b16 v[22:23], v2 offset:37376
    s_waitcnt lgkmcnt(8)
    v_mfma_f32_16x16x32_bf16 v[96:99], v[32:35], v[128:131], v[96:99]
    ds_read_b64_tr_b16 v[24:25], v2 offset:40960
    v_mfma_f32_16x16x32_bf16 v[96:99], v[36:39], v[136:139], v[96:99]
    ds_read_b64_tr_b16 v[26:27], v2 offset:41472
    v_mfma_f32_16x16x32_bf16 v[100:103], v[32:35], v[132:135], v[100:103]
    ds_read_b64_tr_b16 v[28:29], v2 offset:45056
    v_mfma_f32_16x16x32_bf16 v[100:103], v[36:39], v[140:143], v[100:103]
    ds_read_b64_tr_b16 v[30:31], v2 offset:45568
    v_add_u32 v2, 49152, v2
    s_waitcnt lgkmcnt(8)
    v_mfma_f32_16x16x32_bf16 v[104:107], v[40:43], v[128:131], v[104:107]
    ds_read_b64_tr_b16 v[32:33], v3 offset:32768
    v_mfma_f32_16x16x32_bf16 v[104:107], v[44:47], v[136:139], v[104:107]
    ds_read_b64_tr_b16 v[34:35], v3 offset:33280
    v_mfma_f32_16x16x32_bf16 v[108:111], v[40:43], v[132:135], v[108:111]
    ds_read_b64_tr_b16 v[36:37], v3 offset:36864
    v_mfma_f32_16x16x32_bf16 v[108:111], v[44:47], v[140:143], v[108:111]
    ds_read_b64_tr_b16 v[38:39], v3 offset:37376
    s_waitcnt lgkmcnt(8)
    v_mfma_f32_16x16x32_bf16 v[48:51], v[16:19], v[144:147], v[48:51]
    ds_read_b64_tr_b16 v[40:41], v3 offset:40960
    v_mfma_f32_16x16x32_bf16 v[48:51], v[20:23], v[152:155], v[48:51]
    ds_read_b64_tr_b16 v[42:43], v3 offset:41472
    v_mfma_f32_16x16x32_bf16 v[52:55], v[16:19], v[148:151], v[52:55]
    ds_read_b64_tr_b16 v[44:45], v3 offset:45056
    v_mfma_f32_16x16x32_bf16 v[52:55], v[20:23], v[156:159], v[52:55]
    ds_read_b64_tr_b16 v[46:47], v3 offset:45568
    v_add_u32 v3, 49152, v3
    s_waitcnt vmcnt(11)
    s_mov_b32 m0, s46
    v_add_u32 v7, 1, v7
    ds_write_addtid_b32 v7
    s_setprio 0
    s_waitcnt lgkmcnt(9)
    v_mfma_f32_16x16x32_bf16 v[56:59], v[24:27], v[144:147], v[56:59]
    ds_read_b64_tr_b16 v[16:17], v4 offset:32768
    v_mfma_f32_16x16x32_bf16 v[56:59], v[28:31], v[152:155], v[56:59]
    ds_read_b64_tr_b16 v[18:19], v4 offset:33280
    v_mfma_f32_16x16x32_bf16 v[60:63], v[24:27], v[148:151], v[60:63]
    ds_read_b64_tr_b16 v[20:21], v4 offset:36864
    v_mfma_f32_16x16x32_bf16 v[60:63], v[28:31], v[156:159], v[60:63]
    ds_read_b64_tr_b16 v[22:23], v4 offset:37376
    s_waitcnt lgkmcnt(9)
    v_mfma_f32_16x16x32_bf16 v[64:67], v[32:35], v[144:147], v[64:67]
    ds_read_b64_tr_b16 v[24:25], v4 offset:40960
    v_mfma_f32_16x16x32_bf16 v[64:67], v[36:39], v[152:155], v[64:67]
    ds_read_b64_tr_b16 v[26:27], v4 offset:41472
    v_mfma_f32_16x16x32_bf16 v[68:71], v[32:35], v[148:151], v[68:71]
    ds_read_b64_tr_b16 v[28:29], v4 offset:45056
    v_mfma_f32_16x16x32_bf16 v[68:71], v[36:39], v[156:159], v[68:71]
    ds_read_b64_tr_b16 v[30:31], v4 offset:45568
    v_add_u32 v4, 49152, v4
    ds_read_b32 v8, v9
    s_waitcnt lgkmcnt(10)
    v_mfma_f32_16x16x32_bf16 v[72:75], v[40:43], v[144:147], v[72:75]
    ds_read_b64_tr_b16 v[32:33], v5 offset:32768
    v_mfma_f32_16x16x32_bf16 v[72:75], v[44:47], v[152:155], v[72:75]
    ds_read_b64_tr_b16 v[34:35], v5 offset:33280
    s_add_u32 m0, s35, 114688
    s_add_u32 s41, s38, 4128896
    buffer_load_dwordx4 v6, s[8:11], s41 offen lds
    v_mfma_f32_16x16x32_bf16 v[76:79], v[40:43], v[148:151], v[76:79]
    ds_read_b64_tr_b16 v[36:37], v5 offset:36864
    v_mfma_f32_16x16x32_bf16 v[76:79], v[44:47], v[156:159], v[76:79]
    ds_read_b64_tr_b16 v[38:39], v5 offset:37376
    s_add_u32 m0, s35, 122880
    s_add_u32 s41, s38, 4128896
    buffer_load_dwordx4 v6, s[12:15], s41 offen lds
    s_waitcnt lgkmcnt(9)
    v_mfma_f32_16x16x32_bf16 v[80:83], v[16:19], v[144:147], v[80:83]
    ds_read_b64_tr_b16 v[40:41], v5 offset:40960
    v_mfma_f32_16x16x32_bf16 v[80:83], v[20:23], v[152:155], v[80:83]
    ds_read_b64_tr_b16 v[42:43], v5 offset:41472
    v_mfma_f32_16x16x32_bf16 v[84:87], v[16:19], v[148:151], v[84:87]
    ds_read_b64_tr_b16 v[44:45], v5 offset:45056
    v_mfma_f32_16x16x32_bf16 v[84:87], v[20:23], v[156:159], v[84:87]
    ds_read_b64_tr_b16 v[46:47], v5 offset:45568
    v_add_u32 v5, 49152, v5
    s_mov_b32 m0, 157696
    s_mov_b64 exec, 0xffff
    buffer_load_dword v14, s[20:23], s29 offen lds
    s_mov_b64 exec, -1
    s_add_u32 s29, s29, 2048
    s_waitcnt lgkmcnt(8)
    v_cmp_gt_i32 vcc, v7, v8
    s_cbranch_vccnz SBs_30
SBb_31:
    s_setprio 1
    v_mfma_f32_16x16x32_bf16 v[88:91], v[24:27], v[144:147], v[88:91]
    ds_read_b64_tr_b16 v[16:17], v2 offset:0
    v_mfma_f32_16x16x32_bf16 v[88:91], v[28:31], v[152:155], v[88:91]
    ds_read_b64_tr_b16 v[18:19], v2 offset:512
    v_mfma_f32_16x16x32_bf16 v[92:95], v[24:27], v[148:151], v[92:95]
    ds_read_b64_tr_b16 v[20:21], v2 offset:4096
    v_mfma_f32_16x16x32_bf16 v[92:95], v[28:31], v[156:159], v[92:95]
    ds_read_b64_tr_b16 v[22:23], v2 offset:4608
    s_waitcnt lgkmcnt(8)
    v_mfma_f32_16x16x32_bf16 v[96:99], v[32:35], v[144:147], v[96:99]
    ds_read_b64_tr_b16 v[24:25], v2 offset:8192
    v_mfma_f32_16x16x32_bf16 v[96:99], v[36:39], v[152:155], v[96:99]
    ds_read_b64_tr_b16 v[26:27], v2 offset:8704
    v_mfma_f32_16x16x32_bf16 v[100:103], v[32:35], v[148:151], v[100:103]
    ds_read_b64_tr_b16 v[28:29], v2 offset:12288
    v_mfma_f32_16x16x32_bf16 v[100:103], v[36:39], v[156:159], v[100:103]
    ds_read_b64_tr_b16 v[30:31], v2 offset:12800
    s_waitcnt lgkmcnt(8)
    v_mfma_f32_16x16x32_bf16 v[104:107], v[40:43], v[144:147], v[104:107]
    ds_read_b64_tr_b16 v[32:33], v3 offset:0
    v_mfma_f32_16x16x32_bf16 v[104:107], v[44:47], v[152:155], v[104:107]
    ds_read_b64_tr_b16 v[34:35], v3 offset:512
    v_mfma_f32_16x16x32_bf16 v[108:111], v[40:43], v[148:151], v[108:111]
    ds_read_b64_tr_b16 v[36:37], v3 offset:4096
    v_mfma_f32_16x16x32_bf16 v[108:111], v[44:47], v[156:159], v[108:111]
    ds_read_b64_tr_b16 v[38:39], v3 offset:4608
    s_waitcnt vmcnt(8)
    v_mov_b32 v15, 1
    s_mov_b64 exec, 1
    buffer_store_dword v15, v1, s[4:7], s56 offen sc1
    s_mov_b64 exec, -1
    s_waitcnt lgkmcnt(8)
    v_mfma_f32_16x16x32_bf16 v[48:51], v[16:19], v[160:163], v[48:51]
    ds_read_b64_tr_b16 v[40:41], v3 offset:8192
    v_mfma_f32_16x16x32_bf16 v[48:51], v[20:23], v[168:171], v[48:51]
    ds_read_b64_tr_b16 v[42:43], v3 offset:8704
    v_mfma_f32_16x16x32_bf16 v[52:55], v[16:19], v[164:167], v[52:55]
    ds_read_b64_tr_b16 v[44:45], v3 offset:12288
    v_mfma_f32_16x16x32_bf16 v[52:55], v[20:23], v[172:175], v[52:55]
    ds_read_b64_tr_b16 v[46:47], v3 offset:12800
    s_mov_b32 m0, s46
    v_add_u32 v7, 1, v7
    ds_write_addtid_b32 v7
    s_setprio 0
    s_waitcnt lgkmcnt(9)
    v_mfma_f32_16x16x32_bf16 v[56:59], v[24:27], v[160:163], v[56:59]
    ds_read_b64_tr_b16 v[16:17], v4 offset:0
    v_mfma_f32_16x16x32_bf16 v[56:59], v[28:31], v[168:171], v[56:59]
    ds_read_b64_tr_b16 v[18:19], v4 offset:512
    v_mfma_f32_16x16x32_bf16 v[60:63], v[24:27], v[164:167], v[60:63]
    ds_read_b64_tr_b16 v[20:21], v4 offset:4096
    v_mfma_f32_16x16x32_bf16 v[60:63], v[28:31], v[172:175], v[60:63]
    ds_read_b64_tr_b16 v[22:23], v4 offset:4608
    s_waitcnt lgkmcnt(9)
    v_mfma_f32_16x16x32_bf16 v[64:67], v[32:35], v[160:163], v[64:67]
    ds_read_b64_tr_b16 v[24:25], v4 offset:8192
    v_mfma_f32_16x16x32_bf16 v[64:67], v[36:39], v[168:171], v[64:67]
    ds_read_b64_tr_b16 v[26:27], v4 offset:8704
    v_mfma_f32_16x16x32_bf16 v[68:71], v[32:35], v[164:167], v[68:71]
    ds_read_b64_tr_b16 v[28:29], v4 offset:12288
    v_mfma_f32_16x16x32_bf16 v[68:71], v[36:39], v[172:175], v[68:71]
    ds_read_b64_tr_b16 v[30:31], v4 offset:12800
    ds_read_b32 v8, v9
    s_waitcnt lgkmcnt(10)
    v_mfma_f32_16x16x32_bf16 v[72:75], v[40:43], v[160:163], v[72:75]
    ds_read_b64_tr_b16 v[32:33], v5 offset:0
    v_mfma_f32_16x16x32_bf16 v[72:75], v[44:47], v[168:171], v[72:75]
    ds_read_b64_tr_b16 v[34:35], v5 offset:512
    s_add_u32 m0, s35, 131072
    s_add_u32 s41, s38, 4718720
    buffer_load_dwordx4 v6, s[8:11], s41 offen lds
    v_mfma_f32_16x16x32_bf16 v[76:79], v[40:43], v[164:167], v[76:79]
    ds_read_b64_tr_b16 v[36:37], v5 offset:4096
    v_mfma_f32_16x16x32_bf16 v[76:79], v[44:47], v[172:175], v[76:79]
    ds_read_b64_tr_b16 v[38:39], v5 offset:4608
    s_add_u32 m0, s35, 139264
    s_add_u32 s41, s38, 4718720
    buffer_load_dwordx4 v6, s[12:15], s41 offen lds
    s_waitcnt lgkmcnt(9)
    v_mfma_f32_16x16x32_bf16 v[80:83], v[16:19], v[160:163], v[80:83]
    ds_read_b64_tr_b16 v[40:41], v5 offset:8192
    v_mfma_f32_16x16x32_bf16 v[80:83], v[20:23], v[168:171], v[80:83]
    ds_read_b64_tr_b16 v[42:43], v5 offset:8704
    v_mfma_f32_16x16x32_bf16 v[84:87], v[16:19], v[164:167], v[84:87]
    ds_read_b64_tr_b16 v[44:45], v5 offset:12288
    v_mfma_f32_16x16x32_bf16 v[84:87], v[20:23], v[172:175], v[84:87]
    ds_read_b64_tr_b16 v[46:47], v5 offset:12800
    s_waitcnt lgkmcnt(8)
    v_cmp_gt_i32 vcc, v7, v8
    s_cbranch_vccnz SBs_32
SBb_33:
    s_setprio 1
    v_mfma_f32_16x16x32_bf16 v[88:91], v[24:27], v[160:163], v[88:91]
    ds_read_b64_tr_b16 v[16:17], v2 offset:16384
    v_mfma_f32_16x16x32_bf16 v[88:91], v[28:31], v[168:171], v[88:91]
    ds_read_b64_tr_b16 v[18:19], v2 offset:16896
    v_mfma_f32_16x16x32_bf16 v[92:95], v[24:27], v[164:167], v[92:95]
    ds_read_b64_tr_b16 v[20:21], v2 offset:20480
    v_mfma_f32_16x16x32_bf16 v[92:95], v[28:31], v[172:175], v[92:95]
    ds_read_b64_tr_b16 v[22:23], v2 offset:20992
    s_waitcnt lgkmcnt(8)
    v_mfma_f32_16x16x32_bf16 v[96:99], v[32:35], v[160:163], v[96:99]
    ds_read_b64_tr_b16 v[24:25], v2 offset:24576
    v_mfma_f32_16x16x32_bf16 v[96:99], v[36:39], v[168:171], v[96:99]
    ds_read_b64_tr_b16 v[26:27], v2 offset:25088
    v_mfma_f32_16x16x32_bf16 v[100:103], v[32:35], v[164:167], v[100:103]
    ds_read_b64_tr_b16 v[28:29], v2 offset:28672
    v_mfma_f32_16x16x32_bf16 v[100:103], v[36:39], v[172:175], v[100:103]
    ds_read_b64_tr_b16 v[30:31], v2 offset:29184
    s_waitcnt lgkmcnt(8)
    v_mfma_f32_16x16x32_bf16 v[104:107], v[40:43], v[160:163], v[104:107]
    ds_read_b64_tr_b16 v[32:33], v3 offset:16384
    v_mfma_f32_16x16x32_bf16 v[104:107], v[44:47], v[168:171], v[104:107]
    ds_read_b64_tr_b16 v[34:35], v3 offset:16896
    v_mfma_f32_16x16x32_bf16 v[108:111], v[40:43], v[164:167], v[108:111]
    ds_read_b64_tr_b16 v[36:37], v3 offset:20480
    v_mfma_f32_16x16x32_bf16 v[108:111], v[44:47], v[172:175], v[108:111]
    ds_read_b64_tr_b16 v[38:39], v3 offset:20992
    s_waitcnt lgkmcnt(8)
    v_mfma_f32_16x16x32_bf16 v[48:51], v[16:19], v[176:179], v[48:51]
    ds_read_b64_tr_b16 v[40:41], v3 offset:24576
    v_mfma_f32_16x16x32_bf16 v[48:51], v[20:23], v[184:187], v[48:51]
    ds_read_b64_tr_b16 v[42:43], v3 offset:25088
    v_mfma_f32_16x16x32_bf16 v[52:55], v[16:19], v[180:183], v[52:55]
    ds_read_b64_tr_b16 v[44:45], v3 offset:28672
    v_mfma_f32_16x16x32_bf16 v[52:55], v[20:23], v[188:191], v[52:55]
    ds_read_b64_tr_b16 v[46:47], v3 offset:29184
    s_waitcnt vmcnt(9)
    s_mov_b32 m0, s46
    v_add_u32 v7, 1, v7
    ds_write_addtid_b32 v7
    s_setprio 0
    s_waitcnt lgkmcnt(9)
    v_mfma_f32_16x16x32_bf16 v[56:59], v[24:27], v[176:179], v[56:59]
    ds_read_b64_tr_b16 v[16:17], v4 offset:16384
    v_mfma_f32_16x16x32_bf16 v[56:59], v[28:31], v[184:187], v[56:59]
    ds_read_b64_tr_b16 v[18:19], v4 offset:16896
    v_mfma_f32_16x16x32_bf16 v[60:63], v[24:27], v[180:183], v[60:63]
    ds_read_b64_tr_b16 v[20:21], v4 offset:20480
    v_mfma_f32_16x16x32_bf16 v[60:63], v[28:31], v[188:191], v[60:63]
    ds_read_b64_tr_b16 v[22:23], v4 offset:20992
    s_waitcnt lgkmcnt(9)
    v_mfma_f32_16x16x32_bf16 v[64:67], v[32:35], v[176:179], v[64:67]
    ds_read_b64_tr_b16 v[24:25], v4 offset:24576
    v_mfma_f32_16x16x32_bf16 v[64:67], v[36:39], v[184:187], v[64:67]
    ds_read_b64_tr_b16 v[26:27], v4 offset:25088
    v_mfma_f32_16x16x32_bf16 v[68:71], v[32:35], v[180:183], v[68:71]
    ds_read_b64_tr_b16 v[28:29], v4 offset:28672
    v_mfma_f32_16x16x32_bf16 v[68:71], v[36:39], v[188:191], v[68:71]
    ds_read_b64_tr_b16 v[30:31], v4 offset:29184
    ds_read_b32 v8, v9
    s_waitcnt lgkmcnt(10)
    v_mfma_f32_16x16x32_bf16 v[72:75], v[40:43], v[176:179], v[72:75]
    ds_read_b64_tr_b16 v[32:33], v5 offset:16384
    v_mfma_f32_16x16x32_bf16 v[72:75], v[44:47], v[184:187], v[72:75]
    ds_read_b64_tr_b16 v[34:35], v5 offset:16896
    s_add_u32 m0, s35, 0
    s_add_u32 s41, s38, 256
    buffer_load_dwordx4 v6, s[8:11], s41 offen lds
    v_mfma_f32_16x16x32_bf16 v[76:79], v[40:43], v[180:183], v[76:79]
    ds_read_b64_tr_b16 v[36:37], v5 offset:20480
    v_mfma_f32_16x16x32_bf16 v[76:79], v[44:47], v[188:191], v[76:79]
    ds_read_b64_tr_b16 v[38:39], v5 offset:20992
    s_add_u32 m0, s35, 8192
    s_add_u32 s41, s38, 256
    buffer_load_dwordx4 v6, s[12:15], s41 offen lds
    s_waitcnt lgkmcnt(9)
    v_mfma_f32_16x16x32_bf16 v[80:83], v[16:19], v[176:179], v[80:83]
    ds_read_b64_tr_b16 v[40:41], v5 offset:24576
    v_mfma_f32_16x16x32_bf16 v[80:83], v[20:23], v[184:187], v[80:83]
    ds_read_b64_tr_b16 v[42:43], v5 offset:25088
    v_mfma_f32_16x16x32_bf16 v[84:87], v[16:19], v[180:183], v[84:87]
    ds_read_b64_tr_b16 v[44:45], v5 offset:28672
    v_mfma_f32_16x16x32_bf16 v[84:87], v[20:23], v[188:191], v[84:87]
    ds_read_b64_tr_b16 v[46:47], v5 offset:29184
    s_mov_b32 m0, 157696
    s_mov_b64 exec, 0xffff
    buffer_load_dword v14, s[20:23], s29 offen lds
    s_mov_b64 exec, -1
    s_add_u32 s29, s29, 2048
    s_waitcnt lgkmcnt(8)
    v_cmp_gt_i32 vcc, v7, v8
    s_cbranch_vccnz SBs_34
SBb_35:
    s_setprio 1
    v_mfma_f32_16x16x32_bf16 v[88:91], v[24:27], v[176:179], v[88:91]
    ds_read_b64_tr_b16 v[16:17], v2 offset:32768
    v_mfma_f32_16x16x32_bf16 v[88:91], v[28:31], v[184:187], v[88:91]
    ds_read_b64_tr_b16 v[18:19], v2 offset:33280
    v_mfma_f32_16x16x32_bf16 v[92:95], v[24:27], v[180:183], v[92:95]
    ds_read_b64_tr_b16 v[20:21], v2 offset:36864
    v_mfma_f32_16x16x32_bf16 v[92:95], v[28:31], v[188:191], v[92:95]
    ds_read_b64_tr_b16 v[22:23], v2 offset:37376
    s_waitcnt lgkmcnt(8)
    v_mfma_f32_16x16x32_bf16 v[96:99], v[32:35], v[176:179], v[96:99]
    ds_read_b64_tr_b16 v[24:25], v2 offset:40960
    v_mfma_f32_16x16x32_bf16 v[96:99], v[36:39], v[184:187], v[96:99]
    ds_read_b64_tr_b16 v[26:27], v2 offset:41472
    v_mfma_f32_16x16x32_bf16 v[100:103], v[32:35], v[180:183], v[100:103]
    ds_read_b64_tr_b16 v[28:29], v2 offset:45056
    v_mfma_f32_16x16x32_bf16 v[100:103], v[36:39], v[188:191], v[100:103]
    ds_read_b64_tr_b16 v[30:31], v2 offset:45568
    v_add_u32 v2, 49152, v2
    s_waitcnt lgkmcnt(8)
    v_mfma_f32_16x16x32_bf16 v[104:107], v[40:43], v[176:179], v[104:107]
    ds_read_b64_tr_b16 v[32:33], v3 offset:32768
    v_mfma_f32_16x16x32_bf16 v[104:107], v[44:47], v[184:187], v[104:107]
    ds_read_b64_tr_b16 v[34:35], v3 offset:33280
    v_mfma_f32_16x16x32_bf16 v[108:111], v[40:43], v[180:183], v[108:111]
    ds_read_b64_tr_b16 v[36:37], v3 offset:36864
    v_mfma_f32_16x16x32_bf16 v[108:111], v[44:47], v[188:191], v[108:111]
    ds_read_b64_tr_b16 v[38:39], v3 offset:37376
    v_and_b32 v13, 7, v0
    v_lshlrev_b32 v13, 2, v13
    buffer_load_dword v15, v13, s[24:27], 0 offen offset:128 sc1
    s_waitcnt lgkmcnt(8)
    v_mfma_f32_16x16x32_bf16 v[48:51], v[16:19], v[192:195], v[48:51]
    ds_read_b64_tr_b16 v[40:41], v3 offset:40960
    v_mfma_f32_16x16x32_bf16 v[48:51], v[20:23], v[200:203], v[48:51]
    ds_read_b64_tr_b16 v[42:43], v3 offset:41472
    v_mfma_f32_16x16x32_bf16 v[52:55], v[16:19], v[196:199], v[52:55]
    ds_read_b64_tr_b16 v[44:45], v3 offset:45056
    v_mfma_f32_16x16x32_bf16 v[52:55], v[20:23], v[204:207], v[52:55]
    ds_read_b64_tr_b16 v[46:47], v3 offset:45568
    v_add_u32 v3, 49152, v3
    s_waitcnt vmcnt(10)
    s_mov_b32 m0, s46
    v_add_u32 v7, 1, v7
    ds_write_addtid_b32 v7
    s_setprio 0
    s_waitcnt lgkmcnt(9)
    v_mfma_f32_16x16x32_bf16 v[56:59], v[24:27], v[192:195], v[56:59]
    ds_read_b64_tr_b16 v[16:17], v4 offset:32768
    v_mfma_f32_16x16x32_bf16 v[56:59], v[28:31], v[200:203], v[56:59]
    ds_read_b64_tr_b16 v[18:19], v4 offset:33280
    v_mfma_f32_16x16x32_bf16 v[60:63], v[24:27], v[196:199], v[60:63]
    ds_read_b64_tr_b16 v[20:21], v4 offset:36864
    v_mfma_f32_16x16x32_bf16 v[60:63], v[28:31], v[204:207], v[60:63]
    ds_read_b64_tr_b16 v[22:23], v4 offset:37376
    s_waitcnt lgkmcnt(9)
    v_mfma_f32_16x16x32_bf16 v[64:67], v[32:35], v[192:195], v[64:67]
    ds_read_b64_tr_b16 v[24:25], v4 offset:40960
    v_mfma_f32_16x16x32_bf16 v[64:67], v[36:39], v[200:203], v[64:67]
    ds_read_b64_tr_b16 v[26:27], v4 offset:41472
    v_mfma_f32_16x16x32_bf16 v[68:71], v[32:35], v[196:199], v[68:71]
    ds_read_b64_tr_b16 v[28:29], v4 offset:45056
    v_mfma_f32_16x16x32_bf16 v[68:71], v[36:39], v[204:207], v[68:71]
    ds_read_b64_tr_b16 v[30:31], v4 offset:45568
    v_add_u32 v4, 49152, v4
    ds_read_b32 v8, v9
    s_waitcnt lgkmcnt(10)
    v_mfma_f32_16x16x32_bf16 v[72:75], v[40:43], v[192:195], v[72:75]
    ds_read_b64_tr_b16 v[32:33], v5 offset:32768
    v_mfma_f32_16x16x32_bf16 v[72:75], v[44:47], v[200:203], v[72:75]
    ds_read_b64_tr_b16 v[34:35], v5 offset:33280
    s_add_u32 m0, s35, 16384
    s_add_u32 s41, s38, 590080
    buffer_load_dwordx4 v6, s[8:11], s41 offen lds
    v_mfma_f32_16x16x32_bf16 v[76:79], v[40:43], v[196:199], v[76:79]
    ds_read_b64_tr_b16 v[36:37], v5 offset:36864
    v_mfma_f32_16x16x32_bf16 v[76:79], v[44:47], v[204:207], v[76:79]
    ds_read_b64_tr_b16 v[38:39], v5 offset:37376
    s_add_u32 m0, s35, 24576
    s_add_u32 s41, s38, 590080
    buffer_load_dwordx4 v6, s[12:15], s41 offen lds
    s_waitcnt lgkmcnt(9)
    v_mfma_f32_16x16x32_bf16 v[80:83], v[16:19], v[192:195], v[80:83]
    ds_read_b64_tr_b16 v[40:41], v5 offset:40960
    v_mfma_f32_16x16x32_bf16 v[80:83], v[20:23], v[200:203], v[80:83]
    ds_read_b64_tr_b16 v[42:43], v5 offset:41472
    v_mfma_f32_16x16x32_bf16 v[84:87], v[16:19], v[196:199], v[84:87]
    ds_read_b64_tr_b16 v[44:45], v5 offset:45056
    v_mfma_f32_16x16x32_bf16 v[84:87], v[20:23], v[204:207], v[84:87]
    ds_read_b64_tr_b16 v[46:47], v5 offset:45568
    v_add_u32 v5, 49152, v5
    s_waitcnt lgkmcnt(8)
    v_cmp_gt_i32 vcc, v7, v8
    s_cbranch_vccnz SBs_36
SBb_37:
    s_setprio 1
    v_mfma_f32_16x16x32_bf16 v[88:91], v[24:27], v[192:195], v[88:91]
    ds_read_b64_tr_b16 v[16:17], v2 offset:0
    v_mfma_f32_16x16x32_bf16 v[88:91], v[28:31], v[200:203], v[88:91]
    ds_read_b64_tr_b16 v[18:19], v2 offset:512
    v_mfma_f32_16x16x32_bf16 v[92:95], v[24:27], v[196:199], v[92:95]
    ds_read_b64_tr_b16 v[20:21], v2 offset:4096
    v_mfma_f32_16x16x32_bf16 v[92:95], v[28:31], v[204:207], v[92:95]
    ds_read_b64_tr_b16 v[22:23], v2 offset:4608
    s_waitcnt lgkmcnt(8)
    v_mfma_f32_16x16x32_bf16 v[96:99], v[32:35], v[192:195], v[96:99]
    ds_read_b64_tr_b16 v[24:25], v2 offset:8192
    v_mfma_f32_16x16x32_bf16 v[96:99], v[36:39], v[200:203], v[96:99]
    ds_read_b64_tr_b16 v[26:27], v2 offset:8704
    v_mfma_f32_16x16x32_bf16 v[100:103], v[32:35], v[196:199], v[100:103]
    ds_read_b64_tr_b16 v[28:29], v2 offset:12288
    v_mfma_f32_16x16x32_bf16 v[100:103], v[36:39], v[204:207], v[100:103]
    ds_read_b64_tr_b16 v[30:31], v2 offset:12800
    s_waitcnt lgkmcnt(8)
    v_mfma_f32_16x16x32_bf16 v[104:107], v[40:43], v[192:195], v[104:107]
    ds_read_b64_tr_b16 v[32:33], v3 offset:0
    v_mfma_f32_16x16x32_bf16 v[104:107], v[44:47], v[200:203], v[104:107]
    ds_read_b64_tr_b16 v[34:35], v3 offset:512
    v_mfma_f32_16x16x32_bf16 v[108:111], v[40:43], v[196:199], v[108:111]
    ds_read_b64_tr_b16 v[36:37], v3 offset:4096
    v_mfma_f32_16x16x32_bf16 v[108:111], v[44:47], v[204:207], v[108:111]
    ds_read_b64_tr_b16 v[38:39], v3 offset:4608
    s_waitcnt lgkmcnt(8)
    v_mfma_f32_16x16x32_bf16 v[48:51], v[16:19], v[208:211], v[48:51]
    ds_read_b64_tr_b16 v[40:41], v3 offset:8192
    v_mfma_f32_16x16x32_bf16 v[48:51], v[20:23], v[216:219], v[48:51]
    ds_read_b64_tr_b16 v[42:43], v3 offset:8704
    v_mfma_f32_16x16x32_bf16 v[52:55], v[16:19], v[212:215], v[52:55]
    ds_read_b64_tr_b16 v[44:45], v3 offset:12288
    v_mfma_f32_16x16x32_bf16 v[52:55], v[20:23], v[220:223], v[52:55]
    ds_read_b64_tr_b16 v[46:47], v3 offset:12800
    s_waitcnt vmcnt(10)
    s_mov_b32 m0, s46
    v_add_u32 v7, 1, v7
    ds_write_addtid_b32 v7
    s_setprio 0
    s_waitcnt lgkmcnt(9)
    v_mfma_f32_16x16x32_bf16 v[56:59], v[24:27], v[208:211], v[56:59]
    ds_read_b64_tr_b16 v[16:17], v4 offset:0
    v_mfma_f32_16x16x32_bf16 v[56:59], v[28:31], v[216:219], v[56:59]
    ds_read_b64_tr_b16 v[18:19], v4 offset:512
    v_mfma_f32_16x16x32_bf16 v[60:63], v[24:27], v[212:215], v[60:63]
    ds_read_b64_tr_b16 v[20:21], v4 offset:4096
    v_mfma_f32_16x16x32_bf16 v[60:63], v[28:31], v[220:223], v[60:63]
    ds_read_b64_tr_b16 v[22:23], v4 offset:4608
    s_waitcnt lgkmcnt(9)
    v_mfma_f32_16x16x32_bf16 v[64:67], v[32:35], v[208:211], v[64:67]
    ds_read_b64_tr_b16 v[24:25], v4 offset:8192
    v_mfma_f32_16x16x32_bf16 v[64:67], v[36:39], v[216:219], v[64:67]
    ds_read_b64_tr_b16 v[26:27], v4 offset:8704
    v_mfma_f32_16x16x32_bf16 v[68:71], v[32:35], v[212:215], v[68:71]
    ds_read_b64_tr_b16 v[28:29], v4 offset:12288
    v_mfma_f32_16x16x32_bf16 v[68:71], v[36:39], v[220:223], v[68:71]
    ds_read_b64_tr_b16 v[30:31], v4 offset:12800
    ds_read_b32 v8, v9
    s_waitcnt lgkmcnt(10)
    v_mfma_f32_16x16x32_bf16 v[72:75], v[40:43], v[208:211], v[72:75]
    ds_read_b64_tr_b16 v[32:33], v5 offset:0
    v_mfma_f32_16x16x32_bf16 v[72:75], v[44:47], v[216:219], v[72:75]
    ds_read_b64_tr_b16 v[34:35], v5 offset:512
    s_add_u32 m0, s35, 32768
    s_add_u32 s41, s38, 1179904
    buffer_load_dwordx4 v6, s[8:11], s41 offen lds
    v_mfma_f32_16x16x32_bf16 v[76:79], v[40:43], v[212:215], v[76:79]
    ds_read_b64_tr_b16 v[36:37], v5 offset:4096
    v_mfma_f32_16x16x32_bf16 v[76:79], v[44:47], v[220:223], v[76:79]
    ds_read_b64_tr_b16 v[38:39], v5 offset:4608
    s_add_u32 m0, s35, 40960
    s_add_u32 s41, s38, 1179904
    buffer_load_dwordx4 v6, s[12:15], s41 offen lds
    s_waitcnt lgkmcnt(9)
    v_mfma_f32_16x16x32_bf16 v[80:83], v[16:19], v[208:211], v[80:83]
    ds_read_b64_tr_b16 v[40:41], v5 offset:8192
    v_mfma_f32_16x16x32_bf16 v[80:83], v[20:23], v[216:219], v[80:83]
    ds_read_b64_tr_b16 v[42:43], v5 offset:8704
    v_mfma_f32_16x16x32_bf16 v[84:87], v[16:19], v[212:215], v[84:87]
    ds_read_b64_tr_b16 v[44:45], v5 offset:12288
    v_mfma_f32_16x16x32_bf16 v[84:87], v[20:23], v[220:223], v[84:87]
    ds_read_b64_tr_b16 v[46:47], v5 offset:12800
    s_mov_b32 m0, 157696
    s_mov_b64 exec, 0xffff
    buffer_load_dword v14, s[20:23], s29 offen lds
    s_mov_b64 exec, -1
    s_add_u32 s29, s29, 2048
    s_waitcnt lgkmcnt(8)
    v_cmp_gt_i32 vcc, v7, v8
    s_cbranch_vccnz SBs_38
SBb_39:
    s_setprio 1
    v_mfma_f32_16x16x32_bf16 v[88:91], v[24:27], v[208:211], v[88:91]
    ds_read_b64_tr_b16 v[16:17], v2 offset:16384
    v_mfma_f32_16x16x32_bf16 v[88:91], v[28:31], v[216:219], v[88:91]
    ds_read_b64_tr_b16 v[18:19], v2 offset:16896
    v_mfma_f32_16x16x32_bf16 v[92:95], v[24:27], v[212:215], v[92:95]
    ds_read_b64_tr_b16 v[20:21], v2 offset:20480
    v_mfma_f32_16x16x32_bf16 v[92:95], v[28:31], v[220:223], v[92:95]
    ds_read_b64_tr_b16 v[22:23], v2 offset:20992
    s_waitcnt lgkmcnt(8)
    v_mfma_f32_16x16x32_bf16 v[96:99], v[32:35], v[208:211], v[96:99]
    ds_read_b64_tr_b16 v[24:25], v2 offset:24576
    v_mfma_f32_16x16x32_bf16 v[96:99], v[36:39], v[216:219], v[96:99]
    ds_read_b64_tr_b16 v[26:27], v2 offset:25088
    v_mfma_f32_16x16x32_bf16 v[100:103], v[32:35], v[212:215], v[100:103]
    ds_read_b64_tr_b16 v[28:29], v2 offset:28672
    v_mfma_f32_16x16x32_bf16 v[100:103], v[36:39], v[220:223], v[100:103]
    ds_read_b64_tr_b16 v[30:31], v2 offset:29184
    s_waitcnt lgkmcnt(8)
    v_mfma_f32_16x16x32_bf16 v[104:107], v[40:43], v[208:211], v[104:107]
    ds_read_b64_tr_b16 v[32:33], v3 offset:16384
    v_mfma_f32_16x16x32_bf16 v[104:107], v[44:47], v[216:219], v[104:107]
    ds_read_b64_tr_b16 v[34:35], v3 offset:16896
    s_waitcnt vmcnt(5)
    v_cmp_ne_u32 vcc, 1, v15
    s_cbranch_vccnz ASs_40
ASb_41:
    v_mfma_f32_16x16x32_bf16 v[108:111], v[40:43], v[212:215], v[108:111]
    ds_read_b64_tr_b16 v[36:37], v3 offset:20480
    v_mfma_f32_16x16x32_bf16 v[108:111], v[44:47], v[220:223], v[108:111]
    ds_read_b64_tr_b16 v[38:39], v3 offset:20992
    v_min_u32 v13, 5, v0
    v_lshlrev_b32 v13, 2, v13
    s_waitcnt lgkmcnt(8)
    v_mfma_f32_16x16x32_bf16 v[48:51], v[16:19], v[224:227], v[48:51]
    ds_read_b64_tr_b16 v[40:41], v3 offset:24576
    v_mfma_f32_16x16x32_bf16 v[48:51], v[20:23], v[232:235], v[48:51]
    ds_read_b64_tr_b16 v[42:43], v3 offset:25088
    v_mfma_f32_16x16x32_bf16 v[52:55], v[16:19], v[228:231], v[52:55]
    ds_read_b64_tr_b16 v[44:45], v3 offset:28672
    v_mfma_f32_16x16x32_bf16 v[52:55], v[20:23], v[236:239], v[52:55]
    ds_read_b64_tr_b16 v[46:47], v3 offset:29184
    s_mov_b32 m0, s46
    v_add_u32 v7, 1, v7
    ds_write_addtid_b32 v7
    s_setprio 0
    s_waitcnt lgkmcnt(9)
    v_mfma_f32_16x16x32_bf16 v[56:59], v[24:27], v[224:227], v[56:59]
    ds_read_b64_tr_b16 v[16:17], v4 offset:16384
    v_mfma_f32_16x16x32_bf16 v[56:59], v[28:31], v[232:235], v[56:59]
    ds_read_b64_tr_b16 v[18:19], v4 offset:16896
    v_mfma_f32_16x16x32_bf16 v[60:63], v[24:27], v[228:231], v[60:63]
    ds_read_b64_tr_b16 v[20:21], v4 offset:20480
    v_mfma_f32_16x16x32_bf16 v[60:63], v[28:31], v[236:239], v[60:63]
    ds_read_b64_tr_b16 v[22:23], v4 offset:20992
    s_waitcnt lgkmcnt(9)
    v_mfma_f32_16x16x32_bf16 v[64:67], v[32:35], v[224:227], v[64:67]
    ds_read_b64_tr_b16 v[24:25], v4 offset:24576
    v_mfma_f32_16x16x32_bf16 v[64:67], v[36:39], v[232:235], v[64:67]
    ds_read_b64_tr_b16 v[26:27], v4 offset:25088
    v_mfma_f32_16x16x32_bf16 v[68:71], v[32:35], v[228:231], v[68:71]
    ds_read_b64_tr_b16 v[28:29], v4 offset:28672
    v_mfma_f32_16x16x32_bf16 v[68:71], v[36:39], v[236:239], v[68:71]
    ds_read_b64_tr_b16 v[30:31], v4 offset:29184
    ds_read_b32 v8, v9
    s_waitcnt lgkmcnt(10)
    v_mfma_f32_16x16x32_bf16 v[72:75], v[40:43], v[224:227], v[72:75]
    ds_read_b64_tr_b16 v[32:33], v5 offset:16384
    v_mfma_f32_16x16x32_bf16 v[72:75], v[44:47], v[232:235], v[72:75]
    ds_read_b64_tr_b16 v[34:35], v5 offset:16896
    s_add_u32 m0, s35, 49152
    s_add_u32 s41, s38, 1769728
    buffer_load_dwordx4 v6, s[8:11], s41 offen lds
    v_mfma_f32_16x16x32_bf16 v[76:79], v[40:43], v[228:231], v[76:79]
    ds_read_b64_tr_b16 v[36:37], v5 offset:20480
    v_mfma_f32_16x16x32_bf16 v[76:79], v[44:47], v[236:239], v[76:79]
    ds_read_b64_tr_b16 v[38:39], v5 offset:20992
    s_add_u32 m0, s35, 57344
    s_add_u32 s41, s38, 1769728
    buffer_load_dwordx4 v6, s[12:15], s41 offen lds
    s_waitcnt lgkmcnt(9)
    v_mfma_f32_16x16x32_bf16 v[80:83], v[16:19], v[224:227], v[80:83]
    ds_read_b64_tr_b16 v[40:41], v5 offset:24576
    v_mfma_f32_16x16x32_bf16 v[80:83], v[20:23], v[232:235], v[80:83]
    ds_read_b64_tr_b16 v[42:43], v5 offset:25088
    v_mfma_f32_16x16x32_bf16 v[84:87], v[16:19], v[228:231], v[84:87]
    ds_read_b64_tr_b16 v[44:45], v5 offset:28672
    v_mfma_f32_16x16x32_bf16 v[84:87], v[20:23], v[236:239], v[84:87]
    ds_read_b64_tr_b16 v[46:47], v5 offset:29184
    s_waitcnt lgkmcnt(8)
    v_cmp_gt_i32 vcc, v7, v8
    s_cbranch_vccnz SBs_42
SBb_43:
    s_setprio 1
    v_mfma_f32_16x16x32_bf16 v[88:91], v[24:27], v[224:227], v[88:91]
    ds_read_b64_tr_b16 v[16:17], v2 offset:32768
    v_mfma_f32_16x16x32_bf16 v[88:91], v[28:31], v[232:235], v[88:91]
    ds_read_b64_tr_b16 v[18:19], v2 offset:33280
    v_mfma_f32_16x16x32_bf16 v[92:95], v[24:27], v[228:231], v[92:95]
    ds_read_b64_tr_b16 v[20:21], v2 offset:36864
    v_mfma_f32_16x16x32_bf16 v[92:95], v[28:31], v[236:239], v[92:95]
    ds_read_b64_tr_b16 v[22:23], v2 offset:37376
    s_waitcnt lgkmcnt(8)
    v_mfma_f32_16x16x32_bf16 v[96:99], v[32:35], v[224:227], v[96:99]
    ds_read_b64_tr_b16 v[24:25], v2 offset:40960
    v_mfma_f32_16x16x32_bf16 v[96:99], v[36:39], v[232:235], v[96:99]
    ds_read_b64_tr_b16 v[26:27], v2 offset:41472
    v_mfma_f32_16x16x32_bf16 v[100:103], v[32:35], v[228:231], v[100:103]
    ds_read_b64_tr_b16 v[28:29], v2 offset:45056
    v_mfma_f32_16x16x32_bf16 v[100:103], v[36:39], v[236:239], v[100:103]
    ds_read_b64_tr_b16 v[30:31], v2 offset:45568
    v_subrev_u32 v2, 98304, v2
    s_waitcnt lgkmcnt(8)
    v_mfma_f32_16x16x32_bf16 v[104:107], v[40:43], v[224:227], v[104:107]
    ds_read_b64_tr_b16 v[32:33], v3 offset:32768
    v_mfma_f32_16x16x32_bf16 v[104:107], v[44:47], v[232:235], v[104:107]
    ds_read_b64_tr_b16 v[34:35], v3 offset:33280
    v_mfma_f32_16x16x32_bf16 v[108:111], v[40:43], v[228:231], v[108:111]
    ds_read_b64_tr_b16 v[36:37], v3 offset:36864
    v_mfma_f32_16x16x32_bf16 v[108:111], v[44:47], v[236:239], v[108:111]
    ds_read_b64_tr_b16 v[38:39], v3 offset:37376
    s_waitcnt lgkmcnt(8)
    v_mfma_f32_16x16x32_bf16 v[48:51], v[16:19], v[240:243], v[48:51]
    ds_read_b64_tr_b16 v[40:41], v3 offset:40960
    v_mfma_f32_16x16x32_bf16 v[48:51], v[20:23], v[248:251], v[48:51]
    ds_read_b64_tr_b16 v[42:43], v3 offset:41472
    v_mfma_f32_16x16x32_bf16 v[52:55], v[16:19], v[244:247], v[52:55]
    ds_read_b64_tr_b16 v[44:45], v3 offset:45056
    v_mfma_f32_16x16x32_bf16 v[52:55], v[20:23], v[252:255], v[52:55]
    ds_read_b64_tr_b16 v[46:47], v3 offset:45568
    v_subrev_u32 v3, 98304, v3
    s_mov_b32 m0, s46
    v_add_u32 v7, 1, v7
    ds_write_addtid_b32 v7
    s_setprio 0
    s_waitcnt lgkmcnt(9)
    v_mfma_f32_16x16x32_bf16 v[56:59], v[24:27], v[240:243], v[56:59]
    ds_read_b64_tr_b16 v[16:17], v4 offset:32768
    v_mfma_f32_16x16x32_bf16 v[56:59], v[28:31], v[248:251], v[56:59]
    ds_read_b64_tr_b16 v[18:19], v4 offset:33280
    v_mfma_f32_16x16x32_bf16 v[60:63], v[24:27], v[244:247], v[60:63]
    ds_read_b64_tr_b16 v[20:21], v4 offset:36864
    v_mfma_f32_16x16x32_bf16 v[60:63], v[28:31], v[252:255], v[60:63]
    ds_read_b64_tr_b16 v[22:23], v4 offset:37376
    s_waitcnt lgkmcnt(9)
    v_mfma_f32_16x16x32_bf16 v[64:67], v[32:35], v[240:243], v[64:67]
    ds_read_b64_tr_b16 v[24:25], v4 offset:40960
    v_mfma_f32_16x16x32_bf16 v[64:67], v[36:39], v[248:251], v[64:67]
    ds_read_b64_tr_b16 v[26:27], v4 offset:41472
    v_mfma_f32_16x16x32_bf16 v[68:71], v[32:35], v[244:247], v[68:71]
    ds_read_b64_tr_b16 v[28:29], v4 offset:45056
    v_mfma_f32_16x16x32_bf16 v[68:71], v[36:39], v[252:255], v[68:71]
    ds_read_b64_tr_b16 v[30:31], v4 offset:45568
    v_subrev_u32 v4, 98304, v4
    ds_read_b32 v8, v9
    s_waitcnt lgkmcnt(10)
    v_mfma_f32_16x16x32_bf16 v[72:75], v[40:43], v[240:243], v[72:75]
    ds_read_b64_tr_b16 v[32:33], v5 offset:32768
    v_mfma_f32_16x16x32_bf16 v[72:75], v[44:47], v[248:251], v[72:75]
    ds_read_b64_tr_b16 v[34:35], v5 offset:33280
    s_add_u32 m0, s35, 65536
    s_add_u32 s41, s38, 2359552
    buffer_load_dwordx4 v6, s[8:11], s41 offen lds
    v_mfma_f32_16x16x32_bf16 v[76:79], v[40:43], v[244:247], v[76:79]
    ds_read_b64_tr_b16 v[36:37], v5 offset:36864
    v_mfma_f32_16x16x32_bf16 v[76:79], v[44:47], v[252:255], v[76:79]
    ds_read_b64_tr_b16 v[38:39], v5 offset:37376
    s_add_u32 m0, s35, 73728
    s_add_u32 s41, s38, 2359552
    buffer_load_dwordx4 v6, s[12:15], s41 offen lds
    s_waitcnt lgkmcnt(9)
    v_mfma_f32_16x16x32_bf16 v[80:83], v[16:19], v[240:243], v[80:83]
    ds_read_b64_tr_b16 v[40:41], v5 offset:40960
    v_mfma_f32_16x16x32_bf16 v[80:83], v[20:23], v[248:251], v[80:83]
    ds_read_b64_tr_b16 v[42:43], v5 offset:41472
    v_mfma_f32_16x16x32_bf16 v[84:87], v[16:19], v[244:247], v[84:87]
    ds_read_b64_tr_b16 v[44:45], v5 offset:45056
    v_mfma_f32_16x16x32_bf16 v[84:87], v[20:23], v[252:255], v[84:87]
    ds_read_b64_tr_b16 v[46:47], v5 offset:45568
    v_subrev_u32 v5, 98304, v5
    s_waitcnt lgkmcnt(8)
    v_cmp_gt_i32 vcc, v7, v8
    s_cbranch_vccnz SBs_44
SBb_45:
    s_setprio 1
    v_mfma_f32_16x16x32_bf16 v[88:91], v[24:27], v[240:243], v[88:91]
    ds_read_b64_tr_b16 v[16:17], v2 offset:0
    v_mul_f32 v48, v48, v56
    v_mul_f32 v49, v49, v57
    v_mfma_f32_16x16x32_bf16 v[88:91], v[28:31], v[248:251], v[88:91]
    ds_read_b64_tr_b16 v[18:19], v2 offset:512
    v_mul_f32 v50, v50, v58
    v_mul_f32 v51, v51, v59
    v_mfma_f32_16x16x32_bf16 v[92:95], v[24:27], v[244:247], v[92:95]
    ds_read_b64_tr_b16 v[20:21], v2 offset:4096
    v_mul_f32 v64, v64, v72
    v_mul_f32 v65, v65, v73
    v_mfma_f32_16x16x32_bf16 v[92:95], v[28:31], v[252:255], v[92:95]
    ds_read_b64_tr_b16 v[22:23], v2 offset:4608
    v_mul_f32 v66, v66, v74
    v_mul_f32 v67, v67, v75
    s_waitcnt lgkmcnt(8)
    v_mfma_f32_16x16x32_bf16 v[96:99], v[32:35], v[240:243], v[96:99]
    ds_read_b64_tr_b16 v[24:25], v2 offset:8192
    v_cvt_pk_bf16_f32 v56, v48, v49
    v_cvt_pk_bf16_f32 v57, v50, v51
    v_mfma_f32_16x16x32_bf16 v[96:99], v[36:39], v[248:251], v[96:99]
    ds_read_b64_tr_b16 v[26:27], v2 offset:8704
    v_cvt_pk_bf16_f32 v58, v64, v65
    v_cvt_pk_bf16_f32 v59, v66, v67
    v_mfma_f32_16x16x32_bf16 v[100:103], v[32:35], v[244:247], v[100:103]
    ds_read_b64_tr_b16 v[28:29], v2 offset:12288
    s_add_u32 s45, s39, 2048
    buffer_store_dwordx4 v[56:59], v1, s[4:7], s45 offen offset:0 sc1
    v_mul_f32 v52, v52, v60
    v_mfma_f32_16x16x32_bf16 v[100:103], v[36:39], v[252:255], v[100:103]
    ds_read_b64_tr_b16 v[30:31], v2 offset:12800
    v_mul_f32 v53, v53, v61
    v_mul_f32 v54, v54, v62
    v_mul_f32 v55, v55, v63
    s_waitcnt lgkmcnt(8)
    v_mfma_f32_16x16x32_bf16 v[104:107], v[40:43], v[240:243], v[104:107]
    ds_read_b64_tr_b16 v[32:33], v3 offset:0
    v_mul_f32 v68, v68, v76
    v_mul_f32 v69, v69, v77
    v_mfma_f32_16x16x32_bf16 v[104:107], v[44:47], v[248:251], v[104:107]
    ds_read_b64_tr_b16 v[34:35], v3 offset:512
    v_mul_f32 v70, v70, v78
    v_mul_f32 v71, v71, v79
    v_mfma_f32_16x16x32_bf16 v[108:111], v[40:43], v[244:247], v[108:111]
    ds_read_b64_tr_b16 v[36:37], v3 offset:4096
    v_cvt_pk_bf16_f32 v60, v52, v53
    v_cvt_pk_bf16_f32 v61, v54, v55
    v_mfma_f32_16x16x32_bf16 v[108:111], v[44:47], v[252:255], v[108:111]
    ds_read_b64_tr_b16 v[38:39], v3 offset:4608
    v_cvt_pk_bf16_f32 v62, v68, v69
    v_cvt_pk_bf16_f32 v63, v70, v71
    s_add_u32 s45, s39, 186368
    buffer_store_dwordx4 v[60:63], v1, s[4:7], s45 offen offset:0 sc1
    s_waitcnt lgkmcnt(8)
    v_mfma_f32_16x16x32_bf16 v[48:51], v[16:19], v[112:115], 0
    ds_read_b64_tr_b16 v[40:41], v3 offset:8192
    v_mul_f32 v80, v80, v88
    v_mul_f32 v81, v81, v89
    v_mfma_f32_16x16x32_bf16 v[48:51], v[20:23], v[120:123], v[48:51]
    ds_read_b64_tr_b16 v[42:43], v3 offset:8704
    v_mul_f32 v82, v82, v90
    v_mul_f32 v83, v83, v91
    v_mfma_f32_16x16x32_bf16 v[52:55], v[16:19], v[116:119], 0
    ds_read_b64_tr_b16 v[44:45], v3 offset:12288
    v_mul_f32 v96, v96, v104
    v_mul_f32 v97, v97, v105
    v_mfma_f32_16x16x32_bf16 v[52:55], v[20:23], v[124:127], v[52:55]
    ds_read_b64_tr_b16 v[46:47], v3 offset:12800
    v_mul_f32 v98, v98, v106
    v_mul_f32 v99, v99, v107
    s_waitcnt vmcnt(9)
    s_mov_b32 m0, s46
    v_add_u32 v7, 1, v7
    ds_write_addtid_b32 v7
    s_setprio 0
    s_waitcnt lgkmcnt(9)
    v_mfma_f32_16x16x32_bf16 v[56:59], v[24:27], v[112:115], 0
    ds_read_b64_tr_b16 v[16:17], v4 offset:0
    v_cvt_pk_bf16_f32 v88, v80, v81
    v_cvt_pk_bf16_f32 v89, v82, v83
    v_mfma_f32_16x16x32_bf16 v[56:59], v[28:31], v[120:123], v[56:59]
    ds_read_b64_tr_b16 v[18:19], v4 offset:512
    v_cvt_pk_bf16_f32 v90, v96, v97
    v_cvt_pk_bf16_f32 v91, v98, v99
    v_mfma_f32_16x16x32_bf16 v[60:63], v[24:27], v[116:119], 0
    ds_read_b64_tr_b16 v[20:21], v4 offset:4096
    s_add_u32 s45, s39, 2048
    buffer_store_dwordx4 v[88:91], v1, s[4:7], s45 offen offset:1024 sc1
    v_mul_f32 v84, v84, v92
    v_mfma_f32_16x16x32_bf16 v[60:63], v[28:31], v[124:127], v[60:63]
    ds_read_b64_tr_b16 v[22:23], v4 offset:4608
    v_mul_f32 v85, v85, v93
    v_mul_f32 v86, v86, v94
    v_mul_f32 v87, v87, v95
    s_waitcnt lgkmcnt(9)
    v_mfma_f32_16x16x32_bf16 v[64:67], v[32:35], v[112:115], 0
    ds_read_b64_tr_b16 v[24:25], v4 offset:8192
    v_mul_f32 v100, v100, v108
    v_mul_f32 v101, v101, v109
    v_mfma_f32_16x16x32_bf16 v[64:67], v[36:39], v[120:123], v[64:67]
    ds_read_b64_tr_b16 v[26:27], v4 offset:8704
    v_mul_f32 v102, v102, v110
    v_mul_f32 v103, v103, v111
    v_mfma_f32_16x16x32_bf16 v[68:71], v[32:35], v[116:119], 0
    ds_read_b64_tr_b16 v[28:29], v4 offset:12288
    v_cvt_pk_bf16_f32 v92, v84, v85
    v_cvt_pk_bf16_f32 v93, v86, v87
    v_mfma_f32_16x16x32_bf16 v[68:71], v[36:39], v[124:127], v[68:71]
    ds_read_b64_tr_b16 v[30:31], v4 offset:12800
    v_cvt_pk_bf16_f32 v94, v100, v101
    v_cvt_pk_bf16_f32 v95, v102, v103
    s_add_u32 s45, s39, 186368
    buffer_store_dwordx4 v[92:95], v1, s[4:7], s45 offen offset:1024 sc1
    ds_read_b32 v8, v9
    s_waitcnt lgkmcnt(10)
    v_mfma_f32_16x16x32_bf16 v[72:75], v[40:43], v[112:115], 0
    ds_read_b64_tr_b16 v[32:33], v5 offset:0
    v_mfma_f32_16x16x32_bf16 v[72:75], v[44:47], v[120:123], v[72:75]
    ds_read_b64_tr_b16 v[34:35], v5 offset:512
    s_add_u32 m0, s35, 81920
    s_add_u32 s41, s38, 2949376
    buffer_load_dwordx4 v6, s[8:11], s41 offen lds
    v_mfma_f32_16x16x32_bf16 v[76:79], v[40:43], v[116:119], 0
    ds_read_b64_tr_b16 v[36:37], v5 offset:4096
    v_mfma_f32_16x16x32_bf16 v[76:79], v[44:47], v[124:127], v[76:79]
    ds_read_b64_tr_b16 v[38:39], v5 offset:4608
    s_add_u32 m0, s35, 90112
    s_add_u32 s41, s38, 2949376
    buffer_load_dwordx4 v6, s[12:15], s41 offen lds
    s_waitcnt lgkmcnt(9)
    v_mfma_f32_16x16x32_bf16 v[80:83], v[16:19], v[112:115], 0
    ds_read_b64_tr_b16 v[40:41], v5 offset:8192
    v_mfma_f32_16x16x32_bf16 v[80:83], v[20:23], v[120:123], v[80:83]
    ds_read_b64_tr_b16 v[42:43], v5 offset:8704
    v_mfma_f32_16x16x32_bf16 v[84:87], v[16:19], v[116:119], 0
    ds_read_b64_tr_b16 v[44:45], v5 offset:12288
    v_mfma_f32_16x16x32_bf16 v[84:87], v[20:23], v[124:127], v[84:87]
    ds_read_b64_tr_b16 v[46:47], v5 offset:12800
    buffer_load_dword v15, v13, s[4:7], s57 offen sc1
    s_waitcnt lgkmcnt(8)
    v_cmp_gt_i32 vcc, v7, v8
    s_cbranch_vccnz SBs_46
SBb_47:
    s_setprio 1
    v_mfma_f32_16x16x32_bf16 v[88:91], v[24:27], v[112:115], 0
    ds_read_b64_tr_b16 v[16:17], v2 offset:16384
    v_mfma_f32_16x16x32_bf16 v[88:91], v[28:31], v[120:123], v[88:91]
    ds_read_b64_tr_b16 v[18:19], v2 offset:16896
    v_mfma_f32_16x16x32_bf16 v[92:95], v[24:27], v[116:119], 0
    ds_read_b64_tr_b16 v[20:21], v2 offset:20480
    v_mfma_f32_16x16x32_bf16 v[92:95], v[28:31], v[124:127], v[92:95]
    ds_read_b64_tr_b16 v[22:23], v2 offset:20992
    s_waitcnt lgkmcnt(8)
    v_mfma_f32_16x16x32_bf16 v[96:99], v[32:35], v[112:115], 0
    ds_read_b64_tr_b16 v[24:25], v2 offset:24576
    v_mfma_f32_16x16x32_bf16 v[96:99], v[36:39], v[120:123], v[96:99]
    ds_read_b64_tr_b16 v[26:27], v2 offset:25088
    v_mfma_f32_16x16x32_bf16 v[100:103], v[32:35], v[116:119], 0
    ds_read_b64_tr_b16 v[28:29], v2 offset:28672
    v_mfma_f32_16x16x32_bf16 v[100:103], v[36:39], v[124:127], v[100:103]
    ds_read_b64_tr_b16 v[30:31], v2 offset:29184
    s_waitcnt lgkmcnt(8)
    v_mfma_f32_16x16x32_bf16 v[104:107], v[40:43], v[112:115], 0
    ds_read_b64_tr_b16 v[32:33], v3 offset:16384
    v_mfma_f32_16x16x32_bf16 v[104:107], v[44:47], v[120:123], v[104:107]
    ds_read_b64_tr_b16 v[34:35], v3 offset:16896
    v_mfma_f32_16x16x32_bf16 v[108:111], v[40:43], v[116:119], 0
    ds_read_b64_tr_b16 v[36:37], v3 offset:20480
    v_mfma_f32_16x16x32_bf16 v[108:111], v[44:47], v[124:127], v[108:111]
    ds_read_b64_tr_b16 v[38:39], v3 offset:20992
    s_waitcnt lgkmcnt(8)
    v_mfma_f32_16x16x32_bf16 v[48:51], v[16:19], v[128:131], v[48:51]
    ds_read_b64_tr_b16 v[40:41], v3 offset:24576
    v_mfma_f32_16x16x32_bf16 v[48:51], v[20:23], v[136:139], v[48:51]
    ds_read_b64_tr_b16 v[42:43], v3 offset:25088
    v_mfma_f32_16x16x32_bf16 v[52:55], v[16:19], v[132:135], v[52:55]
    ds_read_b64_tr_b16 v[44:45], v3 offset:28672
    v_mfma_f32_16x16x32_bf16 v[52:55], v[20:23], v[140:143], v[52:55]
    ds_read_b64_tr_b16 v[46:47], v3 offset:29184
    s_waitcnt vmcnt(12)
    s_mov_b32 m0, s46
    v_add_u32 v7, 1, v7
    ds_write_addtid_b32 v7
    s_setprio 0
    s_waitcnt lgkmcnt(9)
    v_mfma_f32_16x16x32_bf16 v[56:59], v[24:27], v[128:131], v[56:59]
    ds_read_b64_tr_b16 v[16:17], v4 offset:16384
    v_mfma_f32_16x16x32_bf16 v[56:59], v[28:31], v[136:139], v[56:59]
    ds_read_b64_tr_b16 v[18:19], v4 offset:16896
    v_mfma_f32_16x16x32_bf16 v[60:63], v[24:27], v[132:135], v[60:63]
    ds_read_b64_tr_b16 v[20:21], v4 offset:20480
    v_mfma_f32_16x16x32_bf16 v[60:63], v[28:31], v[140:143], v[60:63]
    ds_read_b64_tr_b16 v[22:23], v4 offset:20992
    s_waitcnt lgkmcnt(9)
    v_mfma_f32_16x16x32_bf16 v[64:67], v[32:35], v[128:131], v[64:67]
    ds_read_b64_tr_b16 v[24:25], v4 offset:24576
    v_mfma_f32_16x16x32_bf16 v[64:67], v[36:39], v[136:139], v[64:67]
    ds_read_b64_tr_b16 v[26:27], v4 offset:25088
    v_mfma_f32_16x16x32_bf16 v[68:71], v[32:35], v[132:135], v[68:71]
    ds_read_b64_tr_b16 v[28:29], v4 offset:28672
    v_mfma_f32_16x16x32_bf16 v[68:71], v[36:39], v[140:143], v[68:71]
    ds_read_b64_tr_b16 v[30:31], v4 offset:29184
    ds_read_b32 v8, v9
    s_waitcnt lgkmcnt(10)
    v_mfma_f32_16x16x32_bf16 v[72:75], v[40:43], v[128:131], v[72:75]
    ds_read_b64_tr_b16 v[32:33], v5 offset:16384
    v_mfma_f32_16x16x32_bf16 v[72:75], v[44:47], v[136:139], v[72:75]
    ds_read_b64_tr_b16 v[34:35], v5 offset:16896
    s_add_u32 m0, s35, 98304
    s_add_u32 s41, s38, 3539200
    buffer_load_dwordx4 v6, s[8:11], s41 offen lds
    v_mfma_f32_16x16x32_bf16 v[76:79], v[40:43], v[132:135], v[76:79]
    ds_read_b64_tr_b16 v[36:37], v5 offset:20480
    v_mfma_f32_16x16x32_bf16 v[76:79], v[44:47], v[140:143], v[76:79]
    ds_read_b64_tr_b16 v[38:39], v5 offset:20992
    s_add_u32 m0, s35, 106496
    s_add_u32 s41, s38, 3539200
    buffer_load_dwordx4 v6, s[12:15], s41 offen lds
    s_waitcnt lgkmcnt(9)
    v_mfma_f32_16x16x32_bf16 v[80:83], v[16:19], v[128:131], v[80:83]
    ds_read_b64_tr_b16 v[40:41], v5 offset:24576
    v_mfma_f32_16x16x32_bf16 v[80:83], v[20:23], v[136:139], v[80:83]
    ds_read_b64_tr_b16 v[42:43], v5 offset:25088
    v_mfma_f32_16x16x32_bf16 v[84:87], v[16:19], v[132:135], v[84:87]
    ds_read_b64_tr_b16 v[44:45], v5 offset:28672
    v_mfma_f32_16x16x32_bf16 v[84:87], v[20:23], v[140:143], v[84:87]
    ds_read_b64_tr_b16 v[46:47], v5 offset:29184
    s_waitcnt vmcnt(2)
    v_cmp_gt_u32 vcc, 1, v15
    s_cbranch_vccnz PLs_48
PLb_49:
    s_waitcnt lgkmcnt(8)
    v_cmp_gt_i32 vcc, v7, v8
    s_cbranch_vccnz SBs_50
SBb_51:
    s_setprio 1
    v_mfma_f32_16x16x32_bf16 v[88:91], v[24:27], v[128:131], v[88:91]
    ds_read_b64_tr_b16 v[16:17], v2 offset:32768
    v_mfma_f32_16x16x32_bf16 v[88:91], v[28:31], v[136:139], v[88:91]
    ds_read_b64_tr_b16 v[18:19], v2 offset:33280
    s_add_u32 s36, s30, 0
    buffer_load_dwordx4 v[112:115], v1, s[4:7], s36 offen sc1
    v_mfma_f32_16x16x32_bf16 v[92:95], v[24:27], v[132:135], v[92:95]
    ds_read_b64_tr_b16 v[20:21], v2 offset:36864
    v_mfma_f32_16x16x32_bf16 v[92:95], v[28:31], v[140:143], v[92:95]
    ds_read_b64_tr_b16 v[22:23], v2 offset:37376
    s_add_u32 s36, s31, 0
    buffer_load_dwordx4 v[116:119], v1, s[4:7], s36 offen sc1
    s_waitcnt lgkmcnt(8)
    v_mfma_f32_16x16x32_bf16 v[96:99], v[32:35], v[128:131], v[96:99]
    ds_read_b64_tr_b16 v[24:25], v2 offset:40960
    v_mfma_f32_16x16x32_bf16 v[96:99], v[36:39], v[136:139], v[96:99]
    ds_read_b64_tr_b16 v[26:27], v2 offset:41472
    s_add_u32 s36, s30, 6144
    buffer_load_dwordx4 v[120:123], v1, s[4:7], s36 offen sc1
    v_mfma_f32_16x16x32_bf16 v[100:103], v[32:35], v[132:135], v[100:103]
    ds_read_b64_tr_b16 v[28:29], v2 offset:45056
    v_mfma_f32_16x16x32_bf16 v[100:103], v[36:39], v[140:143], v[100:103]
    ds_read_b64_tr_b16 v[30:31], v2 offset:45568
    v_add_u32 v2, 49152, v2
    s_add_u32 s36, s31, 6144
    buffer_load_dwordx4 v[124:127], v1, s[4:7], s36 offen sc1
    s_waitcnt lgkmcnt(8)
    v_mfma_f32_16x16x32_bf16 v[104:107], v[40:43], v[128:131], v[104:107]
    ds_read_b64_tr_b16 v[32:33], v3 offset:32768
    v_mfma_f32_16x16x32_bf16 v[104:107], v[44:47], v[136:139], v[104:107]
    ds_read_b64_tr_b16 v[34:35], v3 offset:33280
    v_mfma_f32_16x16x32_bf16 v[108:111], v[40:43], v[132:135], v[108:111]
    ds_read_b64_tr_b16 v[36:37], v3 offset:36864
    v_mfma_f32_16x16x32_bf16 v[108:111], v[44:47], v[140:143], v[108:111]
    ds_read_b64_tr_b16 v[38:39], v3 offset:37376
    s_waitcnt lgkmcnt(8)
    v_mfma_f32_16x16x32_bf16 v[48:51], v[16:19], v[144:147], v[48:51]
    ds_read_b64_tr_b16 v[40:41], v3 offset:40960
    v_mfma_f32_16x16x32_bf16 v[48:51], v[20:23], v[152:155], v[48:51]
    ds_read_b64_tr_b16 v[42:43], v3 offset:41472
    v_mfma_f32_16x16x32_bf16 v[52:55], v[16:19], v[148:151], v[52:55]
    ds_read_b64_tr_b16 v[44:45], v3 offset:45056
    v_mfma_f32_16x16x32_bf16 v[52:55], v[20:23], v[156:159], v[52:55]
    ds_read_b64_tr_b16 v[46:47], v3 offset:45568
    v_add_u32 v3, 49152, v3
    s_mov_b32 m0, s46
    v_add_u32 v7, 1, v7
    ds_write_addtid_b32 v7
    s_setprio 0
    s_waitcnt lgkmcnt(9)
    v_mfma_f32_16x16x32_bf16 v[56:59], v[24:27], v[144:147], v[56:59]
    ds_read_b64_tr_b16 v[16:17], v4 offset:32768
    v_mfma_f32_16x16x32_bf16 v[56:59], v[28:31], v[152:155], v[56:59]
    ds_read_b64_tr_b16 v[18:19], v4 offset:33280
    v_mfma_f32_16x16x32_bf16 v[60:63], v[24:27], v[148:151], v[60:63]
    ds_read_b64_tr_b16 v[20:21], v4 offset:36864
    v_mfma_f32_16x16x32_bf16 v[60:63], v[28:31], v[156:159], v[60:63]
    ds_read_b64_tr_b16 v[22:23], v4 offset:37376
    s_waitcnt lgkmcnt(9)
    v_mfma_f32_16x16x32_bf16 v[64:67], v[32:35], v[144:147], v[64:67]
    ds_read_b64_tr_b16 v[24:25], v4 offset:40960
    v_mfma_f32_16x16x32_bf16 v[64:67], v[36:39], v[152:155], v[64:67]
    ds_read_b64_tr_b16 v[26:27], v4 offset:41472
    v_mfma_f32_16x16x32_bf16 v[68:71], v[32:35], v[148:151], v[68:71]
    ds_read_b64_tr_b16 v[28:29], v4 offset:45056
    v_mfma_f32_16x16x32_bf16 v[68:71], v[36:39], v[156:159], v[68:71]
    ds_read_b64_tr_b16 v[30:31], v4 offset:45568
    v_add_u32 v4, 49152, v4
    ds_read_b32 v8, v9
    s_waitcnt lgkmcnt(10)
    v_mfma_f32_16x16x32_bf16 v[72:75], v[40:43], v[144:147], v[72:75]
    ds_read_b64_tr_b16 v[32:33], v5 offset:32768
    v_mfma_f32_16x16x32_bf16 v[72:75], v[44:47], v[152:155], v[72:75]
    ds_read_b64_tr_b16 v[34:35], v5 offset:33280
    s_add_u32 m0, s35, 114688
    s_add_u32 s41, s38, 4129024
    buffer_load_dwordx4 v6, s[8:11], s41 offen lds
    v_mfma_f32_16x16x32_bf16 v[76:79], v[40:43], v[148:151], v[76:79]
    ds_read_b64_tr_b16 v[36:37], v5 offset:36864
    v_mfma_f32_16x16x32_bf16 v[76:79], v[44:47], v[156:159], v[76:79]
    ds_read_b64_tr_b16 v[38:39], v5 offset:37376
    s_add_u32 m0, s35, 122880
    s_add_u32 s41, s38, 4129024
    buffer_load_dwordx4 v6, s[12:15], s41 offen lds
    s_waitcnt lgkmcnt(9)
    v_mfma_f32_16x16x32_bf16 v[80:83], v[16:19], v[144:147], v[80:83]
    ds_read_b64_tr_b16 v[40:41], v5 offset:40960
    v_mfma_f32_16x16x32_bf16 v[80:83], v[20:23], v[152:155], v[80:83]
    ds_read_b64_tr_b16 v[42:43], v5 offset:41472
    v_mfma_f32_16x16x32_bf16 v[84:87], v[16:19], v[148:151], v[84:87]
    ds_read_b64_tr_b16 v[44:45], v5 offset:45056
    v_mfma_f32_16x16x32_bf16 v[84:87], v[20:23], v[156:159], v[84:87]
    ds_read_b64_tr_b16 v[46:47], v5 offset:45568
    v_add_u32 v5, 49152, v5
    s_waitcnt lgkmcnt(8)
    v_cmp_gt_i32 vcc, v7, v8
    s_cbranch_vccnz SBs_52
SBb_53:
    s_setprio 1
    v_mfma_f32_16x16x32_bf16 v[88:91], v[24:27], v[144:147], v[88:91]
    ds_read_b64_tr_b16 v[16:17], v2 offset:0
    v_mfma_f32_16x16x32_bf16 v[88:91], v[28:31], v[152:155], v[88:91]
    ds_read_b64_tr_b16 v[18:19], v2 offset:512
    s_add_u32 s36, s30, 12288
    buffer_load_dwordx4 v[128:131], v1, s[4:7], s36 offen sc1
    v_mfma_f32_16x16x32_bf16 v[92:95], v[24:27], v[148:151], v[92:95]
    ds_read_b64_tr_b16 v[20:21], v2 offset:4096
    v_mfma_f32_16x16x32_bf16 v[92:95], v[28:31], v[156:159], v[92:95]
    ds_read_b64_tr_b16 v[22:23], v2 offset:4608
    s_add_u32 s36, s31, 12288
    buffer_load_dwordx4 v[132:135], v1, s[4:7], s36 offen sc1
    s_waitcnt lgkmcnt(8)
    v_mfma_f32_16x16x32_bf16 v[96:99], v[32:35], v[144:147], v[96:99]
    ds_read_b64_tr_b16 v[24:25], v2 offset:8192
    v_mfma_f32_16x16x32_bf16 v[96:99], v[36:39], v[152:155], v[96:99]
    ds_read_b64_tr_b16 v[26:27], v2 offset:8704
    s_add_u32 s36, s30, 18432
    buffer_load_dwordx4 v[136:139], v1, s[4:7], s36 offen sc1
    v_mfma_f32_16x16x32_bf16 v[100:103], v[32:35], v[148:151], v[100:103]
    ds_read_b64_tr_b16 v[28:29], v2 offset:12288
    v_mfma_f32_16x16x32_bf16 v[100:103], v[36:39], v[156:159], v[100:103]
    ds_read_b64_tr_b16 v[30:31], v2 offset:12800
    s_add_u32 s36, s31, 18432
    buffer_load_dwordx4 v[140:143], v1, s[4:7], s36 offen sc1
    s_waitcnt lgkmcnt(8)
    v_mfma_f32_16x16x32_bf16 v[104:107], v[40:43], v[144:147], v[104:107]
    ds_read_b64_tr_b16 v[32:33], v3 offset:0
    v_mfma_f32_16x16x32_bf16 v[104:107], v[44:47], v[152:155], v[104:107]
    ds_read_b64_tr_b16 v[34:35], v3 offset:512
    v_mfma_f32_16x16x32_bf16 v[108:111], v[40:43], v[148:151], v[108:111]
    ds_read_b64_tr_b16 v[36:37], v3 offset:4096
    v_mfma_f32_16x16x32_bf16 v[108:111], v[44:47], v[156:159], v[108:111]
    ds_read_b64_tr_b16 v[38:39], v3 offset:4608
    v_mov_b32 v15, 2
    s_mov_b64 exec, 1
    buffer_store_dword v15, v1, s[4:7], s56 offen sc1
    s_mov_b64 exec, -1
    s_waitcnt lgkmcnt(8)
    v_mfma_f32_16x16x32_bf16 v[48:51], v[16:19], v[160:163], v[48:51]
    ds_read_b64_tr_b16 v[40:41], v3 offset:8192
    v_mfma_f32_16x16x32_bf16 v[48:51], v[20:23], v[168:171], v[48:51]
    ds_read_b64_tr_b16 v[42:43], v3 offset:8704
    v_mfma_f32_16x16x32_bf16 v[52:55], v[16:19], v[164:167], v[52:55]
    ds_read_b64_tr_b16 v[44:45], v3 offset:12288
    v_mfma_f32_16x16x32_bf16 v[52:55], v[20:23], v[172:175], v[52:55]
    ds_read_b64_tr_b16 v[46:47], v3 offset:12800
    s_mov_b32 m0, s46
    v_add_u32 v7, 1, v7
    ds_write_addtid_b32 v7
    s_setprio 0
    s_waitcnt lgkmcnt(9)
    v_mfma_f32_16x16x32_bf16 v[56:59], v[24:27], v[160:163], v[56:59]
    ds_read_b64_tr_b16 v[16:17], v4 offset:0
    v_mfma_f32_16x16x32_bf16 v[56:59], v[28:31], v[168:171], v[56:59]
    ds_read_b64_tr_b16 v[18:19], v4 offset:512
    v_mfma_f32_16x16x32_bf16 v[60:63], v[24:27], v[164:167], v[60:63]
    ds_read_b64_tr_b16 v[20:21], v4 offset:4096
    v_mfma_f32_16x16x32_bf16 v[60:63], v[28:31], v[172:175], v[60:63]
    ds_read_b64_tr_b16 v[22:23], v4 offset:4608
    s_waitcnt lgkmcnt(9)
    v_mfma_f32_16x16x32_bf16 v[64:67], v[32:35], v[160:163], v[64:67]
    ds_read_b64_tr_b16 v[24:25], v4 offset:8192
    v_mfma_f32_16x16x32_bf16 v[64:67], v[36:39], v[168:171], v[64:67]
    ds_read_b64_tr_b16 v[26:27], v4 offset:8704
    v_mfma_f32_16x16x32_bf16 v[68:71], v[32:35], v[164:167], v[68:71]
    ds_read_b64_tr_b16 v[28:29], v4 offset:12288
    v_mfma_f32_16x16x32_bf16 v[68:71], v[36:39], v[172:175], v[68:71]
    ds_read_b64_tr_b16 v[30:31], v4 offset:12800
    ds_read_b32 v8, v9
    s_waitcnt lgkmcnt(10)
    v_mfma_f32_16x16x32_bf16 v[72:75], v[40:43], v[160:163], v[72:75]
    ds_read_b64_tr_b16 v[32:33], v5 offset:0
    v_mfma_f32_16x16x32_bf16 v[72:75], v[44:47], v[168:171], v[72:75]
    ds_read_b64_tr_b16 v[34:35], v5 offset:512
    s_add_u32 m0, s35, 131072
    s_add_u32 s41, s38, 4718848
    buffer_load_dwordx4 v6, s[8:11], s41 offen lds
    v_mfma_f32_16x16x32_bf16 v[76:79], v[40:43], v[164:167], v[76:79]
    ds_read_b64_tr_b16 v[36:37], v5 offset:4096
    v_mfma_f32_16x16x32_bf16 v[76:79], v[44:47], v[172:175], v[76:79]
    ds_read_b64_tr_b16 v[38:39], v5 offset:4608
    s_add_u32 m0, s35, 139264
    s_add_u32 s41, s38, 4718848
    buffer_load_dwordx4 v6, s[12:15], s41 offen lds
    s_waitcnt lgkmcnt(9)
    v_mfma_f32_16x16x32_bf16 v[80:83], v[16:19], v[160:163], v[80:83]
    ds_read_b64_tr_b16 v[40:41], v5 offset:8192
    v_mfma_f32_16x16x32_bf16 v[80:83], v[20:23], v[168:171], v[80:83]
    ds_read_b64_tr_b16 v[42:43], v5 offset:8704
    v_mfma_f32_16x16x32_bf16 v[84:87], v[16:19], v[164:167], v[84:87]
    ds_read_b64_tr_b16 v[44:45], v5 offset:12288
    v_mfma_f32_16x16x32_bf16 v[84:87], v[20:23], v[172:175], v[84:87]
    ds_read_b64_tr_b16 v[46:47], v5 offset:12800
    s_waitcnt lgkmcnt(8)
    v_cmp_gt_i32 vcc, v7, v8
    s_cbranch_vccnz SBs_54
SBb_55:
    s_setprio 1
    v_mfma_f32_16x16x32_bf16 v[88:91], v[24:27], v[160:163], v[88:91]
    ds_read_b64_tr_b16 v[16:17], v2 offset:16384
    v_mfma_f32_16x16x32_bf16 v[88:91], v[28:31], v[168:171], v[88:91]
    ds_read_b64_tr_b16 v[18:19], v2 offset:16896
    s_add_u32 s36, s30, 24576
    buffer_load_dwordx4 v[144:147], v1, s[4:7], s36 offen sc1
    v_mfma_f32_16x16x32_bf16 v[92:95], v[24:27], v[164:167], v[92:95]
    ds_read_b64_tr_b16 v[20:21], v2 offset:20480
    v_mfma_f32_16x16x32_bf16 v[92:95], v[28:31], v[172:175], v[92:95]
    ds_read_b64_tr_b16 v[22:23], v2 offset:20992
    s_add_u32 s36, s31, 24576
    buffer_load_dwordx4 v[148:151], v1, s[4:7], s36 offen sc1
    s_waitcnt lgkmcnt(8)
    v_mfma_f32_16x16x32_bf16 v[96:99], v[32:35], v[160:163], v[96:99]
    ds_read_b64_tr_b16 v[24:25], v2 offset:24576
    v_mfma_f32_16x16x32_bf16 v[96:99], v[36:39], v[168:171], v[96:99]
    ds_read_b64_tr_b16 v[26:27], v2 offset:25088
    s_add_u32 s36, s30, 30720
    buffer_load_dwordx4 v[152:155], v1, s[4:7], s36 offen sc1
    v_mfma_f32_16x16x32_bf16 v[100:103], v[32:35], v[164:167], v[100:103]
    ds_read_b64_tr_b16 v[28:29], v2 offset:28672
    v_mfma_f32_16x16x32_bf16 v[100:103], v[36:39], v[172:175], v[100:103]
    ds_read_b64_tr_b16 v[30:31], v2 offset:29184
    s_add_u32 s36, s31, 30720
    buffer_load_dwordx4 v[156:159], v1, s[4:7], s36 offen sc1
    s_waitcnt lgkmcnt(8)
    v_mfma_f32_16x16x32_bf16 v[104:107], v[40:43], v[160:163], v[104:107]
    ds_read_b64_tr_b16 v[32:33], v3 offset:16384
    v_mfma_f32_16x16x32_bf16 v[104:107], v[44:47], v[168:171], v[104:107]
    ds_read_b64_tr_b16 v[34:35], v3 offset:16896
    v_mfma_f32_16x16x32_bf16 v[108:111], v[40:43], v[164:167], v[108:111]
    ds_read_b64_tr_b16 v[36:37], v3 offset:20480
    v_mfma_f32_16x16x32_bf16 v[108:111], v[44:47], v[172:175], v[108:111]
    ds_read_b64_tr_b16 v[38:39], v3 offset:20992
    s_waitcnt lgkmcnt(8)
    v_mfma_f32_16x16x32_bf16 v[48:51], v[16:19], v[176:179], v[48:51]
    ds_read_b64_tr_b16 v[40:41], v3 offset:24576
    v_mfma_f32_16x16x32_bf16 v[48:51], v[20:23], v[184:187], v[48:51]
    ds_read_b64_tr_b16 v[42:43], v3 offset:25088
    v_mfma_f32_16x16x32_bf16 v[52:55], v[16:19], v[180:183], v[52:55]
    ds_read_b64_tr_b16 v[44:45], v3 offset:28672
    v_mfma_f32_16x16x32_bf16 v[52:55], v[20:23], v[188:191], v[52:55]
    ds_read_b64_tr_b16 v[46:47], v3 offset:29184
    v_lshrrev_b32 v6, 3, v0
    s_lshl_b32 s40, s16, 3
    v_add_u32 v6, s40, v6
    v_mul_u32_u24 v6, 1152, v6
    v_lshrrev_b32 v15, 4, v0
    v_lshlrev_b32 v15, 1, v15
    v_and_b32 v14, 7, v0
    v_xor_b32 v15, v15, v14
    v_lshl_add_u32 v6, v15, 4, v6
    s_mov_b32 m0, s46
    v_add_u32 v7, 1, v7
    ds_write_addtid_b32 v7
    s_setprio 0
    s_waitcnt lgkmcnt(9)
    v_mfma_f32_16x16x32_bf16 v[56:59], v[24:27], v[176:179], v[56:59]
    ds_read_b64_tr_b16 v[16:17], v4 offset:16384
    v_mfma_f32_16x16x32_bf16 v[56:59], v[28:31], v[184:187], v[56:59]
    ds_read_b64_tr_b16 v[18:19], v4 offset:16896
    v_mfma_f32_16x16x32_bf16 v[60:63], v[24:27], v[180:183], v[60:63]
    ds_read_b64_tr_b16 v[20:21], v4 offset:20480
    v_mfma_f32_16x16x32_bf16 v[60:63], v[28:31], v[188:191], v[60:63]
    ds_read_b64_tr_b16 v[22:23], v4 offset:20992
    s_waitcnt lgkmcnt(9)
    v_mfma_f32_16x16x32_bf16 v[64:67], v[32:35], v[176:179], v[64:67]
    ds_read_b64_tr_b16 v[24:25], v4 offset:24576
    v_mfma_f32_16x16x32_bf16 v[64:67], v[36:39], v[184:187], v[64:67]
    ds_read_b64_tr_b16 v[26:27], v4 offset:25088
    v_mfma_f32_16x16x32_bf16 v[68:71], v[32:35], v[180:183], v[68:71]
    ds_read_b64_tr_b16 v[28:29], v4 offset:28672
    v_mfma_f32_16x16x32_bf16 v[68:71], v[36:39], v[188:191], v[68:71]
    ds_read_b64_tr_b16 v[30:31], v4 offset:29184
    ds_read_b32 v8, v9
    s_waitcnt lgkmcnt(10)
    v_mfma_f32_16x16x32_bf16 v[72:75], v[40:43], v[176:179], v[72:75]
    ds_read_b64_tr_b16 v[32:33], v5 offset:16384
    v_mfma_f32_16x16x32_bf16 v[72:75], v[44:47], v[184:187], v[72:75]
    ds_read_b64_tr_b16 v[34:35], v5 offset:16896
    v_mfma_f32_16x16x32_bf16 v[76:79], v[40:43], v[180:183], v[76:79]
    ds_read_b64_tr_b16 v[36:37], v5 offset:20480
    v_mfma_f32_16x16x32_bf16 v[76:79], v[44:47], v[188:191], v[76:79]
    ds_read_b64_tr_b16 v[38:39], v5 offset:20992
    s_add_u32 m0, s35, 0
    s_add_u32 s41, s28, 0
    buffer_load_dwordx4 v6, s[20:23], s41 offen lds
    s_waitcnt lgkmcnt(9)
    v_mfma_f32_16x16x32_bf16 v[80:83], v[16:19], v[176:179], v[80:83]
    ds_read_b64_tr_b16 v[40:41], v5 offset:24576
    v_mfma_f32_16x16x32_bf16 v[80:83], v[20:23], v[184:187], v[80:83]
    ds_read_b64_tr_b16 v[42:43], v5 offset:25088
    v_mfma_f32_16x16x32_bf16 v[84:87], v[16:19], v[180:183], v[84:87]
    ds_read_b64_tr_b16 v[44:45], v5 offset:28672
    v_mfma_f32_16x16x32_bf16 v[84:87], v[20:23], v[188:191], v[84:87]
    ds_read_b64_tr_b16 v[46:47], v5 offset:29184
    s_add_u32 m0, s35, 8192
    s_add_u32 s41, s28, 128
    buffer_load_dwordx4 v6, s[20:23], s41 offen lds
    s_waitcnt lgkmcnt(8)
    v_cmp_gt_i32 vcc, v7, v8
    s_cbranch_vccnz SBs_56
SBb_57:
    s_setprio 1
    v_mfma_f32_16x16x32_bf16 v[88:91], v[24:27], v[176:179], v[88:91]
    ds_read_b64_tr_b16 v[16:17], v2 offset:32768
    v_mfma_f32_16x16x32_bf16 v[88:91], v[28:31], v[184:187], v[88:91]
    ds_read_b64_tr_b16 v[18:19], v2 offset:33280
    v_mfma_f32_16x16x32_bf16 v[92:95], v[24:27], v[180:183], v[92:95]
    ds_read_b64_tr_b16 v[20:21], v2 offset:36864
    v_mfma_f32_16x16x32_bf16 v[92:95], v[28:31], v[188:191], v[92:95]
    ds_read_b64_tr_b16 v[22:23], v2 offset:37376
    s_waitcnt lgkmcnt(8)
    v_mfma_f32_16x16x32_bf16 v[96:99], v[32:35], v[176:179], v[96:99]
    ds_read_b64_tr_b16 v[24:25], v2 offset:40960
    v_mfma_f32_16x16x32_bf16 v[96:99], v[36:39], v[184:187], v[96:99]
    ds_read_b64_tr_b16 v[26:27], v2 offset:41472
    v_mfma_f32_16x16x32_bf16 v[100:103], v[32:35], v[180:183], v[100:103]
    ds_read_b64_tr_b16 v[28:29], v2 offset:45056
    v_mfma_f32_16x16x32_bf16 v[100:103], v[36:39], v[188:191], v[100:103]
    ds_read_b64_tr_b16 v[30:31], v2 offset:45568
    v_add_u32 v2, 49152, v2
    s_waitcnt lgkmcnt(8)
    v_mfma_f32_16x16x32_bf16 v[104:107], v[40:43], v[176:179], v[104:107]
    ds_read_b64_tr_b16 v[32:33], v3 offset:32768
    v_mfma_f32_16x16x32_bf16 v[104:107], v[44:47], v[184:187], v[104:107]
    ds_read_b64_tr_b16 v[34:35], v3 offset:33280
    v_mfma_f32_16x16x32_bf16 v[108:111], v[40:43], v[180:183], v[108:111]
    ds_read_b64_tr_b16 v[36:37], v3 offset:36864
    v_mfma_f32_16x16x32_bf16 v[108:111], v[44:47], v[188:191], v[108:111]
    ds_read_b64_tr_b16 v[38:39], v3 offset:37376
    s_add_u32 m0, s35, 16384
    s_add_u32 s41, s28, 256
    buffer_load_dwordx4 v6, s[20:23], s41 offen lds
    s_waitcnt lgkmcnt(8)
    v_mfma_f32_16x16x32_bf16 v[48:51], v[16:19], v[192:195], v[48:51]
    ds_read_b64_tr_b16 v[40:41], v3 offset:40960
    v_mfma_f32_16x16x32_bf16 v[48:51], v[20:23], v[200:203], v[48:51]
    ds_read_b64_tr_b16 v[42:43], v3 offset:41472
    v_mfma_f32_16x16x32_bf16 v[52:55], v[16:19], v[196:199], v[52:55]
    ds_read_b64_tr_b16 v[44:45], v3 offset:45056
    v_mfma_f32_16x16x32_bf16 v[52:55], v[20:23], v[204:207], v[52:55]
    ds_read_b64_tr_b16 v[46:47], v3 offset:45568
    v_add_u32 v3, 49152, v3
    s_waitcnt vmcnt(20)
    s_mov_b32 m0, s46
    v_add_u32 v7, 1, v7
    ds_write_addtid_b32 v7
    s_setprio 0
    s_waitcnt lgkmcnt(9)
    v_mfma_f32_16x16x32_bf16 v[56:59], v[24:27], v[192:195], v[56:59]
    ds_read_b64_tr_b16 v[16:17], v4 offset:32768
    v_mfma_f32_16x16x32_bf16 v[56:59], v[28:31], v[200:203], v[56:59]
    ds_read_b64_tr_b16 v[18:19], v4 offset:33280
    v_mfma_f32_16x16x32_bf16 v[60:63], v[24:27], v[196:199], v[60:63]
    ds_read_b64_tr_b16 v[20:21], v4 offset:36864
    v_mfma_f32_16x16x32_bf16 v[60:63], v[28:31], v[204:207], v[60:63]
    ds_read_b64_tr_b16 v[22:23], v4 offset:37376
    s_waitcnt lgkmcnt(9)
    v_mfma_f32_16x16x32_bf16 v[64:67], v[32:35], v[192:195], v[64:67]
    ds_read_b64_tr_b16 v[24:25], v4 offset:40960
    v_mfma_f32_16x16x32_bf16 v[64:67], v[36:39], v[200:203], v[64:67]
    ds_read_b64_tr_b16 v[26:27], v4 offset:41472
    v_mfma_f32_16x16x32_bf16 v[68:71], v[32:35], v[196:199], v[68:71]
    ds_read_b64_tr_b16 v[28:29], v4 offset:45056
    v_mfma_f32_16x16x32_bf16 v[68:71], v[36:39], v[204:207], v[68:71]
    ds_read_b64_tr_b16 v[30:31], v4 offset:45568
    v_add_u32 v4, 49152, v4
    ds_read_b32 v8, v9
    s_waitcnt lgkmcnt(10)
    v_mfma_f32_16x16x32_bf16 v[72:75], v[40:43], v[192:195], v[72:75]
    ds_read_b64_tr_b16 v[32:33], v5 offset:32768
    v_mfma_f32_16x16x32_bf16 v[72:75], v[44:47], v[200:203], v[72:75]
    ds_read_b64_tr_b16 v[34:35], v5 offset:33280
    v_mfma_f32_16x16x32_bf16 v[76:79], v[40:43], v[196:199], v[76:79]
    ds_read_b64_tr_b16 v[36:37], v5 offset:36864
    v_mfma_f32_16x16x32_bf16 v[76:79], v[44:47], v[204:207], v[76:79]
    ds_read_b64_tr_b16 v[38:39], v5 offset:37376
    s_add_u32 m0, s35, 24576
    s_add_u32 s41, s28, 221184
    buffer_load_dwordx4 v6, s[20:23], s41 offen lds
    s_waitcnt lgkmcnt(9)
    v_mfma_f32_16x16x32_bf16 v[80:83], v[16:19], v[192:195], v[80:83]
    ds_read_b64_tr_b16 v[40:41], v5 offset:40960
    v_mfma_f32_16x16x32_bf16 v[80:83], v[20:23], v[200:203], v[80:83]
    ds_read_b64_tr_b16 v[42:43], v5 offset:41472
    v_mfma_f32_16x16x32_bf16 v[84:87], v[16:19], v[196:199], v[84:87]
    ds_read_b64_tr_b16 v[44:45], v5 offset:45056
    v_mfma_f32_16x16x32_bf16 v[84:87], v[20:23], v[204:207], v[84:87]
    ds_read_b64_tr_b16 v[46:47], v5 offset:45568
    v_add_u32 v5, 49152, v5
    s_add_u32 m0, s35, 147456
    s_add_u32 s41, s28, 221312
    buffer_load_dwordx4 v6, s[20:23], s41 offen lds
    s_waitcnt lgkmcnt(8)
    v_cmp_gt_i32 vcc, v7, v8
    s_cbranch_vccnz SBs_58
SBb_59:
    s_setprio 1
    v_mfma_f32_16x16x32_bf16 v[88:91], v[24:27], v[192:195], v[88:91]
    ds_read_b64_tr_b16 v[16:17], v2 offset:0
    v_mfma_f32_16x16x32_bf16 v[88:91], v[28:31], v[200:203], v[88:91]
    ds_read_b64_tr_b16 v[18:19], v2 offset:512
    v_mfma_f32_16x16x32_bf16 v[92:95], v[24:27], v[196:199], v[92:95]
    ds_read_b64_tr_b16 v[20:21], v2 offset:4096
    v_mfma_f32_16x16x32_bf16 v[92:95], v[28:31], v[204:207], v[92:95]
    ds_read_b64_tr_b16 v[22:23], v2 offset:4608
    s_waitcnt lgkmcnt(8)
    v_mfma_f32_16x16x32_bf16 v[96:99], v[32:35], v[192:195], v[96:99]
    ds_read_b64_tr_b16 v[24:25], v2 offset:8192
    v_mfma_f32_16x16x32_bf16 v[96:99], v[36:39], v[200:203], v[96:99]
    ds_read_b64_tr_b16 v[26:27], v2 offset:8704
    v_mfma_f32_16x16x32_bf16 v[100:103], v[32:35], v[196:199], v[100:103]
    ds_read_b64_tr_b16 v[28:29], v2 offset:12288
    v_mfma_f32_16x16x32_bf16 v[100:103], v[36:39], v[204:207], v[100:103]
    ds_read_b64_tr_b16 v[30:31], v2 offset:12800
    s_waitcnt lgkmcnt(8)
    v_mfma_f32_16x16x32_bf16 v[104:107], v[40:43], v[192:195], v[104:107]
    ds_read_b64_tr_b16 v[32:33], v3 offset:0
    v_mfma_f32_16x16x32_bf16 v[104:107], v[44:47], v[200:203], v[104:107]
    ds_read_b64_tr_b16 v[34:35], v3 offset:512
    v_mfma_f32_16x16x32_bf16 v[108:111], v[40:43], v[196:199], v[108:111]
    ds_read_b64_tr_b16 v[36:37], v3 offset:4096
    v_mfma_f32_16x16x32_bf16 v[108:111], v[44:47], v[204:207], v[108:111]
    ds_read_b64_tr_b16 v[38:39], v3 offset:4608
    s_add_u32 m0, s35, 32768
    s_add_u32 s41, s28, 221440
    buffer_load_dwordx4 v6, s[20:23], s41 offen lds
    s_waitcnt lgkmcnt(8)
    v_mfma_f32_16x16x32_bf16 v[48:51], v[16:19], v[208:211], v[48:51]
    ds_read_b64_tr_b16 v[40:41], v3 offset:8192
    v_mfma_f32_16x16x32_bf16 v[48:51], v[20:23], v[216:219], v[48:51]
    ds_read_b64_tr_b16 v[42:43], v3 offset:8704
    v_mfma_f32_16x16x32_bf16 v[52:55], v[16:19], v[212:215], v[52:55]
    ds_read_b64_tr_b16 v[44:45], v3 offset:12288
    v_mfma_f32_16x16x32_bf16 v[52:55], v[20:23], v[220:223], v[52:55]
    ds_read_b64_tr_b16 v[46:47], v3 offset:12800
    s_waitcnt vmcnt(17)
    s_mov_b32 m0, s46
    v_add_u32 v7, 1, v7
    ds_write_addtid_b32 v7
    s_setprio 0
    s_waitcnt lgkmcnt(9)
    v_mfma_f32_16x16x32_bf16 v[56:59], v[24:27], v[208:211], v[56:59]
    ds_read_b64_tr_b16 v[16:17], v4 offset:0
    v_mfma_f32_16x16x32_bf16 v[56:59], v[28:31], v[216:219], v[56:59]
    ds_read_b64_tr_b16 v[18:19], v4 offset:512
    v_mfma_f32_16x16x32_bf16 v[60:63], v[24:27], v[212:215], v[60:63]
    ds_read_b64_tr_b16 v[20:21], v4 offset:4096
    v_mfma_f32_16x16x32_bf16 v[60:63], v[28:31], v[220:223], v[60:63]
    ds_read_b64_tr_b16 v[22:23], v4 offset:4608
    v_lshrrev_b32 v14, 2, v0
    v_lshlrev_b32 v14, 7, v14
    v_bfe_u32 v15, v0, 3, 2
    v_lshl_add_u32 v14, v15, 5, v14
    v_and_b32 v15, 3, v0
    v_lshl_add_u32 v14, v15, 3, v14
    s_lshl_b32 s40, s42, 12
    s_add_u32 s40, s40, 2048
    v_add_u32 v14, s40, v14
    s_waitcnt lgkmcnt(9)
    v_mfma_f32_16x16x32_bf16 v[64:67], v[32:35], v[208:211], v[64:67]
    ds_read_b64_tr_b16 v[24:25], v4 offset:8192
    v_mfma_f32_16x16x32_bf16 v[64:67], v[36:39], v[216:219], v[64:67]
    ds_read_b64_tr_b16 v[26:27], v4 offset:8704
    v_mfma_f32_16x16x32_bf16 v[68:71], v[32:35], v[212:215], v[68:71]
    ds_read_b64_tr_b16 v[28:29], v4 offset:12288
    v_mfma_f32_16x16x32_bf16 v[68:71], v[36:39], v[220:223], v[68:71]
    ds_read_b64_tr_b16 v[30:31], v4 offset:12800
    ds_read_b32 v8, v9
    s_waitcnt lgkmcnt(10)
    v_mfma_f32_16x16x32_bf16 v[72:75], v[40:43], v[208:211], v[72:75]
    ds_read_b64_tr_b16 v[32:33], v5 offset:0
    v_mfma_f32_16x16x32_bf16 v[72:75], v[44:47], v[216:219], v[72:75]
    ds_read_b64_tr_b16 v[34:35], v5 offset:512
    v_mfma_f32_16x16x32_bf16 v[76:79], v[40:43], v[212:215], v[76:79]
    ds_read_b64_tr_b16 v[36:37], v5 offset:4096
    v_mfma_f32_16x16x32_bf16 v[76:79], v[44:47], v[220:223], v[76:79]
    ds_read_b64_tr_b16 v[38:39], v5 offset:4608
    s_add_u32 m0, s35, 40960
    s_add_u32 s41, s28, 442368
    buffer_load_dwordx4 v6, s[20:23], s41 offen lds
    s_waitcnt lgkmcnt(9)
    v_mfma_f32_16x16x32_bf16 v[80:83], v[16:19], v[208:211], v[80:83]
    ds_read_b64_tr_b16 v[40:41], v5 offset:8192
    v_mfma_f32_16x16x32_bf16 v[80:83], v[20:23], v[216:219], v[80:83]
    ds_read_b64_tr_b16 v[42:43], v5 offset:8704
    v_mfma_f32_16x16x32_bf16 v[84:87], v[16:19], v[212:215], v[84:87]
    ds_read_b64_tr_b16 v[44:45], v5 offset:12288
    v_mfma_f32_16x16x32_bf16 v[84:87], v[20:23], v[220:223], v[84:87]
    ds_read_b64_tr_b16 v[46:47], v5 offset:12800
    s_add_u32 m0, s35, 49152
    s_add_u32 s41, s28, 442496
    buffer_load_dwordx4 v6, s[20:23], s41 offen lds
    s_waitcnt lgkmcnt(8)
    v_cmp_gt_i32 vcc, v7, v8
    s_cbranch_vccnz SBs_60
SBb_61:
    s_setprio 1
    v_mfma_f32_16x16x32_bf16 v[88:91], v[24:27], v[208:211], v[88:91]
    ds_read_b64_tr_b16 v[16:17], v2 offset:16384
    v_mfma_f32_16x16x32_bf16 v[88:91], v[28:31], v[216:219], v[88:91]
    ds_read_b64_tr_b16 v[18:19], v2 offset:16896
    v_mfma_f32_16x16x32_bf16 v[92:95], v[24:27], v[212:215], v[92:95]
    ds_read_b64_tr_b16 v[20:21], v2 offset:20480
    v_mfma_f32_16x16x32_bf16 v[92:95], v[28:31], v[220:223], v[92:95]
    ds_read_b64_tr_b16 v[22:23], v2 offset:20992
    s_waitcnt lgkmcnt(8)
    v_mfma_f32_16x16x32_bf16 v[96:99], v[32:35], v[208:211], v[96:99]
    ds_read_b64_tr_b16 v[24:25], v2 offset:24576
    v_mfma_f32_16x16x32_bf16 v[96:99], v[36:39], v[216:219], v[96:99]
    ds_read_b64_tr_b16 v[26:27], v2 offset:25088
    v_mfma_f32_16x16x32_bf16 v[100:103], v[32:35], v[212:215], v[100:103]
    ds_read_b64_tr_b16 v[28:29], v2 offset:28672
    v_mfma_f32_16x16x32_bf16 v[100:103], v[36:39], v[220:223], v[100:103]
    ds_read_b64_tr_b16 v[30:31], v2 offset:29184
    s_waitcnt lgkmcnt(8)
    v_mfma_f32_16x16x32_bf16 v[104:107], v[40:43], v[208:211], v[104:107]
    ds_read_b64_tr_b16 v[32:33], v3 offset:16384
    v_mfma_f32_16x16x32_bf16 v[104:107], v[44:47], v[216:219], v[104:107]
    ds_read_b64_tr_b16 v[34:35], v3 offset:16896
    v_mfma_f32_16x16x32_bf16 v[108:111], v[40:43], v[212:215], v[108:111]
    ds_read_b64_tr_b16 v[36:37], v3 offset:20480
    v_mfma_f32_16x16x32_bf16 v[108:111], v[44:47], v[220:223], v[108:111]
    ds_read_b64_tr_b16 v[38:39], v3 offset:20992
    s_add_u32 m0, s35, 57344
    s_add_u32 s41, s28, 442624
    buffer_load_dwordx4 v6, s[20:23], s41 offen lds
    s_waitcnt lgkmcnt(8)
    v_mfma_f32_16x16x32_bf16 v[48:51], v[16:19], v[224:227], v[48:51]
    ds_read_b64_tr_b16 v[40:41], v3 offset:24576
    v_mfma_f32_16x16x32_bf16 v[48:51], v[20:23], v[232:235], v[48:51]
    ds_read_b64_tr_b16 v[42:43], v3 offset:25088
    v_mfma_f32_16x16x32_bf16 v[52:55], v[16:19], v[228:231], v[52:55]
    ds_read_b64_tr_b16 v[44:45], v3 offset:28672
    v_mfma_f32_16x16x32_bf16 v[52:55], v[20:23], v[236:239], v[52:55]
    ds_read_b64_tr_b16 v[46:47], v3 offset:29184
    s_waitcnt vmcnt(13)
    s_mov_b32 m0, s46
    v_add_u32 v7, 1, v7
    ds_write_addtid_b32 v7
    s_setprio 0
    s_waitcnt lgkmcnt(9)
    v_mfma_f32_16x16x32_bf16 v[56:59], v[24:27], v[224:227], v[56:59]
    ds_read_b64_tr_b16 v[16:17], v4 offset:16384
    v_mfma_f32_16x16x32_bf16 v[56:59], v[28:31], v[232:235], v[56:59]
    ds_read_b64_tr_b16 v[18:19], v4 offset:16896
    v_mfma_f32_16x16x32_bf16 v[60:63], v[24:27], v[228:231], v[60:63]
    ds_read_b64_tr_b16 v[20:21], v4 offset:20480
    v_mfma_f32_16x16x32_bf16 v[60:63], v[28:31], v[236:239], v[60:63]
    ds_read_b64_tr_b16 v[22:23], v4 offset:20992
    s_waitcnt lgkmcnt(9)
    v_mfma_f32_16x16x32_bf16 v[64:67], v[32:35], v[224:227], v[64:67]
    ds_read_b64_tr_b16 v[24:25], v4 offset:24576
    v_mfma_f32_16x16x32_bf16 v[64:67], v[36:39], v[232:235], v[64:67]
    ds_read_b64_tr_b16 v[26:27], v4 offset:25088
    v_mfma_f32_16x16x32_bf16 v[68:71], v[32:35], v[228:231], v[68:71]
    ds_read_b64_tr_b16 v[28:29], v4 offset:28672
    v_mfma_f32_16x16x32_bf16 v[68:71], v[36:39], v[236:239], v[68:71]
    ds_read_b64_tr_b16 v[30:31], v4 offset:29184
    ds_read_b32 v8, v9
    s_waitcnt lgkmcnt(10)
    v_mfma_f32_16x16x32_bf16 v[72:75], v[40:43], v[224:227], v[72:75]
    ds_read_b64_tr_b16 v[32:33], v5 offset:16384
    v_mfma_f32_16x16x32_bf16 v[72:75], v[44:47], v[232:235], v[72:75]
    ds_read_b64_tr_b16 v[34:35], v5 offset:16896
    v_mfma_f32_16x16x32_bf16 v[76:79], v[40:43], v[228:231], v[76:79]
    ds_read_b64_tr_b16 v[36:37], v5 offset:20480
    v_mfma_f32_16x16x32_bf16 v[76:79], v[44:47], v[236:239], v[76:79]
    ds_read_b64_tr_b16 v[38:39], v5 offset:20992
    s_add_u32 m0, s35, 65536
    s_add_u32 s41, s28, 663552
    buffer_load_dwordx4 v6, s[20:23], s41 offen lds
    s_waitcnt lgkmcnt(9)
    v_mfma_f32_16x16x32_bf16 v[80:83], v[16:19], v[224:227], v[80:83]
    ds_read_b64_tr_b16 v[40:41], v5 offset:24576
    v_mfma_f32_16x16x32_bf16 v[80:83], v[20:23], v[232:235], v[80:83]
    ds_read_b64_tr_b16 v[42:43], v5 offset:25088
    v_mfma_f32_16x16x32_bf16 v[84:87], v[16:19], v[228:231], v[84:87]
    ds_read_b64_tr_b16 v[44:45], v5 offset:28672
    v_mfma_f32_16x16x32_bf16 v[84:87], v[20:23], v[236:239], v[84:87]
    ds_read_b64_tr_b16 v[46:47], v5 offset:29184
    s_add_u32 m0, s35, 73728
    s_add_u32 s41, s28, 663680
    buffer_load_dwordx4 v6, s[20:23], s41 offen lds
    s_waitcnt lgkmcnt(8)
    v_cmp_gt_i32 vcc, v7, v8
    s_cbranch_vccnz SBs_62
SBb_63:
    s_setprio 1
    v_mfma_f32_16x16x32_bf16 v[88:91], v[24:27], v[224:227], v[88:91]
    ds_read_b64_tr_b16 v[16:17], v2 offset:32768
    v_mfma_f32_16x16x32_bf16 v[88:91], v[28:31], v[232:235], v[88:91]
    ds_read_b64_tr_b16 v[18:19], v2 offset:33280
    v_mfma_f32_16x16x32_bf16 v[92:95], v[24:27], v[228:231], v[92:95]
    ds_read_b64_tr_b16 v[20:21], v2 offset:36864
    v_mfma_f32_16x16x32_bf16 v[92:95], v[28:31], v[236:239], v[92:95]
    ds_read_b64_tr_b16 v[22:23], v2 offset:37376
    s_waitcnt lgkmcnt(8)
    v_mfma_f32_16x16x32_bf16 v[96:99], v[32:35], v[224:227], v[96:99]
    ds_read_b64_tr_b16 v[24:25], v2 offset:40960
    v_mfma_f32_16x16x32_bf16 v[96:99], v[36:39], v[232:235], v[96:99]
    ds_read_b64_tr_b16 v[26:27], v2 offset:41472
    v_mfma_f32_16x16x32_bf16 v[100:103], v[32:35], v[228:231], v[100:103]
    ds_read_b64_tr_b16 v[28:29], v2 offset:45056
    v_mfma_f32_16x16x32_bf16 v[100:103], v[36:39], v[236:239], v[100:103]
    ds_read_b64_tr_b16 v[30:31], v2 offset:45568
    s_waitcnt lgkmcnt(8)
    v_mfma_f32_16x16x32_bf16 v[104:107], v[40:43], v[224:227], v[104:107]
    ds_read_b64_tr_b16 v[32:33], v3 offset:32768
    v_mfma_f32_16x16x32_bf16 v[104:107], v[44:47], v[232:235], v[104:107]
    ds_read_b64_tr_b16 v[34:35], v3 offset:33280
    v_mfma_f32_16x16x32_bf16 v[108:111], v[40:43], v[228:231], v[108:111]
    ds_read_b64_tr_b16 v[36:37], v3 offset:36864
    v_mfma_f32_16x16x32_bf16 v[108:111], v[44:47], v[236:239], v[108:111]
    ds_read_b64_tr_b16 v[38:39], v3 offset:37376
    s_add_u32 m0, s35, 81920
    s_add_u32 s41, s28, 663808
    buffer_load_dwordx4 v6, s[20:23], s41 offen lds
    s_waitcnt lgkmcnt(8)
    v_mfma_f32_16x16x32_bf16 v[48:51], v[16:19], v[240:243], v[48:51]
    ds_read_b64_tr_b16 v[40:41], v3 offset:40960
    v_mfma_f32_16x16x32_bf16 v[48:51], v[20:23], v[248:251], v[48:51]
    ds_read_b64_tr_b16 v[42:43], v3 offset:41472
    v_mfma_f32_16x16x32_bf16 v[52:55], v[16:19], v[244:247], v[52:55]
    ds_read_b64_tr_b16 v[44:45], v3 offset:45056
    v_mfma_f32_16x16x32_bf16 v[52:55], v[20:23], v[252:255], v[52:55]
    ds_read_b64_tr_b16 v[46:47], v3 offset:45568
    s_waitcnt vmcnt(8)
    s_mov_b32 m0, s46
    v_add_u32 v7, 1, v7
    ds_write_addtid_b32 v7
    s_setprio 0
    s_waitcnt lgkmcnt(9)
    v_mfma_f32_16x16x32_bf16 v[56:59], v[24:27], v[240:243], v[56:59]
    ds_read_b64_tr_b16 v[16:17], v4 offset:32768
    v_mfma_f32_16x16x32_bf16 v[56:59], v[28:31], v[248:251], v[56:59]
    ds_read_b64_tr_b16 v[18:19], v4 offset:33280
    v_mfma_f32_16x16x32_bf16 v[60:63], v[24:27], v[244:247], v[60:63]
    ds_read_b64_tr_b16 v[20:21], v4 offset:36864
    v_mfma_f32_16x16x32_bf16 v[60:63], v[28:31], v[252:255], v[60:63]
    ds_read_b64_tr_b16 v[22:23], v4 offset:37376
    s_waitcnt lgkmcnt(9)
    v_mfma_f32_16x16x32_bf16 v[64:67], v[32:35], v[240:243], v[64:67]
    ds_read_b64_tr_b16 v[24:25], v4 offset:40960
    v_mfma_f32_16x16x32_bf16 v[64:67], v[36:39], v[248:251], v[64:67]
    ds_read_b64_tr_b16 v[26:27], v4 offset:41472
    v_mfma_f32_16x16x32_bf16 v[68:71], v[32:35], v[244:247], v[68:71]
    ds_read_b64_tr_b16 v[28:29], v4 offset:45056
    v_mfma_f32_16x16x32_bf16 v[68:71], v[36:39], v[252:255], v[68:71]
    ds_read_b64_tr_b16 v[30:31], v4 offset:45568
    ds_read_b32 v8, v9
    s_waitcnt lgkmcnt(10)
    v_mfma_f32_16x16x32_bf16 v[72:75], v[40:43], v[240:243], v[72:75]
    ds_read_b64_tr_b16 v[32:33], v5 offset:32768
    v_mfma_f32_16x16x32_bf16 v[72:75], v[44:47], v[248:251], v[72:75]
    ds_read_b64_tr_b16 v[34:35], v5 offset:33280
    v_mfma_f32_16x16x32_bf16 v[76:79], v[40:43], v[244:247], v[76:79]
    ds_read_b64_tr_b16 v[36:37], v5 offset:36864
    v_mfma_f32_16x16x32_bf16 v[76:79], v[44:47], v[252:255], v[76:79]
    ds_read_b64_tr_b16 v[38:39], v5 offset:37376
    s_waitcnt lgkmcnt(9)
    v_mfma_f32_16x16x32_bf16 v[80:83], v[16:19], v[240:243], v[80:83]
    ds_read_b64_tr_b16 v[40:41], v5 offset:40960
    v_mfma_f32_16x16x32_bf16 v[80:83], v[20:23], v[248:251], v[80:83]
    ds_read_b64_tr_b16 v[42:43], v5 offset:41472
    v_mfma_f32_16x16x32_bf16 v[84:87], v[16:19], v[244:247], v[84:87]
    ds_read_b64_tr_b16 v[44:45], v5 offset:45056
    v_mfma_f32_16x16x32_bf16 v[84:87], v[20:23], v[252:255], v[84:87]
    ds_read_b64_tr_b16 v[46:47], v5 offset:45568
    s_waitcnt lgkmcnt(8)
    v_cmp_gt_i32 vcc, v7, v8
    s_cbranch_vccnz SBs_64
SBb_65:
    s_setprio 1
    v_xor_b32 v2, 0, v14
    v_xor_b32 v3, 32, v14
    v_xor_b32 v4, 64, v14
    v_xor_b32 v5, 96, v14
    v_mfma_f32_16x16x32_bf16 v[88:91], v[24:27], v[240:243], v[88:91]
    ds_read_b64_tr_b16 v[16:17], v2 offset:0
    v_mul_f32 v48, v48, v56
    v_mul_f32 v49, v49, v57
    v_mfma_f32_16x16x32_bf16 v[88:91], v[28:31], v[248:251], v[88:91]
    ds_read_b64_tr_b16 v[18:19], v2 offset:2048
    v_mul_f32 v50, v50, v58
    v_mul_f32 v51, v51, v59
    v_mfma_f32_16x16x32_bf16 v[92:95], v[24:27], v[244:247], v[92:95]
    ds_read_b64_tr_b16 v[20:21], v3 offset:0
    v_mul_f32 v64, v64, v72
    v_mul_f32 v65, v65, v73
    v_mfma_f32_16x16x32_bf16 v[92:95], v[28:31], v[252:255], v[92:95]
    ds_read_b64_tr_b16 v[22:23], v3 offset:2048
    v_mul_f32 v66, v66, v74
    v_mul_f32 v67, v67, v75
    s_waitcnt lgkmcnt(8)
    v_mfma_f32_16x16x32_bf16 v[96:99], v[32:35], v[240:243], v[96:99]
    ds_read_b64_tr_b16 v[24:25], v4 offset:0
    v_cvt_pk_bf16_f32 v56, v48, v49
    v_cvt_pk_bf16_f32 v57, v50, v51
    v_mfma_f32_16x16x32_bf16 v[96:99], v[36:39], v[248:251], v[96:99]
    ds_read_b64_tr_b16 v[26:27], v4 offset:2048
    v_cvt_pk_bf16_f32 v58, v64, v65
    v_cvt_pk_bf16_f32 v59, v66, v67
    v_mfma_f32_16x16x32_bf16 v[100:103], v[32:35], v[244:247], v[100:103]
    ds_read_b64_tr_b16 v[28:29], v5 offset:0
    s_add_u32 s45, s39, 4096
    buffer_store_dwordx4 v[56:59], v1, s[4:7], s45 offen offset:0 sc1
    v_mul_f32 v52, v52, v60
    v_mfma_f32_16x16x32_bf16 v[100:103], v[36:39], v[252:255], v[100:103]
    ds_read_b64_tr_b16 v[30:31], v5 offset:2048
    v_mul_f32 v53, v53, v61
    v_mul_f32 v54, v54, v62
    v_mul_f32 v55, v55, v63
    s_waitcnt lgkmcnt(8)
    v_mfma_f32_16x16x32_bf16 v[104:107], v[40:43], v[240:243], v[104:107]
    ds_read_b64_tr_b16 v[32:33], v2 offset:8192
    v_mul_f32 v68, v68, v76
    v_mul_f32 v69, v69, v77
    v_mfma_f32_16x16x32_bf16 v[104:107], v[44:47], v[248:251], v[104:107]
    ds_read_b64_tr_b16 v[34:35], v2 offset:10240
    v_mul_f32 v70, v70, v78
    v_mul_f32 v71, v71, v79
    v_mfma_f32_16x16x32_bf16 v[108:111], v[40:43], v[244:247], v[108:111]
    ds_read_b64_tr_b16 v[36:37], v3 offset:8192
    v_cvt_pk_bf16_f32 v60, v52, v53
    v_cvt_pk_bf16_f32 v61, v54, v55
    v_mfma_f32_16x16x32_bf16 v[108:111], v[44:47], v[252:255], v[108:111]
    ds_read_b64_tr_b16 v[38:39], v3 offset:10240
    v_cvt_pk_bf16_f32 v62, v68, v69
    v_cvt_pk_bf16_f32 v63, v70, v71
    s_add_u32 s45, s39, 188416
    buffer_store_dwordx4 v[60:63], v1, s[4:7], s45 offen offset:0 sc1
    s_waitcnt vmcnt(7)
    s_mov_b32 m0, s46
    v_add_u32 v7, 1, v7
    ds_write_addtid_b32 v7
    s_setprio 0
    v_add_u32 v240, 57344, v2
    v_add_u32 v241, 57344, v3
    v_add_u32 v242, 57344, v4
    v_add_u32 v243, 57344, v5
    v_add_u32 v244, 114688, v2
    v_add_u32 v245, 114688, v3
    v_add_u32 v246, 114688, v4
    v_add_u32 v247, 114688, v5
    s_waitcnt lgkmcnt(11)
    v_mfma_f32_16x16x32_bf16 v[208:211], v[16:19], v[112:115], 0
    ds_read_b64_tr_b16 v[40:41], v4 offset:8192
    s_add_u32 m0, s35, 122880
    s_add_u32 s41, s28, 884736
    buffer_load_dwordx4 v6, s[20:23], s41 offen lds
    v_mfma_f32_16x16x32_bf16 v[212:215], v[16:19], v[116:119], 0
    ds_read_b64_tr_b16 v[42:43], v4 offset:10240
    s_add_u32 m0, s35, 114688
    s_add_u32 s41, s28, 884864
    buffer_load_dwordx4 v6, s[20:23], s41 offen lds
    v_mul_f32 v80, v80, v88
    s_waitcnt lgkmcnt(11)
    v_mfma_f32_16x16x32_bf16 v[216:219], v[20:23], v[112:115], 0
    ds_read_b64_tr_b16 v[44:45], v5 offset:8192
    v_mul_f32 v81, v81, v89
    v_mul_f32 v82, v82, v90
    v_mfma_f32_16x16x32_bf16 v[220:223], v[20:23], v[116:119], 0
    ds_read_b64_tr_b16 v[46:47], v5 offset:10240
    v_mul_f32 v83, v83, v91
    v_mul_f32 v96, v96, v104
    s_waitcnt lgkmcnt(11)
    v_mfma_f32_16x16x32_bf16 v[224:227], v[24:27], v[112:115], 0
    ds_read_b64_tr_b16 v[16:17], v2 offset:16384
    v_mul_f32 v97, v97, v105
    v_mul_f32 v98, v98, v106
    v_mfma_f32_16x16x32_bf16 v[228:231], v[24:27], v[116:119], 0
    ds_read_b64_tr_b16 v[18:19], v2 offset:18432
    v_mul_f32 v99, v99, v107
    v_cvt_pk_bf16_f32 v88, v80, v81
    s_waitcnt lgkmcnt(11)
    v_mfma_f32_16x16x32_bf16 v[232:235], v[28:31], v[112:115], 0
    ds_read_b64_tr_b16 v[20:21], v3 offset:16384
    v_cvt_pk_bf16_f32 v89, v82, v83
    v_cvt_pk_bf16_f32 v90, v96, v97
    v_mfma_f32_16x16x32_bf16 v[236:239], v[28:31], v[116:119], 0
    ds_read_b64_tr_b16 v[22:23], v3 offset:18432
    v_cvt_pk_bf16_f32 v91, v98, v99
    s_add_u32 s45, s39, 4096
    buffer_store_dwordx4 v[88:91], v1, s[4:7], s45 offen offset:1024 sc1
    s_waitcnt lgkmcnt(11)
    v_mfma_f32_16x16x32_bf16 v[48:51], v[32:35], v[112:115], 0
    ds_read_b64_tr_b16 v[24:25], v4 offset:16384
    s_add_u32 m0, s35, 106496
    s_add_u32 s41, s28, 884992
    buffer_load_dwordx4 v6, s[20:23], s41 offen lds
    v_mfma_f32_16x16x32_bf16 v[52:55], v[32:35], v[116:119], 0
    ds_read_b64_tr_b16 v[26:27], v4 offset:18432
    s_add_u32 m0, s35, 98304
    s_add_u32 s41, s28, 1105920
    buffer_load_dwordx4 v6, s[20:23], s41 offen lds
    v_mul_f32 v84, v84, v92
    ds_read_b32 v8, v9
    s_waitcnt lgkmcnt(12)
    v_mfma_f32_16x16x32_bf16 v[56:59], v[36:39], v[112:115], 0
    ds_read_b64_tr_b16 v[28:29], v5 offset:16384
    v_mul_f32 v85, v85, v93
    v_mul_f32 v86, v86, v94
    v_mfma_f32_16x16x32_bf16 v[60:63], v[36:39], v[116:119], 0
    ds_read_b64_tr_b16 v[30:31], v5 offset:18432
    v_mul_f32 v87, v87, v95
    v_mul_f32 v100, v100, v108
    s_waitcnt lgkmcnt(11)
    v_mfma_f32_16x16x32_bf16 v[64:67], v[40:43], v[112:115], 0
    ds_read_b64_tr_b16 v[32:33], v2 offset:24576
    v_mul_f32 v101, v101, v109
    v_mul_f32 v102, v102, v110
    v_mfma_f32_16x16x32_bf16 v[68:71], v[40:43], v[116:119], 0
    ds_read_b64_tr_b16 v[34:35], v2 offset:26624
    v_mul_f32 v103, v103, v111
    v_cvt_pk_bf16_f32 v92, v84, v85
    s_waitcnt lgkmcnt(11)
    v_mfma_f32_16x16x32_bf16 v[72:75], v[44:47], v[112:115], 0
    ds_read_b64_tr_b16 v[36:37], v3 offset:24576
    v_cvt_pk_bf16_f32 v93, v86, v87
    v_cvt_pk_bf16_f32 v94, v100, v101
    v_mfma_f32_16x16x32_bf16 v[76:79], v[44:47], v[116:119], 0
    ds_read_b64_tr_b16 v[38:39], v3 offset:26624
    v_cvt_pk_bf16_f32 v95, v102, v103
    s_add_u32 s45, s39, 188416
    buffer_store_dwordx4 v[92:95], v1, s[4:7], s45 offen offset:1024 sc1
    s_waitcnt lgkmcnt(6)
    v_cmp_gt_i32 vcc, v7, v8
    s_cbranch_vccnz SBs_66
SBb_67:
    s_setprio 1
    v_mfma_f32_16x16x32_bf16 v[80:83], v[16:19], v[112:115], 0
    ds_read_b64_tr_b16 v[40:41], v4 offset:24576
    v_mfma_f32_16x16x32_bf16 v[84:87], v[16:19], v[116:119], 0
    ds_read_b64_tr_b16 v[42:43], v4 offset:26624
    v_mfma_f32_16x16x32_bf16 v[88:91], v[20:23], v[112:115], 0
    ds_read_b64_tr_b16 v[44:45], v5 offset:24576
    v_mfma_f32_16x16x32_bf16 v[92:95], v[20:23], v[116:119], 0
    ds_read_b64_tr_b16 v[46:47], v5 offset:26624
    s_add_u32 m0, s35, 139264
    s_add_u32 s41, s28, 1106048
    buffer_load_dwordx4 v6, s[20:23], s41 offen lds
    v_mfma_f32_16x16x32_bf16 v[96:99], v[24:27], v[112:115], 0
    ds_read_b64_tr_b16 v[16:17], v244 offset:32768
    v_mfma_f32_16x16x32_bf16 v[100:103], v[24:27], v[116:119], 0
    ds_read_b64_tr_b16 v[18:19], v244 offset:34816
    s_waitcnt lgkmcnt(10)
    v_mfma_f32_16x16x32_bf16 v[104:107], v[28:31], v[112:115], 0
    ds_read_b64_tr_b16 v[20:21], v245 offset:32768
    v_mfma_f32_16x16x32_bf16 v[108:111], v[28:31], v[116:119], 0
    ds_read_b64_tr_b16 v[22:23], v245 offset:34816
    buffer_load_dword v14, v13, s[4:7], s57 offen sc1
    s_waitcnt vmcnt(12)
    s_mov_b32 m0, s46
    v_add_u32 v7, 1, v7
    ds_write_addtid_b32 v7
    s_setprio 0
    s_waitcnt lgkmcnt(11)
    v_mfma_f32_16x16x32_bf16 v[208:211], v[32:35], v[120:123], v[208:211]
    ds_read_b64_tr_b16 v[24:25], v246 offset:32768
    v_mfma_f32_16x16x32_bf16 v[212:215], v[32:35], v[124:127], v[212:215]
    ds_read_b64_tr_b16 v[26:27], v246 offset:34816
    s_waitcnt lgkmcnt(11)
    v_mfma_f32_16x16x32_bf16 v[216:219], v[36:39], v[120:123], v[216:219]
    ds_read_b64_tr_b16 v[28:29], v247 offset:32768
    v_mfma_f32_16x16x32_bf16 v[220:223], v[36:39], v[124:127], v[220:223]
    ds_read_b64_tr_b16 v[30:31], v247 offset:34816
    s_waitcnt lgkmcnt(11)
    v_mfma_f32_16x16x32_bf16 v[224:227], v[40:43], v[120:123], v[224:227]
    ds_read_b64_tr_b16 v[32:33], v2 offset:32768
    v_mfma_f32_16x16x32_bf16 v[228:231], v[40:43], v[124:127], v[228:231]
    ds_read_b64_tr_b16 v[34:35], v2 offset:34816
    s_waitcnt lgkmcnt(11)
    v_mfma_f32_16x16x32_bf16 v[232:235], v[44:47], v[120:123], v[232:235]
    ds_read_b64_tr_b16 v[36:37], v3 offset:32768
    v_mfma_f32_16x16x32_bf16 v[236:239], v[44:47], v[124:127], v[236:239]
    ds_read_b64_tr_b16 v[38:39], v3 offset:34816
    s_add_u32 m0, s35, 131072
    s_add_u32 s41, s28, 1106176
    buffer_load_dwordx4 v6, s[20:23], s41 offen lds
    s_waitcnt lgkmcnt(11)
    v_mfma_f32_16x16x32_bf16 v[48:51], v[16:19], v[120:123], v[48:51]
    ds_read_b64_tr_b16 v[40:41], v4 offset:32768
    v_mfma_f32_16x16x32_bf16 v[52:55], v[16:19], v[124:127], v[52:55]
    ds_read_b64_tr_b16 v[42:43], v4 offset:34816
    ds_read_b32 v8, v9
    s_waitcnt lgkmcnt(12)
    v_mfma_f32_16x16x32_bf16 v[56:59], v[20:23], v[120:123], v[56:59]
    ds_read_b64_tr_b16 v[44:45], v5 offset:32768
    v_mfma_f32_16x16x32_bf16 v[60:63], v[20:23], v[124:127], v[60:63]
    ds_read_b64_tr_b16 v[46:47], v5 offset:34816
    s_waitcnt lgkmcnt(11)
    v_mfma_f32_16x16x32_bf16 v[64:67], v[24:27], v[120:123], v[64:67]
    ds_read_b64_tr_b16 v[16:17], v2 offset:40960
    v_mfma_f32_16x16x32_bf16 v[68:71], v[24:27], v[124:127], v[68:71]
    ds_read_b64_tr_b16 v[18:19], v2 offset:43008
    s_waitcnt lgkmcnt(11)
    v_mfma_f32_16x16x32_bf16 v[72:75], v[28:31], v[120:123], v[72:75]
    ds_read_b64_tr_b16 v[20:21], v3 offset:40960
    v_mfma_f32_16x16x32_bf16 v[76:79], v[28:31], v[124:127], v[76:79]
    ds_read_b64_tr_b16 v[22:23], v3 offset:43008
    s_add_u32 m0, s35, 90112
    s_add_u32 s41, s28, 73728
    buffer_load_dwordx4 v6, s[20:23], s41 offen lds
    s_waitcnt lgkmcnt(6)
    v_cmp_gt_i32 vcc, v7, v8
    s_cbranch_vccnz SBs_68
SBb_69:
    s_setprio 1
    s_waitcnt vmcnt(2)
    v_cmp_gt_u32 vcc, 2, v14
    s_cbranch_vccnz PLs_70
PLb_71:
    v_mfma_f32_16x16x32_bf16 v[80:83], v[32:35], v[120:123], v[80:83]
    ds_read_b64_tr_b16 v[24:25], v4 offset:40960
    v_mfma_f32_16x16x32_bf16 v[84:87], v[32:35], v[124:127], v[84:87]
    ds_read_b64_tr_b16 v[26:27], v4 offset:43008
    v_mfma_f32_16x16x32_bf16 v[88:91], v[36:39], v[120:123], v[88:91]
    ds_read_b64_tr_b16 v[28:29], v5 offset:40960
    v_mfma_f32_16x16x32_bf16 v[92:95], v[36:39], v[124:127], v[92:95]
    ds_read_b64_tr_b16 v[30:31], v5 offset:43008
    v_mfma_f32_16x16x32_bf16 v[96:99], v[40:43], v[120:123], v[96:99]
    ds_read_b64_tr_b16 v[32:33], v2 offset:49152
    v_mfma_f32_16x16x32_bf16 v[100:103], v[40:43], v[124:127], v[100:103]
    ds_read_b64_tr_b16 v[34:35], v2 offset:51200
    s_waitcnt lgkmcnt(10)
    v_mfma_f32_16x16x32_bf16 v[104:107], v[44:47], v[120:123], v[104:107]
    ds_read_b64_tr_b16 v[36:37], v3 offset:49152
    v_mfma_f32_16x16x32_bf16 v[108:111], v[44:47], v[124:127], v[108:111]
    ds_read_b64_tr_b16 v[38:39], v3 offset:51200
    s_add_u32 m0, s35, 24576
    s_add_u32 s41, s28, 73856
    buffer_load_dwordx4 v6, s[20:23], s41 offen lds
    s_mov_b32 m0, s46
    v_add_u32 v7, 1, v7
    ds_write_addtid_b32 v7
    s_setprio 0
    s_waitcnt lgkmcnt(11)
    v_mfma_f32_16x16x32_bf16 v[208:211], v[16:19], v[128:131], v[208:211]
    ds_read_b64_tr_b16 v[40:41], v4 offset:49152
    v_mfma_f32_16x16x32_bf16 v[212:215], v[16:19], v[132:135], v[212:215]
    ds_read_b64_tr_b16 v[42:43], v4 offset:51200
    s_waitcnt lgkmcnt(11)
    v_mfma_f32_16x16x32_bf16 v[216:219], v[20:23], v[128:131], v[216:219]
    ds_read_b64_tr_b16 v[44:45], v5 offset:49152
    s_add_u32 s36, s30, 2048
    buffer_load_dwordx4 v[160:163], v1, s[4:7], s36 offen sc1
    v_mfma_f32_16x16x32_bf16 v[220:223], v[20:23], v[132:135], v[220:223]
    ds_read_b64_tr_b16 v[46:47], v5 offset:51200
    s_waitcnt lgkmcnt(11)
    v_mfma_f32_16x16x32_bf16 v[224:227], v[24:27], v[128:131], v[224:227]
    ds_read_b64_tr_b16 v[16:17], v240 offset:0
    v_mfma_f32_16x16x32_bf16 v[228:231], v[24:27], v[132:135], v[228:231]
    ds_read_b64_tr_b16 v[18:19], v240 offset:2048
    s_add_u32 s36, s31, 2048
    buffer_load_dwordx4 v[164:167], v1, s[4:7], s36 offen sc1
    s_waitcnt lgkmcnt(11)
    v_mfma_f32_16x16x32_bf16 v[232:235], v[28:31], v[128:131], v[232:235]
    ds_read_b64_tr_b16 v[20:21], v241 offset:0
    v_mfma_f32_16x16x32_bf16 v[236:239], v[28:31], v[132:135], v[236:239]
    ds_read_b64_tr_b16 v[22:23], v241 offset:2048
    s_add_u32 m0, s35, 16384
    s_add_u32 s41, s28, 294912
    buffer_load_dwordx4 v6, s[20:23], s41 offen lds
    s_waitcnt lgkmcnt(11)
    v_mfma_f32_16x16x32_bf16 v[48:51], v[32:35], v[128:131], v[48:51]
    ds_read_b64_tr_b16 v[24:25], v242 offset:0
    v_mfma_f32_16x16x32_bf16 v[52:55], v[32:35], v[132:135], v[52:55]
    ds_read_b64_tr_b16 v[26:27], v242 offset:2048
    ds_read_b32 v8, v9
    s_waitcnt lgkmcnt(12)
    v_mfma_f32_16x16x32_bf16 v[56:59], v[36:39], v[128:131], v[56:59]
    ds_read_b64_tr_b16 v[28:29], v243 offset:0
    v_mfma_f32_16x16x32_bf16 v[60:63], v[36:39], v[132:135], v[60:63]
    ds_read_b64_tr_b16 v[30:31], v243 offset:2048
    s_waitcnt lgkmcnt(11)
    v_mfma_f32_16x16x32_bf16 v[64:67], v[40:43], v[128:131], v[64:67]
    ds_read_b64_tr_b16 v[32:33], v240 offset:8192
    v_mfma_f32_16x16x32_bf16 v[68:71], v[40:43], v[132:135], v[68:71]
    ds_read_b64_tr_b16 v[34:35], v240 offset:10240
    s_waitcnt lgkmcnt(11)
    v_mfma_f32_16x16x32_bf16 v[72:75], v[44:47], v[128:131], v[72:75]
    ds_read_b64_tr_b16 v[36:37], v241 offset:8192
    v_mfma_f32_16x16x32_bf16 v[76:79], v[44:47], v[132:135], v[76:79]
    ds_read_b64_tr_b16 v[38:39], v241 offset:10240
    s_add_u32 m0, s35, 8192
    s_add_u32 s41, s28, 295040
    buffer_load_dwordx4 v6, s[20:23], s41 offen lds
    s_waitcnt lgkmcnt(6)
    v_cmp_gt_i32 vcc, v7, v8
    s_cbranch_vccnz SBs_72
SBb_73:
    s_setprio 1
    v_mfma_f32_16x16x32_bf16 v[80:83], v[16:19], v[128:131], v[80:83]
    ds_read_b64_tr_b16 v[40:41], v242 offset:8192
    v_mfma_f32_16x16x32_bf16 v[84:87], v[16:19], v[132:135], v[84:87]
    ds_read_b64_tr_b16 v[42:43], v242 offset:10240
    v_mfma_f32_16x16x32_bf16 v[88:91], v[20:23], v[128:131], v[88:91]
    ds_read_b64_tr_b16 v[44:45], v243 offset:8192
    v_mfma_f32_16x16x32_bf16 v[92:95], v[20:23], v[132:135], v[92:95]
    ds_read_b64_tr_b16 v[46:47], v243 offset:10240
    v_mfma_f32_16x16x32_bf16 v[96:99], v[24:27], v[128:131], v[96:99]
    ds_read_b64_tr_b16 v[16:17], v240 offset:16384
    v_mfma_f32_16x16x32_bf16 v[100:103], v[24:27], v[132:135], v[100:103]
    ds_read_b64_tr_b16 v[18:19], v240 offset:18432
    s_waitcnt lgkmcnt(10)
    v_mfma_f32_16x16x32_bf16 v[104:107], v[28:31], v[128:131], v[104:107]
    ds_read_b64_tr_b16 v[20:21], v241 offset:16384
    v_mfma_f32_16x16x32_bf16 v[108:111], v[28:31], v[132:135], v[108:111]
    ds_read_b64_tr_b16 v[22:23], v241 offset:18432
    s_add_u32 m0, s35, 147456
    s_add_u32 s41, s28, 516096
    buffer_load_dwordx4 v6, s[20:23], s41 offen lds
    s_mov_b32 m0, s46
    v_add_u32 v7, 1, v7
    ds_write_addtid_b32 v7
    s_setprio 0
    s_waitcnt lgkmcnt(11)
    v_mfma_f32_16x16x32_bf16 v[208:211], v[32:35], v[136:139], v[208:211]
    ds_read_b64_tr_b16 v[24:25], v242 offset:16384
    v_mfma_f32_16x16x32_bf16 v[212:215], v[32:35], v[140:143], v[212:215]
    ds_read_b64_tr_b16 v[26:27], v242 offset:18432
    s_waitcnt lgkmcnt(11)
    v_mfma_f32_16x16x32_bf16 v[216:219], v[36:39], v[136:139], v[216:219]
    ds_read_b64_tr_b16 v[28:29], v243 offset:16384
    s_add_u32 s36, s30, 8192
    buffer_load_dwordx4 v[168:171], v1, s[4:7], s36 offen sc1
    v_mfma_f32_16x16x32_bf16 v[220:223], v[36:39], v[140:143], v[220:223]
    ds_read_b64_tr_b16 v[30:31], v243 offset:18432
    s_waitcnt lgkmcnt(11)
    v_mfma_f32_16x16x32_bf16 v[224:227], v[40:43], v[136:139], v[224:227]
    ds_read_b64_tr_b16 v[32:33], v240 offset:24576
    v_mfma_f32_16x16x32_bf16 v[228:231], v[40:43], v[140:143], v[228:231]
    ds_read_b64_tr_b16 v[34:35], v240 offset:26624
    s_add_u32 s36, s31, 8192
    buffer_load_dwordx4 v[172:175], v1, s[4:7], s36 offen sc1
    s_waitcnt lgkmcnt(11)
    v_mfma_f32_16x16x32_bf16 v[232:235], v[44:47], v[136:139], v[232:235]
    ds_read_b64_tr_b16 v[36:37], v241 offset:24576
    v_mfma_f32_16x16x32_bf16 v[236:239], v[44:47], v[140:143], v[236:239]
    ds_read_b64_tr_b16 v[38:39], v241 offset:26624
    s_add_u32 m0, s35, 40960
    s_add_u32 s41, s28, 516224
    buffer_load_dwordx4 v6, s[20:23], s41 offen lds
    s_waitcnt lgkmcnt(11)
    v_mfma_f32_16x16x32_bf16 v[48:51], v[16:19], v[136:139], v[48:51]
    ds_read_b64_tr_b16 v[40:41], v242 offset:24576
    v_mfma_f32_16x16x32_bf16 v[52:55], v[16:19], v[140:143], v[52:55]
    ds_read_b64_tr_b16 v[42:43], v242 offset:26624
    ds_read_b32 v8, v9
    s_waitcnt lgkmcnt(12)
    v_mfma_f32_16x16x32_bf16 v[56:59], v[20:23], v[136:139], v[56:59]
    ds_read_b64_tr_b16 v[44:45], v243 offset:24576
    v_mfma_f32_16x16x32_bf16 v[60:63], v[20:23], v[140:143], v[60:63]
    ds_read_b64_tr_b16 v[46:47], v243 offset:26624
    s_waitcnt lgkmcnt(11)
    v_mfma_f32_16x16x32_bf16 v[64:67], v[24:27], v[136:139], v[64:67]
    ds_read_b64_tr_b16 v[16:17], v244 offset:8192
    v_mfma_f32_16x16x32_bf16 v[68:71], v[24:27], v[140:143], v[68:71]
    ds_read_b64_tr_b16 v[18:19], v244 offset:10240
    s_waitcnt lgkmcnt(11)
    v_mfma_f32_16x16x32_bf16 v[72:75], v[28:31], v[136:139], v[72:75]
    ds_read_b64_tr_b16 v[20:21], v245 offset:8192
    v_mfma_f32_16x16x32_bf16 v[76:79], v[28:31], v[140:143], v[76:79]
    ds_read_b64_tr_b16 v[22:23], v245 offset:10240
    s_add_u32 m0, s35, 32768
    s_add_u32 s41, s28, 737280
    buffer_load_dwordx4 v6, s[20:23], s41 offen lds
    s_waitcnt lgkmcnt(6)
    v_cmp_gt_i32 vcc, v7, v8
    s_cbranch_vccnz SBs_74
SBb_75:
    s_setprio 1
    v_mfma_f32_16x16x32_bf16 v[80:83], v[32:35], v[136:139], v[80:83]
    ds_read_b64_tr_b16 v[24:25], v246 offset:8192
    v_mfma_f32_16x16x32_bf16 v[84:87], v[32:35], v[140:143], v[84:87]
    ds_read_b64_tr_b16 v[26:27], v246 offset:10240
    v_mfma_f32_16x16x32_bf16 v[88:91], v[36:39], v[136:139], v[88:91]
    ds_read_b64_tr_b16 v[28:29], v247 offset:8192
    v_mfma_f32_16x16x32_bf16 v[92:95], v[36:39], v[140:143], v[92:95]
    ds_read_b64_tr_b16 v[30:31], v247 offset:10240
    s_add_u32 m0, s35, 65536
    s_add_u32 s41, s28, 737408
    buffer_load_dwordx4 v6, s[20:23], s41 offen lds
    v_mfma_f32_16x16x32_bf16 v[96:99], v[40:43], v[136:139], v[96:99]
    ds_read_b64_tr_b16 v[32:33], v244 offset:0
    v_mfma_f32_16x16x32_bf16 v[100:103], v[40:43], v[140:143], v[100:103]
    ds_read_b64_tr_b16 v[34:35], v244 offset:2048
    s_waitcnt lgkmcnt(10)
    v_mfma_f32_16x16x32_bf16 v[104:107], v[44:47], v[136:139], v[104:107]
    ds_read_b64_tr_b16 v[36:37], v245 offset:0
    v_mfma_f32_16x16x32_bf16 v[108:111], v[44:47], v[140:143], v[108:111]
    ds_read_b64_tr_b16 v[38:39], v245 offset:2048
    v_mov_b32 v15, 3
    s_mov_b64 exec, 1
    buffer_store_dword v15, v1, s[4:7], s56 offen sc1
    s_mov_b64 exec, -1
    s_waitcnt vmcnt(12)
    s_mov_b32 m0, s46
    v_add_u32 v7, 1, v7
    ds_write_addtid_b32 v7
    s_setprio 0
    s_waitcnt lgkmcnt(11)
    v_mfma_f32_16x16x32_bf16 v[208:211], v[16:19], v[144:147], v[208:211]
    ds_read_b64_tr_b16 v[40:41], v246 offset:0
    v_mfma_f32_16x16x32_bf16 v[212:215], v[16:19], v[148:151], v[212:215]
    ds_read_b64_tr_b16 v[42:43], v246 offset:2048
    s_waitcnt lgkmcnt(11)
    v_mfma_f32_16x16x32_bf16 v[216:219], v[20:23], v[144:147], v[216:219]
    ds_read_b64_tr_b16 v[44:45], v247 offset:0
    s_add_u32 s36, s30, 14336
    buffer_load_dwordx4 v[176:179], v1, s[4:7], s36 offen sc1
    v_mfma_f32_16x16x32_bf16 v[220:223], v[20:23], v[148:151], v[220:223]
    ds_read_b64_tr_b16 v[46:47], v247 offset:2048
    s_waitcnt lgkmcnt(11)
    v_mfma_f32_16x16x32_bf16 v[224:227], v[24:27], v[144:147], v[224:227]
    ds_read_b64_tr_b16 v[16:17], v240 offset:49152
    v_mfma_f32_16x16x32_bf16 v[228:231], v[24:27], v[148:151], v[228:231]
    ds_read_b64_tr_b16 v[18:19], v240 offset:51200
    s_add_u32 s36, s31, 14336
    buffer_load_dwordx4 v[180:183], v1, s[4:7], s36 offen sc1
    s_waitcnt lgkmcnt(11)
    v_mfma_f32_16x16x32_bf16 v[232:235], v[28:31], v[144:147], v[232:235]
    ds_read_b64_tr_b16 v[20:21], v241 offset:49152
    v_mfma_f32_16x16x32_bf16 v[236:239], v[28:31], v[148:151], v[236:239]
    ds_read_b64_tr_b16 v[22:23], v241 offset:51200
    s_add_u32 m0, s35, 57344
    s_add_u32 s41, s28, 958464
    buffer_load_dwordx4 v6, s[20:23], s41 offen lds
    s_waitcnt lgkmcnt(11)
    v_mfma_f32_16x16x32_bf16 v[48:51], v[32:35], v[144:147], v[48:51]
    ds_read_b64_tr_b16 v[24:25], v242 offset:49152
    v_mfma_f32_16x16x32_bf16 v[52:55], v[32:35], v[148:151], v[52:55]
    ds_read_b64_tr_b16 v[26:27], v242 offset:51200
    ds_read_b32 v8, v9
    s_waitcnt lgkmcnt(12)
    v_mfma_f32_16x16x32_bf16 v[56:59], v[36:39], v[144:147], v[56:59]
    ds_read_b64_tr_b16 v[28:29], v243 offset:49152
    v_mfma_f32_16x16x32_bf16 v[60:63], v[36:39], v[148:151], v[60:63]
    ds_read_b64_tr_b16 v[30:31], v243 offset:51200
    s_waitcnt lgkmcnt(11)
    v_mfma_f32_16x16x32_bf16 v[64:67], v[40:43], v[144:147], v[64:67]
    ds_read_b64_tr_b16 v[32:33], v240 offset:40960
    v_mfma_f32_16x16x32_bf16 v[68:71], v[40:43], v[148:151], v[68:71]
    ds_read_b64_tr_b16 v[34:35], v240 offset:43008
    s_waitcnt lgkmcnt(11)
    v_mfma_f32_16x16x32_bf16 v[72:75], v[44:47], v[144:147], v[72:75]
    ds_read_b64_tr_b16 v[36:37], v241 offset:40960
    v_mfma_f32_16x16x32_bf16 v[76:79], v[44:47], v[148:151], v[76:79]
    ds_read_b64_tr_b16 v[38:39], v241 offset:43008
    s_add_u32 m0, s35, 49152
    s_add_u32 s41, s28, 958592
    buffer_load_dwordx4 v6, s[20:23], s41 offen lds
    s_waitcnt lgkmcnt(6)
    v_cmp_gt_i32 vcc, v7, v8
    s_cbranch_vccnz SBs_76
SBb_77:
    s_setprio 1
    v_mfma_f32_16x16x32_bf16 v[80:83], v[16:19], v[144:147], v[80:83]
    ds_read_b64_tr_b16 v[40:41], v242 offset:40960
    v_mfma_f32_16x16x32_bf16 v[84:87], v[16:19], v[148:151], v[84:87]
    ds_read_b64_tr_b16 v[42:43], v242 offset:43008
    v_mfma_f32_16x16x32_bf16 v[88:91], v[20:23], v[144:147], v[88:91]
    ds_read_b64_tr_b16 v[44:45], v243 offset:40960
    v_mfma_f32_16x16x32_bf16 v[92:95], v[20:23], v[148:151], v[92:95]
    ds_read_b64_tr_b16 v[46:47], v243 offset:43008
    v_mfma_f32_16x16x32_bf16 v[96:99], v[24:27], v[144:147], v[96:99]
    ds_read_b64_tr_b16 v[16:17], v244 offset:24576
    v_mfma_f32_16x16x32_bf16 v[100:103], v[24:27], v[148:151], v[100:103]
    ds_read_b64_tr_b16 v[18:19], v244 offset:26624
    s_waitcnt lgkmcnt(10)
    v_mfma_f32_16x16x32_bf16 v[104:107], v[28:31], v[144:147], v[104:107]
    ds_read_b64_tr_b16 v[20:21], v245 offset:24576
    v_mfma_f32_16x16x32_bf16 v[108:111], v[28:31], v[148:151], v[108:111]
    ds_read_b64_tr_b16 v[22:23], v245 offset:26624
    s_add_u32 m0, s35, 122880
    s_add_u32 s41, s28, 1179648
    buffer_load_dwordx4 v6, s[20:23], s41 offen lds
    s_waitcnt vmcnt(12)
    s_mov_b32 m0, s46
    v_add_u32 v7, 1, v7
    ds_write_addtid_b32 v7
    s_setprio 0
    s_waitcnt lgkmcnt(11)
    v_mfma_f32_16x16x32_bf16 v[208:211], v[32:35], v[152:155], v[208:211]
    ds_read_b64_tr_b16 v[24:25], v246 offset:24576
    v_mfma_f32_16x16x32_bf16 v[212:215], v[32:35], v[156:159], v[212:215]
    ds_read_b64_tr_b16 v[26:27], v246 offset:26624
    s_waitcnt lgkmcnt(11)
    v_mfma_f32_16x16x32_bf16 v[216:219], v[36:39], v[152:155], v[216:219]
    ds_read_b64_tr_b16 v[28:29], v247 offset:24576
    v_mfma_f32_16x16x32_bf16 v[220:223], v[36:39], v[156:159], v[220:223]
    ds_read_b64_tr_b16 v[30:31], v247 offset:26624
    s_add_u32 s36, s30, 20480
    buffer_load_dwordx4 v[184:187], v1, s[4:7], s36 offen sc1
    s_waitcnt lgkmcnt(11)
    v_mfma_f32_16x16x32_bf16 v[224:227], v[40:43], v[152:155], v[224:227]
    ds_read_b64_tr_b16 v[32:33], v244 offset:16384
    v_mfma_f32_16x16x32_bf16 v[228:231], v[40:43], v[156:159], v[228:231]
    ds_read_b64_tr_b16 v[34:35], v244 offset:18432
    s_waitcnt lgkmcnt(11)
    v_mfma_f32_16x16x32_bf16 v[232:235], v[44:47], v[152:155], v[232:235]
    ds_read_b64_tr_b16 v[36:37], v245 offset:16384
    v_mfma_f32_16x16x32_bf16 v[236:239], v[44:47], v[156:159], v[236:239]
    ds_read_b64_tr_b16 v[38:39], v245 offset:18432
    s_add_u32 s36, s31, 20480
    buffer_load_dwordx4 v[188:191], v1, s[4:7], s36 offen sc1
    s_waitcnt lgkmcnt(11)
    v_mfma_f32_16x16x32_bf16 v[48:51], v[16:19], v[152:155], v[48:51]
    ds_read_b64_tr_b16 v[40:41], v246 offset:16384
    v_mfma_f32_16x16x32_bf16 v[52:55], v[16:19], v[156:159], v[52:55]
    ds_read_b64_tr_b16 v[42:43], v246 offset:18432
    ds_read_b32 v8, v9
    s_waitcnt lgkmcnt(12)
    v_mfma_f32_16x16x32_bf16 v[56:59], v[20:23], v[152:155], v[56:59]
    ds_read_b64_tr_b16 v[44:45], v247 offset:16384
    v_mfma_f32_16x16x32_bf16 v[60:63], v[20:23], v[156:159], v[60:63]
    ds_read_b64_tr_b16 v[46:47], v247 offset:18432
    s_waitcnt lgkmcnt(11)
    v_mfma_f32_16x16x32_bf16 v[64:67], v[24:27], v[152:155], v[64:67]
    ds_read_b64_tr_b16 v[16:17], v240 offset:32768
    v_mfma_f32_16x16x32_bf16 v[68:71], v[24:27], v[156:159], v[68:71]
    ds_read_b64_tr_b16 v[18:19], v240 offset:34816
    s_waitcnt lgkmcnt(11)
    v_mfma_f32_16x16x32_bf16 v[72:75], v[28:31], v[152:155], v[72:75]
    ds_read_b64_tr_b16 v[20:21], v241 offset:32768
    v_mfma_f32_16x16x32_bf16 v[76:79], v[28:31], v[156:159], v[76:79]
    ds_read_b64_tr_b16 v[22:23], v241 offset:34816
    s_waitcnt lgkmcnt(6)
    v_cmp_gt_i32 vcc, v7, v8
    s_cbranch_vccnz SBs_78
SBb_79:
    s_setprio 1
    v_mfma_f32_16x16x32_bf16 v[80:83], v[32:35], v[152:155], v[80:83]
    ds_read_b64_tr_b16 v[24:25], v242 offset:32768
    v_mfma_f32_16x16x32_bf16 v[84:87], v[32:35], v[156:159], v[84:87]
    ds_read_b64_tr_b16 v[26:27], v242 offset:34816
    v_mfma_f32_16x16x32_bf16 v[88:91], v[36:39], v[152:155], v[88:91]
    ds_read_b64_tr_b16 v[28:29], v243 offset:32768
    v_mfma_f32_16x16x32_bf16 v[92:95], v[36:39], v[156:159], v[92:95]
    ds_read_b64_tr_b16 v[30:31], v243 offset:34816
    s_add_u32 m0, s35, 114688
    s_add_u32 s41, s28, 1179776
    buffer_load_dwordx4 v6, s[20:23], s41 offen lds
    v_mfma_f32_16x16x32_bf16 v[96:99], v[40:43], v[152:155], v[96:99]
    ds_read_b64_tr_b16 v[32:33], v2 offset:24576
    v_mfma_f32_16x16x32_bf16 v[100:103], v[40:43], v[156:159], v[100:103]
    ds_read_b64_tr_b16 v[34:35], v2 offset:26624
    s_waitcnt lgkmcnt(10)
    v_mfma_f32_16x16x32_bf16 v[104:107], v[44:47], v[152:155], v[104:107]
    ds_read_b64_tr_b16 v[36:37], v3 offset:24576
    v_mfma_f32_16x16x32_bf16 v[108:111], v[44:47], v[156:159], v[108:111]
    ds_read_b64_tr_b16 v[38:39], v3 offset:26624
    s_add_u32 m0, s35, 106496
    s_add_u32 s41, s28, 147456
    buffer_load_dwordx4 v6, s[20:23], s41 offen lds
    s_waitcnt vmcnt(11)
    s_mov_b32 m0, s46
    v_add_u32 v7, 1, v7
    ds_write_addtid_b32 v7
    s_setprio 0
    s_waitcnt lgkmcnt(11)
    v_mfma_f32_16x16x32_bf16 v[208:211], v[16:19], v[160:163], v[208:211]
    ds_read_b64_tr_b16 v[40:41], v4 offset:24576
    v_mfma_f32_16x16x32_bf16 v[212:215], v[16:19], v[164:167], v[212:215]
    ds_read_b64_tr_b16 v[42:43], v4 offset:26624
    s_waitcnt lgkmcnt(11)
    v_mfma_f32_16x16x32_bf16 v[216:219], v[20:23], v[160:163], v[216:219]
    ds_read_b64_tr_b16 v[44:45], v5 offset:24576
    s_add_u32 s36, s30, 26624
    buffer_load_dwordx4 v[192:195], v1, s[4:7], s36 offen sc1
    v_mfma_f32_16x16x32_bf16 v[220:223], v[20:23], v[164:167], v[220:223]
    ds_read_b64_tr_b16 v[46:47], v5 offset:26624
    s_waitcnt lgkmcnt(11)
    v_mfma_f32_16x16x32_bf16 v[224:227], v[24:27], v[160:163], v[224:227]
    ds_read_b64_tr_b16 v[16:17], v2 offset:16384
    v_mfma_f32_16x16x32_bf16 v[228:231], v[24:27], v[164:167], v[228:231]
    ds_read_b64_tr_b16 v[18:19], v2 offset:18432
    s_add_u32 s36, s31, 26624
    buffer_load_dwordx4 v[196:199], v1, s[4:7], s36 offen sc1
    s_waitcnt lgkmcnt(11)
    v_mfma_f32_16x16x32_bf16 v[232:235], v[28:31], v[160:163], v[232:235]
    ds_read_b64_tr_b16 v[20:21], v3 offset:16384
    v_mfma_f32_16x16x32_bf16 v[236:239], v[28:31], v[164:167], v[236:239]
    ds_read_b64_tr_b16 v[22:23], v3 offset:18432
    s_add_u32 m0, s35, 98304
    s_add_u32 s41, s28, 147584
    buffer_load_dwordx4 v6, s[20:23], s41 offen lds
    s_waitcnt lgkmcnt(11)
    v_mfma_f32_16x16x32_bf16 v[48:51], v[32:35], v[160:163], v[48:51]
    ds_read_b64_tr_b16 v[24:25], v4 offset:16384
    v_mfma_f32_16x16x32_bf16 v[52:55], v[32:35], v[164:167], v[52:55]
    ds_read_b64_tr_b16 v[26:27], v4 offset:18432
    ds_read_b32 v8, v9
    s_waitcnt lgkmcnt(12)
    v_mfma_f32_16x16x32_bf16 v[56:59], v[36:39], v[160:163], v[56:59]
    ds_read_b64_tr_b16 v[28:29], v5 offset:16384
    v_mfma_f32_16x16x32_bf16 v[60:63], v[36:39], v[164:167], v[60:63]
    ds_read_b64_tr_b16 v[30:31], v5 offset:18432
    s_waitcnt lgkmcnt(11)
    v_mfma_f32_16x16x32_bf16 v[64:67], v[40:43], v[160:163], v[64:67]
    ds_read_b64_tr_b16 v[32:33], v2 offset:8192
    v_mfma_f32_16x16x32_bf16 v[68:71], v[40:43], v[164:167], v[68:71]
    ds_read_b64_tr_b16 v[34:35], v2 offset:10240
    s_waitcnt lgkmcnt(11)
    v_mfma_f32_16x16x32_bf16 v[72:75], v[44:47], v[160:163], v[72:75]
    ds_read_b64_tr_b16 v[36:37], v3 offset:8192
    v_mfma_f32_16x16x32_bf16 v[76:79], v[44:47], v[164:167], v[76:79]
    ds_read_b64_tr_b16 v[38:39], v3 offset:10240
    buffer_load_dword v14, v13, s[4:7], s57 offen sc1
    s_waitcnt lgkmcnt(6)
    v_cmp_gt_i32 vcc, v7, v8
    s_cbranch_vccnz SBs_80
SBb_81:
    s_setprio 1
    v_mfma_f32_16x16x32_bf16 v[208:211], v[16:19], v[168:171], v[208:211]
    ds_read_b64_tr_b16 v[40:41], v4 offset:8192
    v_mfma_f32_16x16x32_bf16 v[212:215], v[16:19], v[172:175], v[212:215]
    ds_read_b64_tr_b16 v[42:43], v4 offset:10240
    s_add_u32 s36, s30, 32768
    buffer_load_dwordx4 v[200:203], v1, s[4:7], s36 offen sc1
    v_mfma_f32_16x16x32_bf16 v[216:219], v[20:23], v[168:171], v[216:219]
    ds_read_b64_tr_b16 v[44:45], v5 offset:8192
    v_mfma_f32_16x16x32_bf16 v[220:223], v[20:23], v[172:175], v[220:223]
    ds_read_b64_tr_b16 v[46:47], v5 offset:10240
    s_add_u32 s36, s31, 32768
    buffer_load_dwordx4 v[204:207], v1, s[4:7], s36 offen sc1
    v_mfma_f32_16x16x32_bf16 v[224:227], v[24:27], v[168:171], v[224:227]
    ds_read_b64_tr_b16 v[16:17], v244 offset:32768
    v_mfma_f32_16x16x32_bf16 v[228:231], v[24:27], v[172:175], v[228:231]
    ds_read_b64_tr_b16 v[18:19], v244 offset:34816
    s_add_u32 m0, s35, 139264
    s_add_u32 s41, s28, 368640
    buffer_load_dwordx4 v6, s[20:23], s41 offen lds
    s_waitcnt lgkmcnt(10)
    v_mfma_f32_16x16x32_bf16 v[232:235], v[28:31], v[168:171], v[232:235]
    ds_read_b64_tr_b16 v[20:21], v245 offset:32768
    v_mfma_f32_16x16x32_bf16 v[236:239], v[28:31], v[172:175], v[236:239]
    ds_read_b64_tr_b16 v[22:23], v245 offset:34816
    s_add_u32 m0, s35, 131072
    s_add_u32 s41, s28, 368768
    buffer_load_dwordx4 v6, s[20:23], s41 offen lds
    s_waitcnt vmcnt(13)
    s_mov_b32 m0, s46
    v_add_u32 v7, 1, v7
    ds_write_addtid_b32 v7
    s_setprio 0
    s_waitcnt lgkmcnt(11)
    v_mfma_f32_16x16x32_bf16 v[48:51], v[32:35], v[168:171], v[48:51]
    ds_read_b64_tr_b16 v[24:25], v246 offset:32768
    v_mfma_f32_16x16x32_bf16 v[52:55], v[32:35], v[172:175], v[52:55]
    ds_read_b64_tr_b16 v[26:27], v246 offset:34816
    s_waitcnt lgkmcnt(11)
    v_mfma_f32_16x16x32_bf16 v[56:59], v[36:39], v[168:171], v[56:59]
    ds_read_b64_tr_b16 v[28:29], v247 offset:32768
    v_mfma_f32_16x16x32_bf16 v[60:63], v[36:39], v[172:175], v[60:63]
    ds_read_b64_tr_b16 v[30:31], v247 offset:34816
    s_waitcnt lgkmcnt(11)
    v_mfma_f32_16x16x32_bf16 v[64:67], v[40:43], v[168:171], v[64:67]
    ds_read_b64_tr_b16 v[32:33], v2 offset:40960
    v_mfma_f32_16x16x32_bf16 v[68:71], v[40:43], v[172:175], v[68:71]
    ds_read_b64_tr_b16 v[34:35], v2 offset:43008
    s_waitcnt lgkmcnt(11)
    v_mfma_f32_16x16x32_bf16 v[72:75], v[44:47], v[168:171], v[72:75]
    ds_read_b64_tr_b16 v[36:37], v3 offset:40960
    v_mfma_f32_16x16x32_bf16 v[76:79], v[44:47], v[172:175], v[76:79]
    ds_read_b64_tr_b16 v[38:39], v3 offset:43008
    s_add_u32 m0, s35, 90112
    s_add_u32 s41, s28, 589824
    buffer_load_dwordx4 v6, s[20:23], s41 offen lds
    s_waitcnt vmcnt(5)
    v_cmp_gt_u32 vcc, 3, v14
    s_cbranch_vccnz PLs_82
PLb_83:
    s_waitcnt lgkmcnt(11)
    v_mfma_f32_16x16x32_bf16 v[208:211], v[16:19], v[176:179], v[208:211]
    ds_read_b64_tr_b16 v[40:41], v4 offset:40960
    v_mfma_f32_16x16x32_bf16 v[212:215], v[16:19], v[180:183], v[212:215]
    ds_read_b64_tr_b16 v[42:43], v4 offset:43008
    ds_read_b32 v8, v9
    s_waitcnt lgkmcnt(12)
    v_mfma_f32_16x16x32_bf16 v[216:219], v[20:23], v[176:179], v[216:219]
    ds_read_b64_tr_b16 v[44:45], v5 offset:40960
    v_mfma_f32_16x16x32_bf16 v[220:223], v[20:23], v[180:183], v[220:223]
    ds_read_b64_tr_b16 v[46:47], v5 offset:43008
    s_add_u32 s36, s30, 4096
    buffer_load_dwordx4 v[112:115], v1, s[4:7], s36 offen sc1
    s_waitcnt lgkmcnt(11)
    v_mfma_f32_16x16x32_bf16 v[224:227], v[24:27], v[176:179], v[224:227]
    ds_read_b64_tr_b16 v[16:17], v2 offset:32768
    v_mfma_f32_16x16x32_bf16 v[228:231], v[24:27], v[180:183], v[228:231]
    ds_read_b64_tr_b16 v[18:19], v2 offset:34816
    s_waitcnt lgkmcnt(11)
    v_mfma_f32_16x16x32_bf16 v[232:235], v[28:31], v[176:179], v[232:235]
    ds_read_b64_tr_b16 v[20:21], v3 offset:32768
    v_mfma_f32_16x16x32_bf16 v[236:239], v[28:31], v[180:183], v[236:239]
    ds_read_b64_tr_b16 v[22:23], v3 offset:34816
    s_add_u32 s36, s31, 4096
    buffer_load_dwordx4 v[116:119], v1, s[4:7], s36 offen sc1
    s_waitcnt lgkmcnt(6)
    v_cmp_gt_i32 vcc, v7, v8
    s_cbranch_vccnz SBs_84
SBb_85:
    s_setprio 1
    v_mfma_f32_16x16x32_bf16 v[48:51], v[32:35], v[176:179], v[48:51]
    ds_read_b64_tr_b16 v[24:25], v4 offset:32768
    v_mfma_f32_16x16x32_bf16 v[52:55], v[32:35], v[180:183], v[52:55]
    ds_read_b64_tr_b16 v[26:27], v4 offset:34816
    v_mfma_f32_16x16x32_bf16 v[56:59], v[36:39], v[176:179], v[56:59]
    ds_read_b64_tr_b16 v[28:29], v5 offset:32768
    v_mfma_f32_16x16x32_bf16 v[60:63], v[36:39], v[180:183], v[60:63]
    ds_read_b64_tr_b16 v[30:31], v5 offset:34816
    v_mfma_f32_16x16x32_bf16 v[64:67], v[40:43], v[176:179], v[64:67]
    ds_read_b64_tr_b16 v[32:33], v240 offset:8192
    v_mfma_f32_16x16x32_bf16 v[68:71], v[40:43], v[180:183], v[68:71]
    ds_read_b64_tr_b16 v[34:35], v240 offset:10240
    s_waitcnt lgkmcnt(10)
    v_mfma_f32_16x16x32_bf16 v[72:75], v[44:47], v[176:179], v[72:75]
    ds_read_b64_tr_b16 v[36:37], v241 offset:8192
    v_mfma_f32_16x16x32_bf16 v[76:79], v[44:47], v[180:183], v[76:79]
    ds_read_b64_tr_b16 v[38:39], v241 offset:10240
    s_mov_b32 m0, s46
    v_add_u32 v7, 1, v7
    ds_write_addtid_b32 v7
    s_setprio 0
    s_waitcnt lgkmcnt(11)
    v_mfma_f32_16x16x32_bf16 v[208:211], v[16:19], v[184:187], v[208:211]
    ds_read_b64_tr_b16 v[40:41], v242 offset:8192
    v_mfma_f32_16x16x32_bf16 v[212:215], v[16:19], v[188:191], v[212:215]
    ds_read_b64_tr_b16 v[42:43], v242 offset:10240
    s_waitcnt lgkmcnt(11)
    v_mfma_f32_16x16x32_bf16 v[216:219], v[20:23], v[184:187], v[216:219]
    ds_read_b64_tr_b16 v[44:45], v243 offset:8192
    v_mfma_f32_16x16x32_bf16 v[220:223], v[20:23], v[188:191], v[220:223]
    ds_read_b64_tr_b16 v[46:47], v243 offset:10240
    s_add_u32 s36, s30, 10240
    buffer_load_dwordx4 v[120:123], v1, s[4:7], s36 offen sc1
    s_waitcnt lgkmcnt(11)
    v_mfma_f32_16x16x32_bf16 v[224:227], v[24:27], v[184:187], v[224:227]
    ds_read_b64_tr_b16 v[16:17], v240 offset:0
    v_mfma_f32_16x16x32_bf16 v[228:231], v[24:27], v[188:191], v[228:231]
    ds_read_b64_tr_b16 v[18:19], v240 offset:2048
    s_waitcnt lgkmcnt(11)
    v_mfma_f32_16x16x32_bf16 v[232:235], v[28:31], v[184:187], v[232:235]
    ds_read_b64_tr_b16 v[20:21], v241 offset:0
    v_mfma_f32_16x16x32_bf16 v[236:239], v[28:31], v[188:191], v[236:239]
    ds_read_b64_tr_b16 v[22:23], v241 offset:2048
    s_add_u32 s36, s31, 10240
    buffer_load_dwordx4 v[124:127], v1, s[4:7], s36 offen sc1
    s_waitcnt lgkmcnt(11)
    v_mfma_f32_16x16x32_bf16 v[48:51], v[32:35], v[184:187], v[48:51]
    ds_read_b64_tr_b16 v[24:25], v242 offset:0
    v_mfma_f32_16x16x32_bf16 v[52:55], v[32:35], v[188:191], v[52:55]
    ds_read_b64_tr_b16 v[26:27], v242 offset:2048
    ds_read_b32 v8, v9
    s_waitcnt lgkmcnt(12)
    v_mfma_f32_16x16x32_bf16 v[56:59], v[36:39], v[184:187], v[56:59]
    ds_read_b64_tr_b16 v[28:29], v243 offset:0
    v_mfma_f32_16x16x32_bf16 v[60:63], v[36:39], v[188:191], v[60:63]
    ds_read_b64_tr_b16 v[30:31], v243 offset:2048
    s_waitcnt lgkmcnt(11)
    v_mfma_f32_16x16x32_bf16 v[64:67], v[40:43], v[184:187], v[64:67]
    ds_read_b64_tr_b16 v[32:33], v2 offset:49152
    v_mfma_f32_16x16x32_bf16 v[68:71], v[40:43], v[188:191], v[68:71]
    ds_read_b64_tr_b16 v[34:35], v2 offset:51200
    s_waitcnt lgkmcnt(11)
    v_mfma_f32_16x16x32_bf16 v[72:75], v[44:47], v[184:187], v[72:75]
    ds_read_b64_tr_b16 v[36:37], v3 offset:49152
    v_mfma_f32_16x16x32_bf16 v[76:79], v[44:47], v[188:191], v[76:79]
    ds_read_b64_tr_b16 v[38:39], v3 offset:51200
    s_waitcnt lgkmcnt(6)
    v_cmp_gt_i32 vcc, v7, v8
    s_cbranch_vccnz SBs_86
SBb_87:
    s_setprio 1
    v_mfma_f32_16x16x32_bf16 v[208:211], v[16:19], v[192:195], v[208:211]
    ds_read_b64_tr_b16 v[40:41], v4 offset:49152
    v_mfma_f32_16x16x32_bf16 v[212:215], v[16:19], v[196:199], v[212:215]
    ds_read_b64_tr_b16 v[42:43], v4 offset:51200
    v_mfma_f32_16x16x32_bf16 v[216:219], v[20:23], v[192:195], v[216:219]
    ds_read_b64_tr_b16 v[44:45], v5 offset:49152
    s_add_u32 s36, s30, 16384
    buffer_load_dwordx4 v[128:131], v1, s[4:7], s36 offen sc1
    v_mfma_f32_16x16x32_bf16 v[220:223], v[20:23], v[196:199], v[220:223]
    ds_read_b64_tr_b16 v[46:47], v5 offset:51200
    v_mfma_f32_16x16x32_bf16 v[224:227], v[24:27], v[192:195], v[224:227]
    ds_read_b64_tr_b16 v[16:17], v244 offset:8192
    v_mfma_f32_16x16x32_bf16 v[228:231], v[24:27], v[196:199], v[228:231]
    ds_read_b64_tr_b16 v[18:19], v244 offset:10240
    s_add_u32 s36, s31, 16384
    buffer_load_dwordx4 v[132:135], v1, s[4:7], s36 offen sc1
    s_waitcnt lgkmcnt(10)
    v_mfma_f32_16x16x32_bf16 v[232:235], v[28:31], v[192:195], v[232:235]
    ds_read_b64_tr_b16 v[20:21], v245 offset:8192
    v_mfma_f32_16x16x32_bf16 v[236:239], v[28:31], v[196:199], v[236:239]
    ds_read_b64_tr_b16 v[22:23], v245 offset:10240
    s_add_u32 m0, s35, 147456
    s_add_u32 s41, s28, 589952
    buffer_load_dwordx4 v6, s[20:23], s41 offen lds
    s_waitcnt vmcnt(8)
    s_mov_b32 m0, s46
    v_add_u32 v7, 1, v7
    ds_write_addtid_b32 v7
    s_setprio 0
    s_waitcnt lgkmcnt(11)
    v_mfma_f32_16x16x32_bf16 v[48:51], v[32:35], v[192:195], v[48:51]
    ds_read_b64_tr_b16 v[24:25], v246 offset:8192
    v_mfma_f32_16x16x32_bf16 v[52:55], v[32:35], v[196:199], v[52:55]
    ds_read_b64_tr_b16 v[26:27], v246 offset:10240
    s_waitcnt lgkmcnt(11)
    v_mfma_f32_16x16x32_bf16 v[56:59], v[36:39], v[192:195], v[56:59]
    ds_read_b64_tr_b16 v[28:29], v247 offset:8192
    v_mfma_f32_16x16x32_bf16 v[60:63], v[36:39], v[196:199], v[60:63]
    ds_read_b64_tr_b16 v[30:31], v247 offset:10240
    s_waitcnt lgkmcnt(11)
    v_mfma_f32_16x16x32_bf16 v[64:67], v[40:43], v[192:195], v[64:67]
    ds_read_b64_tr_b16 v[32:33], v244 offset:0
    v_mfma_f32_16x16x32_bf16 v[68:71], v[40:43], v[196:199], v[68:71]
    ds_read_b64_tr_b16 v[34:35], v244 offset:2048
    s_waitcnt lgkmcnt(11)
    v_mfma_f32_16x16x32_bf16 v[72:75], v[44:47], v[192:195], v[72:75]
    ds_read_b64_tr_b16 v[36:37], v245 offset:0
    v_mfma_f32_16x16x32_bf16 v[76:79], v[44:47], v[196:199], v[76:79]
    ds_read_b64_tr_b16 v[38:39], v245 offset:2048
    s_add_u32 m0, s35, 81920
    s_add_u32 s41, s28, 811008
    buffer_load_dwordx4 v6, s[20:23], s41 offen lds
    s_waitcnt lgkmcnt(11)
    v_mfma_f32_16x16x32_bf16 v[208:211], v[16:19], v[200:203], v[208:211]
    ds_read_b64_tr_b16 v[40:41], v246 offset:0
    v_mfma_f32_16x16x32_bf16 v[212:215], v[16:19], v[204:207], v[212:215]
    ds_read_b64_tr_b16 v[42:43], v246 offset:2048
    ds_read_b32 v8, v9
    s_waitcnt lgkmcnt(12)
    v_mfma_f32_16x16x32_bf16 v[216:219], v[20:23], v[200:203], v[216:219]
    ds_read_b64_tr_b16 v[44:45], v247 offset:0
    s_add_u32 s36, s30, 22528
    buffer_load_dwordx4 v[136:139], v1, s[4:7], s36 offen sc1
    v_mfma_f32_16x16x32_bf16 v[220:223], v[20:23], v[204:207], v[220:223]
    ds_read_b64_tr_b16 v[46:47], v247 offset:2048
    s_waitcnt lgkmcnt(11)
    v_mfma_f32_16x16x32_bf16 v[224:227], v[24:27], v[200:203], v[224:227]
    ds_read_b64_tr_b16 v[16:17], v240 offset:49152
    v_mfma_f32_16x16x32_bf16 v[228:231], v[24:27], v[204:207], v[228:231]
    ds_read_b64_tr_b16 v[18:19], v240 offset:51200
    s_add_u32 s36, s31, 22528
    buffer_load_dwordx4 v[140:143], v1, s[4:7], s36 offen sc1
    s_waitcnt lgkmcnt(11)
    v_mfma_f32_16x16x32_bf16 v[232:235], v[28:31], v[200:203], v[232:235]
    ds_read_b64_tr_b16 v[20:21], v241 offset:49152
    v_mfma_f32_16x16x32_bf16 v[236:239], v[28:31], v[204:207], v[236:239]
    ds_read_b64_tr_b16 v[22:23], v241 offset:51200
    s_add_u32 m0, s35, 73728
    s_add_u32 s41, s28, 811136
    buffer_load_dwordx4 v6, s[20:23], s41 offen lds
    s_waitcnt lgkmcnt(6)
    v_cmp_gt_i32 vcc, v7, v8
    s_cbranch_vccnz SBs_88
SBb_89:
    s_setprio 1
    v_mfma_f32_16x16x32_bf16 v[48:51], v[32:35], v[200:203], v[48:51]
    ds_read_b64_tr_b16 v[24:25], v242 offset:49152
    v_mfma_f32_16x16x32_bf16 v[52:55], v[32:35], v[204:207], v[52:55]
    ds_read_b64_tr_b16 v[26:27], v242 offset:51200
    v_mfma_f32_16x16x32_bf16 v[56:59], v[36:39], v[200:203], v[56:59]
    ds_read_b64_tr_b16 v[28:29], v243 offset:49152
    v_mfma_f32_16x16x32_bf16 v[60:63], v[36:39], v[204:207], v[60:63]
    ds_read_b64_tr_b16 v[30:31], v243 offset:51200
    v_mfma_f32_16x16x32_bf16 v[64:67], v[40:43], v[200:203], v[64:67]
    ds_read_b64_tr_b16 v[32:33], v240 offset:40960
    v_mfma_f32_16x16x32_bf16 v[68:71], v[40:43], v[204:207], v[68:71]
    ds_read_b64_tr_b16 v[34:35], v240 offset:43008
    s_waitcnt lgkmcnt(10)
    v_mfma_f32_16x16x32_bf16 v[72:75], v[44:47], v[200:203], v[72:75]
    ds_read_b64_tr_b16 v[36:37], v241 offset:40960
    v_mfma_f32_16x16x32_bf16 v[76:79], v[44:47], v[204:207], v[76:79]
    ds_read_b64_tr_b16 v[38:39], v241 offset:43008
    s_add_u32 m0, s35, 65536
    s_add_u32 s41, s28, 1032192
    buffer_load_dwordx4 v6, s[20:23], s41 offen lds
    s_waitcnt vmcnt(4)
    s_mov_b32 m0, s46
    v_add_u32 v7, 1, v7
    ds_write_addtid_b32 v7
    s_setprio 0
    s_waitcnt lgkmcnt(11)
    v_mfma_f32_16x16x32_bf16 v[208:211], v[16:19], v[112:115], v[208:211]
    ds_read_b64_tr_b16 v[40:41], v242 offset:40960
    v_mfma_f32_16x16x32_bf16 v[212:215], v[16:19], v[116:119], v[212:215]
    ds_read_b64_tr_b16 v[42:43], v242 offset:43008
    s_add_u32 s36, s30, 28672
    buffer_load_dwordx4 v[144:147], v1, s[4:7], s36 offen sc1
    s_waitcnt lgkmcnt(11)
    v_mfma_f32_16x16x32_bf16 v[216:219], v[20:23], v[112:115], v[216:219]
    ds_read_b64_tr_b16 v[44:45], v243 offset:40960
    v_mfma_f32_16x16x32_bf16 v[220:223], v[20:23], v[116:119], v[220:223]
    ds_read_b64_tr_b16 v[46:47], v243 offset:43008
    s_add_u32 s36, s31, 28672
    buffer_load_dwordx4 v[148:151], v1, s[4:7], s36 offen sc1
    s_waitcnt lgkmcnt(11)
    v_mfma_f32_16x16x32_bf16 v[224:227], v[24:27], v[112:115], v[224:227]
    ds_read_b64_tr_b16 v[16:17], v244 offset:24576
    v_mfma_f32_16x16x32_bf16 v[228:231], v[24:27], v[116:119], v[228:231]
    ds_read_b64_tr_b16 v[18:19], v244 offset:26624
    s_add_u32 m0, s35, 57344
    s_add_u32 s41, s28, 1032320
    buffer_load_dwordx4 v6, s[20:23], s41 offen lds
    s_waitcnt lgkmcnt(11)
    v_mfma_f32_16x16x32_bf16 v[232:235], v[28:31], v[112:115], v[232:235]
    ds_read_b64_tr_b16 v[20:21], v245 offset:24576
    v_mfma_f32_16x16x32_bf16 v[236:239], v[28:31], v[116:119], v[236:239]
    ds_read_b64_tr_b16 v[22:23], v245 offset:26624
    s_add_u32 m0, s35, 0
    s_add_u32 s41, s28, 1253376
    buffer_load_dwordx4 v6, s[20:23], s41 offen lds
    s_waitcnt lgkmcnt(11)
    v_mfma_f32_16x16x32_bf16 v[48:51], v[32:35], v[112:115], v[48:51]
    ds_read_b64_tr_b16 v[24:25], v246 offset:24576
    v_mfma_f32_16x16x32_bf16 v[52:55], v[32:35], v[116:119], v[52:55]
    ds_read_b64_tr_b16 v[26:27], v246 offset:26624
    ds_read_b32 v8, v9
    s_waitcnt lgkmcnt(12)
    v_mfma_f32_16x16x32_bf16 v[56:59], v[36:39], v[112:115], v[56:59]
    ds_read_b64_tr_b16 v[28:29], v247 offset:24576
    v_mfma_f32_16x16x32_bf16 v[60:63], v[36:39], v[116:119], v[60:63]
    ds_read_b64_tr_b16 v[30:31], v247 offset:26624
    s_add_u32 m0, s35, 8192
    s_add_u32 s41, s28, 1253504
    buffer_load_dwordx4 v6, s[20:23], s41 offen lds
    s_waitcnt lgkmcnt(11)
    v_mfma_f32_16x16x32_bf16 v[64:67], v[40:43], v[112:115], v[64:67]
    ds_read_b64_tr_b16 v[32:33], v244 offset:16384
    v_mfma_f32_16x16x32_bf16 v[68:71], v[40:43], v[116:119], v[68:71]
    ds_read_b64_tr_b16 v[34:35], v244 offset:18432
    s_waitcnt lgkmcnt(11)
    v_mfma_f32_16x16x32_bf16 v[72:75], v[44:47], v[112:115], v[72:75]
    ds_read_b64_tr_b16 v[36:37], v245 offset:16384
    v_mfma_f32_16x16x32_bf16 v[76:79], v[44:47], v[116:119], v[76:79]
    ds_read_b64_tr_b16 v[38:39], v245 offset:18432
    s_add_u32 m0, s35, 16384
    s_add_u32 s41, s28, 73984
    buffer_load_dwordx4 v6, s[20:23], s41 offen lds
    s_waitcnt lgkmcnt(6)
    v_cmp_gt_i32 vcc, v7, v8
    s_cbranch_vccnz SBs_90
SBb_91:
    s_setprio 1
    v_mfma_f32_16x16x32_bf16 v[208:211], v[16:19], v[120:123], v[208:211]
    ds_read_b64_tr_b16 v[40:41], v246 offset:16384
    v_mfma_f32_16x16x32_bf16 v[212:215], v[16:19], v[124:127], v[212:215]
    ds_read_b64_tr_b16 v[42:43], v246 offset:18432
    s_add_u32 s36, s30, 34816
    buffer_load_dwordx4 v[152:155], v1, s[4:7], s36 offen sc1
    v_mfma_f32_16x16x32_bf16 v[216:219], v[20:23], v[120:123], v[216:219]
    ds_read_b64_tr_b16 v[44:45], v247 offset:16384
    v_mfma_f32_16x16x32_bf16 v[220:223], v[20:23], v[124:127], v[220:223]
    ds_read_b64_tr_b16 v[46:47], v247 offset:18432
    s_add_u32 s36, s31, 34816
    buffer_load_dwordx4 v[156:159], v1, s[4:7], s36 offen sc1
    v_mfma_f32_16x16x32_bf16 v[224:227], v[24:27], v[120:123], v[224:227]
    ds_read_b64_tr_b16 v[16:17], v240 offset:32768
    v_mfma_f32_16x16x32_bf16 v[228:231], v[24:27], v[124:127], v[228:231]
    ds_read_b64_tr_b16 v[18:19], v240 offset:34816
    s_add_u32 m0, s35, 24576
    s_add_u32 s41, s28, 295168
    buffer_load_dwordx4 v6, s[20:23], s41 offen lds
    s_waitcnt lgkmcnt(10)
    v_mfma_f32_16x16x32_bf16 v[232:235], v[28:31], v[120:123], v[232:235]
    ds_read_b64_tr_b16 v[20:21], v241 offset:32768
    v_mfma_f32_16x16x32_bf16 v[236:239], v[28:31], v[124:127], v[236:239]
    ds_read_b64_tr_b16 v[22:23], v241 offset:34816
    s_add_u32 m0, s35, 32768
    s_add_u32 s41, s28, 516352
    buffer_load_dwordx4 v6, s[20:23], s41 offen lds
    s_waitcnt vmcnt(7)
    s_mov_b32 m0, s46
    v_add_u32 v7, 1, v7
    ds_write_addtid_b32 v7
    s_setprio 0
    s_waitcnt lgkmcnt(11)
    v_mfma_f32_16x16x32_bf16 v[48:51], v[32:35], v[120:123], v[48:51]
    ds_read_b64_tr_b16 v[24:25], v242 offset:32768
    v_mfma_f32_16x16x32_bf16 v[52:55], v[32:35], v[124:127], v[52:55]
    ds_read_b64_tr_b16 v[26:27], v242 offset:34816
    s_waitcnt lgkmcnt(11)
    v_mfma_f32_16x16x32_bf16 v[56:59], v[36:39], v[120:123], v[56:59]
    ds_read_b64_tr_b16 v[28:29], v243 offset:32768
    v_mfma_f32_16x16x32_bf16 v[60:63], v[36:39], v[124:127], v[60:63]
    ds_read_b64_tr_b16 v[30:31], v243 offset:34816
    s_add_u32 m0, s35, 40960
    s_add_u32 s41, s28, 737536
    buffer_load_dwordx4 v6, s[20:23], s41 offen lds
    s_waitcnt lgkmcnt(11)
    v_mfma_f32_16x16x32_bf16 v[64:67], v[40:43], v[120:123], v[64:67]
    ds_read_b64_tr_b16 v[32:33], v244 offset:32768
    v_mfma_f32_16x16x32_bf16 v[68:71], v[40:43], v[124:127], v[68:71]
    ds_read_b64_tr_b16 v[34:35], v244 offset:34816
    s_waitcnt lgkmcnt(11)
    v_mfma_f32_16x16x32_bf16 v[72:75], v[44:47], v[120:123], v[72:75]
    ds_read_b64_tr_b16 v[36:37], v245 offset:32768
    v_mfma_f32_16x16x32_bf16 v[76:79], v[44:47], v[124:127], v[76:79]
    ds_read_b64_tr_b16 v[38:39], v245 offset:34816
    s_add_u32 m0, s35, 49152
    s_add_u32 s41, s28, 958720
    buffer_load_dwordx4 v6, s[20:23], s41 offen lds
    s_waitcnt lgkmcnt(11)
    v_mfma_f32_16x16x32_bf16 v[208:211], v[16:19], v[128:131], v[208:211]
    ds_read_b64_tr_b16 v[40:41], v246 offset:32768
    v_mfma_f32_16x16x32_bf16 v[212:215], v[16:19], v[132:135], v[212:215]
    ds_read_b64_tr_b16 v[42:43], v246 offset:34816
    ds_read_b32 v8, v9
    s_waitcnt lgkmcnt(12)
    v_mfma_f32_16x16x32_bf16 v[216:219], v[20:23], v[128:131], v[216:219]
    ds_read_b64_tr_b16 v[44:45], v247 offset:32768
    v_mfma_f32_16x16x32_bf16 v[220:223], v[20:23], v[132:135], v[220:223]
    ds_read_b64_tr_b16 v[46:47], v247 offset:34816
    s_waitcnt lgkmcnt(11)
    v_mfma_f32_16x16x32_bf16 v[224:227], v[24:27], v[128:131], v[224:227]
    ds_read_b64_tr_b16 v[16:17], v240 offset:24576
    v_mfma_f32_16x16x32_bf16 v[228:231], v[24:27], v[132:135], v[228:231]
    ds_read_b64_tr_b16 v[18:19], v240 offset:26624
    s_waitcnt lgkmcnt(11)
    v_mfma_f32_16x16x32_bf16 v[232:235], v[28:31], v[128:131], v[232:235]
    ds_read_b64_tr_b16 v[20:21], v241 offset:24576
    v_mfma_f32_16x16x32_bf16 v[236:239], v[28:31], v[132:135], v[236:239]
    ds_read_b64_tr_b16 v[22:23], v241 offset:26624
    s_waitcnt lgkmcnt(6)
    v_cmp_gt_i32 vcc, v7, v8
    s_cbranch_vccnz SBs_92
SBb_93:
    s_setprio 1
    v_mfma_f32_16x16x32_bf16 v[48:51], v[32:35], v[128:131], v[48:51]
    ds_read_b64_tr_b16 v[24:25], v242 offset:24576
    v_mfma_f32_16x16x32_bf16 v[52:55], v[32:35], v[132:135], v[52:55]
    ds_read_b64_tr_b16 v[26:27], v242 offset:26624
    v_mfma_f32_16x16x32_bf16 v[56:59], v[36:39], v[128:131], v[56:59]
    ds_read_b64_tr_b16 v[28:29], v243 offset:24576
    v_mfma_f32_16x16x32_bf16 v[60:63], v[36:39], v[132:135], v[60:63]
    ds_read_b64_tr_b16 v[30:31], v243 offset:26624
    v_mfma_f32_16x16x32_bf16 v[64:67], v[40:43], v[128:131], v[64:67]
    ds_read_b64_tr_b16 v[32:33], v240 offset:16384
    v_mfma_f32_16x16x32_bf16 v[68:71], v[40:43], v[132:135], v[68:71]
    ds_read_b64_tr_b16 v[34:35], v240 offset:18432
    s_waitcnt lgkmcnt(10)
    v_mfma_f32_16x16x32_bf16 v[72:75], v[44:47], v[128:131], v[72:75]
    ds_read_b64_tr_b16 v[36:37], v241 offset:16384
    v_mfma_f32_16x16x32_bf16 v[76:79], v[44:47], v[132:135], v[76:79]
    ds_read_b64_tr_b16 v[38:39], v241 offset:18432
    s_waitcnt vmcnt(6)
    s_mov_b32 m0, s46
    v_add_u32 v7, 1, v7
    ds_write_addtid_b32 v7
    s_setprio 0
    s_waitcnt lgkmcnt(11)
    v_mfma_f32_16x16x32_bf16 v[208:211], v[16:19], v[136:139], v[208:211]
    ds_read_b64_tr_b16 v[40:41], v242 offset:16384
    v_mfma_f32_16x16x32_bf16 v[212:215], v[16:19], v[140:143], v[212:215]
    ds_read_b64_tr_b16 v[42:43], v242 offset:18432
    s_waitcnt lgkmcnt(11)
    v_mfma_f32_16x16x32_bf16 v[216:219], v[20:23], v[136:139], v[216:219]
    ds_read_b64_tr_b16 v[44:45], v243 offset:16384
    v_mfma_f32_16x16x32_bf16 v[220:223], v[20:23], v[140:143], v[220:223]
    ds_read_b64_tr_b16 v[46:47], v243 offset:18432
    s_waitcnt lgkmcnt(11)
    v_mfma_f32_16x16x32_bf16 v[224:227], v[24:27], v[136:139], v[224:227]
    ds_read_b64_tr_b16 v[16:17], v240 offset:8192
    v_mfma_f32_16x16x32_bf16 v[228:231], v[24:27], v[140:143], v[228:231]
    ds_read_b64_tr_b16 v[18:19], v240 offset:10240
    s_waitcnt lgkmcnt(11)
    v_mfma_f32_16x16x32_bf16 v[232:235], v[28:31], v[136:139], v[232:235]
    ds_read_b64_tr_b16 v[20:21], v241 offset:8192
    v_mfma_f32_16x16x32_bf16 v[236:239], v[28:31], v[140:143], v[236:239]
    ds_read_b64_tr_b16 v[22:23], v241 offset:10240
    s_waitcnt lgkmcnt(11)
    v_mfma_f32_16x16x32_bf16 v[48:51], v[32:35], v[136:139], v[48:51]
    ds_read_b64_tr_b16 v[24:25], v242 offset:8192
    v_mfma_f32_16x16x32_bf16 v[52:55], v[32:35], v[140:143], v[52:55]
    ds_read_b64_tr_b16 v[26:27], v242 offset:10240
    ds_read_b32 v8, v9
    s_waitcnt lgkmcnt(12)
    v_mfma_f32_16x16x32_bf16 v[56:59], v[36:39], v[136:139], v[56:59]
    ds_read_b64_tr_b16 v[28:29], v243 offset:8192
    v_mfma_f32_16x16x32_bf16 v[60:63], v[36:39], v[140:143], v[60:63]
    ds_read_b64_tr_b16 v[30:31], v243 offset:10240
    s_waitcnt lgkmcnt(11)
    v_mfma_f32_16x16x32_bf16 v[64:67], v[40:43], v[136:139], v[64:67]
    ds_read_b64_tr_b16 v[32:33], v240 offset:0
    v_mfma_f32_16x16x32_bf16 v[68:71], v[40:43], v[140:143], v[68:71]
    ds_read_b64_tr_b16 v[34:35], v240 offset:2048
    s_waitcnt lgkmcnt(11)
    v_mfma_f32_16x16x32_bf16 v[72:75], v[44:47], v[136:139], v[72:75]
    ds_read_b64_tr_b16 v[36:37], v241 offset:0
    v_mfma_f32_16x16x32_bf16 v[76:79], v[44:47], v[140:143], v[76:79]
    ds_read_b64_tr_b16 v[38:39], v241 offset:2048
    s_waitcnt lgkmcnt(6)
    v_cmp_gt_i32 vcc, v7, v8
    s_cbranch_vccnz SBs_94
SBb_95:
    s_setprio 1
    v_mfma_f32_16x16x32_bf16 v[208:211], v[16:19], v[144:147], v[208:211]
    ds_read_b64_tr_b16 v[40:41], v242 offset:0
    v_mfma_f32_16x16x32_bf16 v[212:215], v[16:19], v[148:151], v[212:215]
    ds_read_b64_tr_b16 v[42:43], v242 offset:2048
    v_mfma_f32_16x16x32_bf16 v[216:219], v[20:23], v[144:147], v[216:219]
    ds_read_b64_tr_b16 v[44:45], v243 offset:0
    v_mfma_f32_16x16x32_bf16 v[220:223], v[20:23], v[148:151], v[220:223]
    ds_read_b64_tr_b16 v[46:47], v243 offset:2048
    v_mfma_f32_16x16x32_bf16 v[224:227], v[24:27], v[144:147], v[224:227]
    ds_read_b64_tr_b16 v[16:17], v2 offset:0
    v_mfma_f32_16x16x32_bf16 v[228:231], v[24:27], v[148:151], v[228:231]
    ds_read_b64_tr_b16 v[18:19], v2 offset:2048
    s_waitcnt lgkmcnt(10)
    v_mfma_f32_16x16x32_bf16 v[232:235], v[28:31], v[144:147], v[232:235]
    ds_read_b64_tr_b16 v[20:21], v3 offset:0
    v_mfma_f32_16x16x32_bf16 v[236:239], v[28:31], v[148:151], v[236:239]
    ds_read_b64_tr_b16 v[22:23], v3 offset:2048
    s_add_u32 m0, s35, 81920
    s_add_u32 s41, s28, 1179904
    buffer_load_dwordx4 v6, s[20:23], s41 offen lds
    s_waitcnt vmcnt(1)
    s_mov_b32 m0, s46
    v_add_u32 v7, 1, v7
    ds_write_addtid_b32 v7
    s_setprio 0
    s_waitcnt lgkmcnt(11)
    v_mfma_f32_16x16x32_bf16 v[48:51], v[32:35], v[144:147], v[48:51]
    ds_read_b64_tr_b16 v[24:25], v4 offset:0
    v_mfma_f32_16x16x32_bf16 v[52:55], v[32:35], v[148:151], v[52:55]
    ds_read_b64_tr_b16 v[26:27], v4 offset:2048
    s_waitcnt lgkmcnt(11)
    v_mfma_f32_16x16x32_bf16 v[56:59], v[36:39], v[144:147], v[56:59]
    ds_read_b64_tr_b16 v[28:29], v5 offset:0
    v_mfma_f32_16x16x32_bf16 v[60:63], v[36:39], v[148:151], v[60:63]
    ds_read_b64_tr_b16 v[30:31], v5 offset:2048
    s_waitcnt lgkmcnt(11)
    v_mfma_f32_16x16x32_bf16 v[64:67], v[40:43], v[144:147], v[64:67]
    ds_read_b64_tr_b16 v[32:33], v2 offset:8192
    v_mfma_f32_16x16x32_bf16 v[68:71], v[40:43], v[148:151], v[68:71]
    ds_read_b64_tr_b16 v[34:35], v2 offset:10240
    s_waitcnt lgkmcnt(11)
    v_mfma_f32_16x16x32_bf16 v[72:75], v[44:47], v[144:147], v[72:75]
    ds_read_b64_tr_b16 v[36:37], v3 offset:8192
    v_mfma_f32_16x16x32_bf16 v[76:79], v[44:47], v[148:151], v[76:79]
    ds_read_b64_tr_b16 v[38:39], v3 offset:10240
    s_waitcnt lgkmcnt(11)
    v_mfma_f32_16x16x32_bf16 v[208:211], v[16:19], v[152:155], v[208:211]
    ds_read_b64_tr_b16 v[40:41], v4 offset:8192
    v_mfma_f32_16x16x32_bf16 v[212:215], v[16:19], v[156:159], v[212:215]
    ds_read_b64_tr_b16 v[42:43], v4 offset:10240
    ds_read_b32 v8, v9
    s_waitcnt lgkmcnt(12)
    v_mfma_f32_16x16x32_bf16 v[216:219], v[20:23], v[152:155], v[216:219]
    ds_read_b64_tr_b16 v[44:45], v5 offset:8192
    v_mfma_f32_16x16x32_bf16 v[220:223], v[20:23], v[156:159], v[220:223]
    ds_read_b64_tr_b16 v[46:47], v5 offset:10240
    s_waitcnt lgkmcnt(11)
    v_mfma_f32_16x16x32_bf16 v[224:227], v[24:27], v[152:155], v[224:227]
    ds_read_b64_tr_b16 v[16:17], v2 offset:16384
    v_mfma_f32_16x16x32_bf16 v[228:231], v[24:27], v[156:159], v[228:231]
    ds_read_b64_tr_b16 v[18:19], v2 offset:18432
    s_waitcnt lgkmcnt(11)
    v_mfma_f32_16x16x32_bf16 v[232:235], v[28:31], v[152:155], v[232:235]
    ds_read_b64_tr_b16 v[20:21], v3 offset:16384
    v_mfma_f32_16x16x32_bf16 v[236:239], v[28:31], v[156:159], v[236:239]
    ds_read_b64_tr_b16 v[22:23], v3 offset:18432
    s_waitcnt lgkmcnt(6)
    v_cmp_gt_i32 vcc, v7, v8
    s_cbranch_vccnz SBs_96
SBb_97:
    s_setprio 1
    v_mfma_f32_16x16x32_bf16 v[48:51], v[32:35], v[152:155], v[48:51]
    ds_read_b64_tr_b16 v[24:25], v4 offset:16384
    v_mfma_f32_16x16x32_bf16 v[52:55], v[32:35], v[156:159], v[52:55]
    ds_read_b64_tr_b16 v[26:27], v4 offset:18432
    v_mfma_f32_16x16x32_bf16 v[56:59], v[36:39], v[152:155], v[56:59]
    ds_read_b64_tr_b16 v[28:29], v5 offset:16384
    v_mfma_f32_16x16x32_bf16 v[60:63], v[36:39], v[156:159], v[60:63]
    ds_read_b64_tr_b16 v[30:31], v5 offset:18432
    s_add_u32 m0, s35, 57344
    s_add_u32 s41, s28, 147712
    buffer_load_dwordx4 v6, s[20:23], s41 offen lds
    v_mfma_f32_16x16x32_bf16 v[64:67], v[40:43], v[152:155], v[64:67]
    ds_read_b64_tr_b16 v[32:33], v2 offset:24576
    v_mfma_f32_16x16x32_bf16 v[68:71], v[40:43], v[156:159], v[68:71]
    ds_read_b64_tr_b16 v[34:35], v2 offset:26624
    s_waitcnt lgkmcnt(10)
    v_mfma_f32_16x16x32_bf16 v[72:75], v[44:47], v[152:155], v[72:75]
    ds_read_b64_tr_b16 v[36:37], v3 offset:24576
    v_mfma_f32_16x16x32_bf16 v[76:79], v[44:47], v[156:159], v[76:79]
    ds_read_b64_tr_b16 v[38:39], v3 offset:26624
    s_add_u32 m0, s35, 65536
    s_add_u32 s41, s28, 368896
    buffer_load_dwordx4 v6, s[20:23], s41 offen lds
    s_cmp_eq_u32 s42, 1
    s_cbranch_scc1 K2_ffn_h1
    s_waitcnt vmcnt(2)
    s_mov_b32 m0, s46
    v_add_u32 v7, 1, v7
    ds_write_addtid_b32 v7
    s_setprio 0
    s_waitcnt lgkmcnt(11)
    v_mfma_f32_16x16x32_bf16 v[80:83], v[16:19], v[160:163], v[80:83]
    ds_read_b64_tr_b16 v[40:41], v4 offset:24576
    v_mfma_f32_16x16x32_bf16 v[84:87], v[16:19], v[164:167], v[84:87]
    ds_read_b64_tr_b16 v[42:43], v4 offset:26624
    s_add_u32 m0, s35, 73728
    s_add_u32 s41, s28, 590080
    buffer_load_dwordx4 v6, s[20:23], s41 offen lds
    ds_read_b32 v8, v9
    s_waitcnt lgkmcnt(12)
    v_mfma_f32_16x16x32_bf16 v[88:91], v[20:23], v[160:163], v[88:91]
    ds_read_b64_tr_b16 v[44:45], v5 offset:24576
    v_mfma_f32_16x16x32_bf16 v[92:95], v[20:23], v[164:167], v[92:95]
    ds_read_b64_tr_b16 v[46:47], v5 offset:26624
    s_waitcnt lgkmcnt(12)
    v_mfma_f32_16x16x32_bf16 v[96:99], v[24:27], v[160:163], v[96:99]
    ds_read_b64_tr_b16 v[16:17], v2 offset:32768
    ds_write_b128 v11, v[48:51] offset:0
    v_mfma_f32_16x16x32_bf16 v[100:103], v[24:27], v[164:167], v[100:103]
    ds_read_b64_tr_b16 v[18:19], v2 offset:34816
    ds_write_b128 v11, v[52:55] offset:1024
    s_waitcnt lgkmcnt(14)
    v_mfma_f32_16x16x32_bf16 v[104:107], v[28:31], v[160:163], v[104:107]
    ds_read_b64_tr_b16 v[20:21], v3 offset:32768
    ds_write_b128 v11, v[56:59] offset:2048
    v_mfma_f32_16x16x32_bf16 v[108:111], v[28:31], v[164:167], v[108:111]
    ds_read_b64_tr_b16 v[22:23], v3 offset:34816
    ds_write_b128 v11, v[60:63] offset:3072
    s_waitcnt lgkmcnt(10)
    v_cmp_gt_i32 vcc, v7, v8
    s_cbranch_vccnz SBs_98
SBb_99:
    s_setprio 1
    v_mfma_f32_16x16x32_bf16 v[80:83], v[32:35], v[168:171], v[80:83]
    ds_read_b64_tr_b16 v[24:25], v4 offset:32768
    v_mfma_f32_16x16x32_bf16 v[84:87], v[32:35], v[172:175], v[84:87]
    ds_read_b64_tr_b16 v[26:27], v4 offset:34816
    s_add_u32 m0, s35, 0
    s_add_u32 s41, s28, 811264
    buffer_load_dwordx4 v6, s[20:23], s41 offen lds
    v_mfma_f32_16x16x32_bf16 v[88:91], v[36:39], v[168:171], v[88:91]
    ds_read_b64_tr_b16 v[28:29], v5 offset:32768
    s_add_u32 m0, s35, 8192
    s_add_u32 s41, s28, 1032448
    buffer_load_dwordx4 v6, s[20:23], s41 offen lds
    v_mfma_f32_16x16x32_bf16 v[92:95], v[36:39], v[172:175], v[92:95]
    ds_read_b64_tr_b16 v[30:31], v5 offset:34816
    ds_write_b128 v11, v[64:67] offset:4096
    v_mfma_f32_16x16x32_bf16 v[96:99], v[40:43], v[168:171], v[96:99]
    ds_read_b64_tr_b16 v[32:33], v2 offset:40960
    v_mfma_f32_16x16x32_bf16 v[100:103], v[40:43], v[172:175], v[100:103]
    ds_read_b64_tr_b16 v[34:35], v2 offset:43008
    ds_write_b128 v11, v[68:71] offset:5120
    s_waitcnt lgkmcnt(15)
    v_mfma_f32_16x16x32_bf16 v[104:107], v[44:47], v[168:171], v[104:107]
    ds_read_b64_tr_b16 v[36:37], v3 offset:40960
    ds_write_b128 v11, v[72:75] offset:6144
    v_mfma_f32_16x16x32_bf16 v[108:111], v[44:47], v[172:175], v[108:111]
    ds_read_b64_tr_b16 v[38:39], v3 offset:43008
    ds_write_b128 v11, v[76:79] offset:7168
    s_waitcnt vmcnt(2)
    s_mov_b32 m0, s46
    v_add_u32 v7, 1, v7
    ds_write_addtid_b32 v7
    s_setprio 0
    s_waitcnt lgkmcnt(15)
    v_mfma_f32_16x16x32_bf16 v[80:83], v[16:19], v[176:179], v[80:83]
    ds_read_b64_tr_b16 v[40:41], v4 offset:40960
    s_add_u32 m0, s35, 16384
    s_add_u32 s41, s28, 1253632
    buffer_load_dwordx4 v6, s[20:23], s41 offen lds
    v_mfma_f32_16x16x32_bf16 v[84:87], v[16:19], v[180:183], v[84:87]
    ds_read_b64_tr_b16 v[42:43], v4 offset:43008
    v_mov_b32 v160, 0
    v_mov_b32 v161, 0
    ds_read_b32 v8, v9
    s_waitcnt lgkmcnt(15)
    v_mfma_f32_16x16x32_bf16 v[88:91], v[20:23], v[176:179], v[88:91]
    ds_read_b64_tr_b16 v[44:45], v5 offset:40960
    v_mov_b32 v162, 0
    v_mov_b32 v163, 0
    v_mfma_f32_16x16x32_bf16 v[92:95], v[20:23], v[180:183], v[92:95]
    ds_read_b64_tr_b16 v[46:47], v5 offset:43008
    v_mov_b32 v164, 0
    v_mov_b32 v165, 0
    s_waitcnt lgkmcnt(15)
    v_mfma_f32_16x16x32_bf16 v[96:99], v[24:27], v[176:179], v[96:99]
    ds_read_b64_tr_b16 v[16:17], v2 offset:49152
    v_mov_b32 v166, 0
    v_mov_b32 v167, 0
    v_mfma_f32_16x16x32_bf16 v[100:103], v[24:27], v[180:183], v[100:103]
    ds_read_b64_tr_b16 v[18:19], v2 offset:51200
    v_mov_b32 v168, 0
    v_mov_b32 v169, 0
    s_waitcnt lgkmcnt(15)
    v_mfma_f32_16x16x32_bf16 v[104:107], v[28:31], v[176:179], v[104:107]
    ds_read_b64_tr_b16 v[20:21], v3 offset:49152
    v_mov_b32 v170, 0
    v_mov_b32 v171, 0
    v_mfma_f32_16x16x32_bf16 v[108:111], v[28:31], v[180:183], v[108:111]
    ds_read_b64_tr_b16 v[22:23], v3 offset:51200
    v_mov_b32 v172, 0
    v_mov_b32 v173, 0
    v_mov_b32 v174, 0
    v_mov_b32 v175, 0
    s_waitcnt lgkmcnt(6)
    v_cmp_gt_i32 vcc, v7, v8
    s_cbranch_vccnz SBs_100
SBb_101:
    s_setprio 1
    v_mfma_f32_16x16x32_bf16 v[80:83], v[32:35], v[184:187], v[80:83]
    ds_read_b64_tr_b16 v[24:25], v4 offset:49152
    ds_read_b128 v[48:51], v12 offset:0
    v_mfma_f32_16x16x32_bf16 v[84:87], v[32:35], v[188:191], v[84:87]
    ds_read_b64_tr_b16 v[26:27], v4 offset:51200
    ds_read_b128 v[52:55], v12 offset:1024
    v_mfma_f32_16x16x32_bf16 v[88:91], v[36:39], v[184:187], v[88:91]
    ds_read_b64_tr_b16 v[28:29], v5 offset:49152
    ds_read_b128 v[56:59], v12 offset:2048
    v_mfma_f32_16x16x32_bf16 v[92:95], v[36:39], v[188:191], v[92:95]
    ds_read_b64_tr_b16 v[30:31], v5 offset:51200
    ds_read_b128 v[60:63], v12 offset:3072
    v_mfma_f32_16x16x32_bf16 v[96:99], v[40:43], v[184:187], v[96:99]
    ds_read_b64_tr_b16 v[32:33], v240 offset:24576
    ds_read_b128 v[64:67], v12 offset:4096
    v_mfma_f32_16x16x32_bf16 v[100:103], v[40:43], v[188:191], v[100:103]
    ds_read_b64_tr_b16 v[34:35], v240 offset:26624
    ds_read_b128 v[68:71], v12 offset:5120
    s_waitcnt lgkmcnt(15)
    v_mfma_f32_16x16x32_bf16 v[104:107], v[44:47], v[184:187], v[104:107]
    ds_read_b64_tr_b16 v[36:37], v241 offset:24576
    ds_read_b128 v[72:75], v12 offset:6144
    v_mfma_f32_16x16x32_bf16 v[108:111], v[44:47], v[188:191], v[108:111]
    ds_read_b64_tr_b16 v[38:39], v241 offset:26624
    ds_read_b128 v[76:79], v12 offset:7168
    s_load_dwordx2 s[52:53], s[0:1], 104
    s_load_dwordx2 s[28:29], s[0:1], 0
    s_load_dwordx2 s[30:31], s[0:1], 64
    s_waitcnt lgkmcnt(15)
    v_mfma_f32_16x16x32_bf16 v[80:83], v[16:19], v[192:195], v[80:83]
    ds_read_b64_tr_b16 v[40:41], v242 offset:24576
    s_waitcnt lgkmcnt(15)
    v_add_f32 v208, v208, v48
    v_add_f32 v209, v209, v49
    v_mfma_f32_16x16x32_bf16 v[84:87], v[16:19], v[196:199], v[84:87]
    ds_read_b64_tr_b16 v[42:43], v242 offset:26624
    v_add_f32 v210, v210, v50
    v_add_f32 v211, v211, v51
    v_mfma_f32_16x16x32_bf16 v[88:91], v[20:23], v[192:195], v[88:91]
    ds_read_b64_tr_b16 v[44:45], v243 offset:24576
    s_waitcnt lgkmcnt(15)
    v_add_f32 v212, v212, v52
    v_add_f32 v213, v213, v53
    v_mfma_f32_16x16x32_bf16 v[92:95], v[20:23], v[196:199], v[92:95]
    ds_read_b64_tr_b16 v[46:47], v243 offset:26624
    v_add_f32 v214, v214, v54
    v_add_f32 v215, v215, v55
    v_mfma_f32_16x16x32_bf16 v[96:99], v[24:27], v[192:195], v[96:99]
    ds_read_b64_tr_b16 v[16:17], v240 offset:0
    s_waitcnt lgkmcnt(15)
    v_add_f32 v216, v216, v56
    v_add_f32 v217, v217, v57
    v_mfma_f32_16x16x32_bf16 v[100:103], v[24:27], v[196:199], v[100:103]
    ds_read_b64_tr_b16 v[18:19], v240 offset:2048
    v_add_f32 v218, v218, v58
    v_add_f32 v219, v219, v59
    s_waitcnt lgkmcnt(15)
    v_mfma_f32_16x16x32_bf16 v[104:107], v[28:31], v[192:195], v[104:107]
    ds_read_b64_tr_b16 v[20:21], v241 offset:0
    s_waitcnt lgkmcnt(15)
    v_add_f32 v220, v220, v60
    v_add_f32 v221, v221, v61
    v_mfma_f32_16x16x32_bf16 v[108:111], v[28:31], v[196:199], v[108:111]
    ds_read_b64_tr_b16 v[22:23], v241 offset:2048
    v_add_f32 v222, v222, v62
    v_add_f32 v223, v223, v63
    s_waitcnt vmcnt(0)
    s_mov_b32 m0, s46
    v_add_u32 v7, 1, v7
    ds_write_addtid_b32 v7
    s_setprio 0
    s_waitcnt lgkmcnt(14)
    v_mfma_f32_16x16x32_bf16 v[80:83], v[32:35], v[200:203], v[80:83]
    ds_read_b64_tr_b16 v[24:25], v242 offset:0
    v_mfma_f32_16x16x32_bf16 v[84:87], v[32:35], v[204:207], v[84:87]
    ds_read_b64_tr_b16 v[26:27], v242 offset:2048
    v_cvt_pk_bf16_f32 v48, v208, v209
    v_cvt_pk_bf16_f32 v49, v210, v211
    s_waitcnt lgkmcnt(12)
    v_mfma_f32_16x16x32_bf16 v[88:91], v[36:39], v[200:203], v[88:91]
    ds_read_b64_tr_b16 v[28:29], v243 offset:0
    v_cvt_pk_bf16_f32 v50, v216, v217
    v_cvt_pk_bf16_f32 v51, v218, v219
    v_mfma_f32_16x16x32_bf16 v[92:95], v[36:39], v[204:207], v[92:95]
    ds_read_b64_tr_b16 v[30:31], v243 offset:2048
    s_cmp_eq_u32 s49, 0
    s_cselect_b32 s44, 0x7ff00000, s54
    buffer_store_dwordx4 v[48:51], v1, s[4:7], s44 offen offset:0 sc1
    s_cbranch_scc0 K2_nx_102
    v_add_f32 v160, v160, v208
    v_add_f32 v161, v161, v209
    v_add_f32 v162, v162, v210
    v_add_f32 v163, v163, v211
    v_add_f32 v164, v164, v216
    v_add_f32 v165, v165, v217
    v_add_f32 v166, v166, v218
    v_add_f32 v167, v167, v219
K2_nx_102:
    s_waitcnt lgkmcnt(11)
    v_mfma_f32_16x16x32_bf16 v[96:99], v[40:43], v[200:203], v[96:99]
    ds_read_b64_tr_b16 v[32:33], v240 offset:8192
    v_mfma_f32_16x16x32_bf16 v[100:103], v[40:43], v[204:207], v[100:103]
    ds_read_b64_tr_b16 v[34:35], v240 offset:10240
    v_cvt_pk_bf16_f32 v52, v212, v213
    v_cvt_pk_bf16_f32 v53, v214, v215
    s_waitcnt lgkmcnt(11)
    v_mfma_f32_16x16x32_bf16 v[104:107], v[44:47], v[200:203], v[104:107]
    ds_read_b64_tr_b16 v[36:37], v241 offset:8192
    v_cvt_pk_bf16_f32 v54, v220, v221
    v_cvt_pk_bf16_f32 v55, v222, v223
    v_mfma_f32_16x16x32_bf16 v[108:111], v[44:47], v[204:207], v[108:111]
    ds_read_b64_tr_b16 v[38:39], v241 offset:10240
    s_cmp_eq_u32 s49, 1
    s_cselect_b32 s44, 0x7ff00000, s54
    buffer_store_dwordx4 v[52:55], v1, s[4:7], s44 offen offset:1024 sc1
    s_cbranch_scc0 K2_nx_103
    v_add_f32 v160, v160, v212
    v_add_f32 v161, v161, v213
    v_add_f32 v162, v162, v214
    v_add_f32 v163, v163, v215
    v_add_f32 v164, v164, v220
    v_add_f32 v165, v165, v221
    v_add_f32 v166, v166, v222
    v_add_f32 v167, v167, v223
K2_nx_103:
    s_waitcnt lgkmcnt(11)
    v_mfma_f32_16x16x32_bf16 v[80:83], v[16:19], v[112:115], v[80:83]
    ds_read_b64_tr_b16 v[40:41], v242 offset:8192
    v_add_f32 v224, v224, v64
    v_add_f32 v225, v225, v65
    v_add_f32 v226, v226, v66
    v_add_f32 v227, v227, v67
    v_add_f32 v228, v228, v68
    v_add_f32 v229, v229, v69
    v_mfma_f32_16x16x32_bf16 v[84:87], v[16:19], v[116:119], v[84:87]
    ds_read_b64_tr_b16 v[42:43], v242 offset:10240
    v_add_f32 v230, v230, v70
    v_add_f32 v231, v231, v71
    v_add_f32 v232, v232, v72
    v_add_f32 v233, v233, v73
    v_add_f32 v234, v234, v74
    v_add_f32 v235, v235, v75
    ds_read_b32 v8, v9
    s_waitcnt lgkmcnt(12)
    v_mfma_f32_16x16x32_bf16 v[88:91], v[20:23], v[112:115], v[88:91]
    ds_read_b64_tr_b16 v[44:45], v243 offset:8192
    v_add_f32 v236, v236, v76
    v_add_f32 v237, v237, v77
    v_add_f32 v238, v238, v78
    v_add_f32 v239, v239, v79
    v_lshrrev_b32 v176, 1, v10
    v_mfma_f32_16x16x32_bf16 v[92:95], v[20:23], v[116:119], v[92:95]
    ds_read_b64_tr_b16 v[46:47], v243 offset:10240
    v_lshrrev_b32 v179, 4, v0
    v_lshlrev_b32 v177, 3, v179
    v_lshrrev_b32 v178, 1, v179
    v_lshlrev_b32 v178, 8, v178
    s_waitcnt lgkmcnt(11)
    v_mfma_f32_16x16x32_bf16 v[96:99], v[24:27], v[112:115], v[96:99]
    ds_read_b64_tr_b16 v[16:17], v240 offset:16384
    v_and_b32 v180, 15, v0
    v_lshl_add_u32 v178, v180, 4, v178
    v_and_b32 v180, 1, v179
    v_mfma_f32_16x16x32_bf16 v[100:103], v[24:27], v[116:119], v[100:103]
    ds_read_b64_tr_b16 v[18:19], v240 offset:18432
    v_lshl_add_u32 v178, v180, 3, v178
    s_mul_i32 s32, s99, 6
    s_lshl_b32 s33, s42, 1
    s_waitcnt lgkmcnt(11)
    v_mfma_f32_16x16x32_bf16 v[104:107], v[28:31], v[112:115], v[104:107]
    ds_read_b64_tr_b16 v[20:21], v241 offset:16384
    s_add_u32 s34, s32, s33
    s_lshr_b32 s33, s49, 1
    s_add_u32 s34, s34, s33
    v_mfma_f32_16x16x32_bf16 v[108:111], v[28:31], v[116:119], v[108:111]
    ds_read_b64_tr_b16 v[22:23], v241 offset:18432
    s_add_u32 s35, s32, s42
    s_add_u32 s35, s35, 4
    s_lshl_b32 s32, s98, 2
    s_and_b32 s33, s16, 3
    s_waitcnt lgkmcnt(6)
    v_cmp_gt_i32 vcc, v7, v8
    s_cbranch_vccnz SBs_104
SBb_105:
    s_setprio 1
    v_mfma_f32_16x16x32_bf16 v[80:83], v[32:35], v[120:123], v[80:83]
    ds_read_b64_tr_b16 v[24:25], v242 offset:16384
    v_cvt_pk_bf16_f32 v64, v224, v225
    v_cvt_pk_bf16_f32 v65, v226, v227
    v_cvt_pk_bf16_f32 v66, v232, v233
    v_cvt_pk_bf16_f32 v67, v234, v235
    v_mfma_f32_16x16x32_bf16 v[84:87], v[32:35], v[124:127], v[84:87]
    ds_read_b64_tr_b16 v[26:27], v242 offset:18432
    s_cmp_eq_u32 s49, 2
    s_cselect_b32 s44, 0x7ff00000, s54
    buffer_store_dwordx4 v[64:67], v1, s[4:7], s44 offen offset:2048 sc1
    s_cbranch_scc0 K2_nx_106
    v_add_f32 v160, v160, v224
    v_add_f32 v161, v161, v225
    v_add_f32 v162, v162, v226
    v_add_f32 v163, v163, v227
    v_add_f32 v164, v164, v232
    v_add_f32 v165, v165, v233
    v_add_f32 v166, v166, v234
    v_add_f32 v167, v167, v235
K2_nx_106:
    v_cvt_pk_bf16_f32 v68, v228, v229
    v_cvt_pk_bf16_f32 v69, v230, v231
    v_cvt_pk_bf16_f32 v70, v236, v237
    v_cvt_pk_bf16_f32 v71, v238, v239
    v_mfma_f32_16x16x32_bf16 v[88:91], v[36:39], v[120:123], v[88:91]
    ds_read_b64_tr_b16 v[28:29], v243 offset:16384
    s_cmp_eq_u32 s49, 3
    s_cselect_b32 s44, 0x7ff00000, s55
    buffer_store_dwordx4 v[68:71], v1, s[4:7], s44 offen offset:0 sc1
    s_cbranch_scc0 K2_nx_107
    v_add_f32 v160, v160, v228
    v_add_f32 v161, v161, v229
    v_add_f32 v162, v162, v230
    v_add_f32 v163, v163, v231
    v_add_f32 v164, v164, v236
    v_add_f32 v165, v165, v237
    v_add_f32 v166, v166, v238
    v_add_f32 v167, v167, v239
K2_nx_107:
    s_add_u32 s32, s32, s33
    s_mul_i32 s32, s32, 36
    v_mfma_f32_16x16x32_bf16 v[92:95], v[36:39], v[124:127], v[92:95]
    ds_read_b64_tr_b16 v[30:31], v243 offset:18432
    s_and_b32 s33, s49, 1
    s_mul_i32 s33, s33, 18
    s_add_u32 s36, s32, s33
    v_mfma_f32_16x16x32_bf16 v[96:99], v[40:43], v[120:123], v[96:99]
    ds_read_b64_tr_b16 v[32:33], v2 offset:0
    s_add_u32 s36, s36, s34
    s_lshl_b32 s36, s36, 10
    s_cmp_eq_u32 s49, 0
    s_cselect_b32 s33, 18, 0
    v_mfma_f32_16x16x32_bf16 v[100:103], v[40:43], v[124:127], v[100:103]
    ds_read_b64_tr_b16 v[34:35], v2 offset:2048
    s_add_u32 s37, s32, s33
    s_add_u32 s37, s37, s35
    s_lshl_b32 s37, s37, 10
    s_waitcnt lgkmcnt(10)
    v_mfma_f32_16x16x32_bf16 v[104:107], v[44:47], v[120:123], v[104:107]
    ds_read_b64_tr_b16 v[36:37], v3 offset:0
    s_lshl_b32 s34, s34, 6
    s_lshl_b32 s35, s35, 6
    s_lshr_b32 s38, s60, 1
    v_mfma_f32_16x16x32_bf16 v[108:111], v[44:47], v[124:127], v[108:111]
    ds_read_b64_tr_b16 v[38:39], v3 offset:2048
    s_lshr_b32 s39, s61, 1
    s_cmp_eq_u32 s49, 4
    s_cselect_b32 s36, 0x7ff00000, s36
    s_and_b32 s33, s49, 3
    s_cselect_b32 s37, 0x7ff00000, s37
    s_waitcnt lgkmcnt(10)
    v_mfma_f32_16x16x32_bf16 v[80:83], v[16:19], v[128:131], v[80:83]
    ds_read_b64_tr_b16 v[40:41], v4 offset:0
    v_mfma_f32_16x16x32_bf16 v[84:87], v[16:19], v[132:135], v[84:87]
    ds_read_b64_tr_b16 v[42:43], v4 offset:2048
    s_waitcnt lgkmcnt(0)
    s_mov_b32 s8, s52
    s_mov_b32 s9, s53
    s_mov_b32 s10, 4718592
    s_mov_b32 s11, 0x20000
    s_mov_b32 s12, s28
    s_mov_b32 s13, s29
    s_mov_b32 s14, 2359296
    s_mov_b32 s15, 0x20000
    s_mov_b32 s20, s30
    s_mov_b32 s21, s31
    s_mov_b32 s22, 1152
    s_mov_b32 s23, 0x20000
    v_mfma_f32_16x16x32_bf16 v[88:91], v[20:23], v[128:131], v[88:91]
    ds_read_b64_tr_b16 v[44:45], v5 offset:0
    buffer_load_dwordx2 v[184:185], v176, s[12:15], s38 offen offset:0
    v_mfma_f32_16x16x32_bf16 v[92:95], v[20:23], v[132:135], v[92:95]
    ds_read_b64_tr_b16 v[46:47], v5 offset:2048
    buffer_load_dwordx2 v[186:187], v178, s[4:7], s36 offen offset:0 sc1
    v_mfma_f32_16x16x32_bf16 v[96:99], v[24:27], v[128:131], v[96:99]
    ds_read_b64_tr_b16 v[16:17], v2 offset:8192
    buffer_load_dwordx2 v[188:189], v177, s[20:23], s34 offen offset:0
    v_mfma_f32_16x16x32_bf16 v[100:103], v[24:27], v[132:135], v[100:103]
    ds_read_b64_tr_b16 v[18:19], v2 offset:10240
    buffer_load_dwordx2 v[190:191], v176, s[12:15], s38 offen offset:32
    v_mfma_f32_16x16x32_bf16 v[104:107], v[28:31], v[128:131], v[104:107]
    ds_read_b64_tr_b16 v[20:21], v3 offset:8192
    buffer_load_dwordx2 v[192:193], v178, s[4:7], s36 offen offset:512 sc1
    v_mfma_f32_16x16x32_bf16 v[108:111], v[28:31], v[132:135], v[108:111]
    ds_read_b64_tr_b16 v[22:23], v3 offset:10240
    buffer_load_dwordx2 v[194:195], v177, s[20:23], s34 offen offset:32
    v_mfma_f32_16x16x32_bf16 v[80:83], v[32:35], v[136:139], v[80:83]
    ds_read_b64_tr_b16 v[24:25], v4 offset:8192
    v_mfma_f32_16x16x32_bf16 v[84:87], v[32:35], v[140:143], v[84:87]
    ds_read_b64_tr_b16 v[26:27], v4 offset:10240
    buffer_load_dwordx2 v[196:197], v176, s[12:15], s39 offen offset:0
    v_mfma_f32_16x16x32_bf16 v[88:91], v[36:39], v[136:139], v[88:91]
    ds_read_b64_tr_b16 v[28:29], v5 offset:8192
    buffer_load_dwordx2 v[198:199], v178, s[4:7], s37 offen offset:0 sc1
    v_mfma_f32_16x16x32_bf16 v[92:95], v[36:39], v[140:143], v[92:95]
    ds_read_b64_tr_b16 v[30:31], v5 offset:10240
    buffer_load_dwordx2 v[200:201], v177, s[20:23], s35 offen offset:0
    v_mfma_f32_16x16x32_bf16 v[96:99], v[40:43], v[136:139], v[96:99]
    ds_read_b64_tr_b16 v[32:33], v2 offset:16384
    v_mfma_f32_16x16x32_bf16 v[100:103], v[40:43], v[140:143], v[100:103]
    ds_read_b64_tr_b16 v[34:35], v2 offset:18432
    buffer_load_dwordx2 v[202:203], v176, s[12:15], s39 offen offset:32
    s_waitcnt lgkmcnt(10)
    v_mfma_f32_16x16x32_bf16 v[104:107], v[44:47], v[136:139], v[104:107]
    ds_read_b64_tr_b16 v[36:37], v3 offset:16384
    buffer_load_dwordx2 v[204:205], v178, s[4:7], s37 offen offset:512 sc1
    v_mfma_f32_16x16x32_bf16 v[108:111], v[44:47], v[140:143], v[108:111]
    ds_read_b64_tr_b16 v[38:39], v3 offset:18432
    buffer_load_dwordx2 v[206:207], v177, s[20:23], s35 offen offset:32
    s_waitcnt lgkmcnt(10)
    v_mfma_f32_16x16x32_bf16 v[80:83], v[16:19], v[144:147], v[80:83]
    ds_read_b64_tr_b16 v[40:41], v4 offset:16384
    v_mfma_f32_16x16x32_bf16 v[84:87], v[16:19], v[148:151], v[84:87]
    ds_read_b64_tr_b16 v[42:43], v4 offset:18432
    s_waitcnt lgkmcnt(10)
    v_mfma_f32_16x16x32_bf16 v[88:91], v[20:23], v[144:147], v[88:91]
    ds_read_b64_tr_b16 v[44:45], v5 offset:16384
    v_mfma_f32_16x16x32_bf16 v[92:95], v[20:23], v[148:151], v[92:95]
    ds_read_b64_tr_b16 v[46:47], v5 offset:18432
    s_waitcnt lgkmcnt(10)
    v_mfma_f32_16x16x32_bf16 v[96:99], v[24:27], v[144:147], v[96:99]
    v_mfma_f32_16x16x32_bf16 v[100:103], v[24:27], v[148:151], v[100:103]
    s_waitcnt lgkmcnt(8)
    v_mfma_f32_16x16x32_bf16 v[104:107], v[28:31], v[144:147], v[104:107]
    v_mfma_f32_16x16x32_bf16 v[108:111], v[28:31], v[148:151], v[108:111]
    s_waitcnt lgkmcnt(6)
    v_mfma_f32_16x16x32_bf16 v[80:83], v[32:35], v[152:155], v[80:83]
    v_mfma_f32_16x16x32_bf16 v[84:87], v[32:35], v[156:159], v[84:87]
    s_waitcnt lgkmcnt(4)
    v_mfma_f32_16x16x32_bf16 v[88:91], v[36:39], v[152:155], v[88:91]
    v_mfma_f32_16x16x32_bf16 v[92:95], v[36:39], v[156:159], v[92:95]
    s_waitcnt lgkmcnt(2)
    v_mfma_f32_16x16x32_bf16 v[96:99], v[40:43], v[152:155], v[96:99]
    v_mfma_f32_16x16x32_bf16 v[100:103], v[40:43], v[156:159], v[100:103]
    s_waitcnt lgkmcnt(0)
    v_mfma_f32_16x16x32_bf16 v[104:107], v[44:47], v[152:155], v[104:107]
    v_mfma_f32_16x16x32_bf16 v[108:111], v[44:47], v[156:159], v[108:111]
    s_nop 7
    ds_write_b128 v11, v[96:99] offset:0
    ds_write_b128 v11, v[100:103] offset:1024
    ds_write_b128 v11, v[104:107] offset:2048
    ds_write_b128 v11, v[108:111] offset:3072
    s_waitcnt lgkmcnt(0)
    s_barrier
    ds_read_b128 v[96:99], v12 offset:0
    ds_read_b128 v[100:103], v12 offset:1024
    ds_read_b128 v[104:107], v12 offset:2048
    ds_read_b128 v[108:111], v12 offset:3072
    s_waitcnt lgkmcnt(3)
    v_add_f32 v80, v80, v96
    v_add_f32 v81, v81, v97
    v_add_f32 v82, v82, v98
    v_add_f32 v83, v83, v99
    s_waitcnt lgkmcnt(2)
    v_add_f32 v84, v84, v100
    v_add_f32 v85, v85, v101
    v_add_f32 v86, v86, v102
    v_add_f32 v87, v87, v103
    s_waitcnt lgkmcnt(1)
    v_add_f32 v88, v88, v104
    v_add_f32 v89, v89, v105
    v_add_f32 v90, v90, v106
    v_add_f32 v91, v91, v107
    s_waitcnt lgkmcnt(0)
    v_add_f32 v92, v92, v108
    v_add_f32 v93, v93, v109
    v_add_f32 v94, v94, v110
    v_add_f32 v95, v95, v111
    v_cvt_pk_bf16_f32 v96, v80, v81
    v_cvt_pk_bf16_f32 v97, v82, v83
    v_cvt_pk_bf16_f32 v98, v88, v89
    v_cvt_pk_bf16_f32 v99, v90, v91
    s_cmp_eq_u32 s49, 4
    s_cselect_b32 s44, 0x7ff00000, s55
    buffer_store_dwordx4 v[96:99], v1, s[4:7], s44 offen offset:1024 sc1
    s_cbranch_scc0 K2_nx_108
    v_add_f32 v168, v168, v80
    v_add_f32 v169, v169, v81
    v_add_f32 v170, v170, v82
    v_add_f32 v171, v171, v83
    v_add_f32 v172, v172, v88
    v_add_f32 v173, v173, v89
    v_add_f32 v174, v174, v90
    v_add_f32 v175, v175, v91
K2_nx_108:
    v_cvt_pk_bf16_f32 v100, v84, v85
    v_cvt_pk_bf16_f32 v101, v86, v87
    v_cvt_pk_bf16_f32 v102, v92, v93
    v_cvt_pk_bf16_f32 v103, v94, v95
    s_cmp_eq_u32 s49, 0
    s_cselect_b32 s44, 0x7ff00000, s55
    buffer_store_dwordx4 v[100:103], v1, s[4:7], s44 offen offset:2048 sc1
    s_cbranch_scc0 K2_nx_109
    v_add_f32 v168, v168, v84
    v_add_f32 v169, v169, v85
    v_add_f32 v170, v170, v86
    v_add_f32 v171, v171, v87
    v_add_f32 v172, v172, v92
    v_add_f32 v173, v173, v93
    v_add_f32 v174, v174, v94
    v_add_f32 v175, v175, v95
K2_nx_109:
    s_branch K2_fin
K2_ffn_h1:
    s_waitcnt vmcnt(2)
    s_mov_b32 m0, s46
    v_add_u32 v7, 1, v7
    ds_write_addtid_b32 v7
    s_setprio 0
    s_waitcnt lgkmcnt(11)
    v_mfma_f32_16x16x32_bf16 v[80:83], v[16:19], v[160:163], v[80:83]
    ds_read_b64_tr_b16 v[40:41], v4 offset:24576
    v_mfma_f32_16x16x32_bf16 v[84:87], v[16:19], v[164:167], v[84:87]
    ds_read_b64_tr_b16 v[42:43], v4 offset:26624
    s_add_u32 m0, s35, 73728
    s_add_u32 s41, s28, 590080
    buffer_load_dwordx4 v6, s[20:23], s41 offen lds
    ds_read_b32 v8, v9
    s_waitcnt lgkmcnt(12)
    v_mfma_f32_16x16x32_bf16 v[88:91], v[20:23], v[160:163], v[88:91]
    ds_read_b64_tr_b16 v[44:45], v5 offset:24576
    v_mfma_f32_16x16x32_bf16 v[92:95], v[20:23], v[164:167], v[92:95]
    ds_read_b64_tr_b16 v[46:47], v5 offset:26624
    s_waitcnt lgkmcnt(12)
    v_mfma_f32_16x16x32_bf16 v[96:99], v[24:27], v[160:163], v[96:99]
    ds_read_b64_tr_b16 v[16:17], v2 offset:32768
    ds_write_b128 v11, v[208:211] offset:0
    v_mfma_f32_16x16x32_bf16 v[100:103], v[24:27], v[164:167], v[100:103]
    ds_read_b64_tr_b16 v[18:19], v2 offset:34816
    ds_write_b128 v11, v[212:215] offset:1024
    s_waitcnt lgkmcnt(14)
    v_mfma_f32_16x16x32_bf16 v[104:107], v[28:31], v[160:163], v[104:107]
    ds_read_b64_tr_b16 v[20:21], v3 offset:32768
    ds_write_b128 v11, v[216:219] offset:2048
    v_mfma_f32_16x16x32_bf16 v[108:111], v[28:31], v[164:167], v[108:111]
    ds_read_b64_tr_b16 v[22:23], v3 offset:34816
    ds_write_b128 v11, v[220:223] offset:3072
    s_waitcnt lgkmcnt(10)
    v_cmp_gt_i32 vcc, v7, v8
    s_cbranch_vccnz SBs_110
SBb_111:
    s_setprio 1
    v_mfma_f32_16x16x32_bf16 v[80:83], v[32:35], v[168:171], v[80:83]
    ds_read_b64_tr_b16 v[24:25], v4 offset:32768
    v_mfma_f32_16x16x32_bf16 v[84:87], v[32:35], v[172:175], v[84:87]
    ds_read_b64_tr_b16 v[26:27], v4 offset:34816
    s_add_u32 m0, s35, 0
    s_add_u32 s41, s28, 811264
    buffer_load_dwordx4 v6, s[20:23], s41 offen lds
    v_mfma_f32_16x16x32_bf16 v[88:91], v[36:39], v[168:171], v[88:91]
    ds_read_b64_tr_b16 v[28:29], v5 offset:32768
    s_add_u32 m0, s35, 8192
    s_add_u32 s41, s28, 1032448
    buffer_load_dwordx4 v6, s[20:23], s41 offen lds
    v_mfma_f32_16x16x32_bf16 v[92:95], v[36:39], v[172:175], v[92:95]
    ds_read_b64_tr_b16 v[30:31], v5 offset:34816
    ds_write_b128 v11, v[224:227] offset:4096
    v_mfma_f32_16x16x32_bf16 v[96:99], v[40:43], v[168:171], v[96:99]
    ds_read_b64_tr_b16 v[32:33], v2 offset:40960
    v_mfma_f32_16x16x32_bf16 v[100:103], v[40:43], v[172:175], v[100:103]
    ds_read_b64_tr_b16 v[34:35], v2 offset:43008
    ds_write_b128 v11, v[228:231] offset:5120
    s_waitcnt lgkmcnt(15)
    v_mfma_f32_16x16x32_bf16 v[104:107], v[44:47], v[168:171], v[104:107]
    ds_read_b64_tr_b16 v[36:37], v3 offset:40960
    ds_write_b128 v11, v[232:235] offset:6144
    v_mfma_f32_16x16x32_bf16 v[108:111], v[44:47], v[172:175], v[108:111]
    ds_read_b64_tr_b16 v[38:39], v3 offset:43008
    ds_write_b128 v11, v[236:239] offset:7168
    s_waitcnt vmcnt(2)
    s_mov_b32 m0, s46
    v_add_u32 v7, 1, v7
    ds_write_addtid_b32 v7
    s_setprio 0
    s_waitcnt lgkmcnt(15)
    v_mfma_f32_16x16x32_bf16 v[80:83], v[16:19], v[176:179], v[80:83]
    ds_read_b64_tr_b16 v[40:41], v4 offset:40960
    s_add_u32 m0, s35, 16384
    s_add_u32 s41, s28, 1253632
    buffer_load_dwordx4 v6, s[20:23], s41 offen lds
    v_mfma_f32_16x16x32_bf16 v[84:87], v[16:19], v[180:183], v[84:87]
    ds_read_b64_tr_b16 v[42:43], v4 offset:43008
    v_mov_b32 v160, 0
    v_mov_b32 v161, 0
    ds_read_b32 v8, v9
    s_waitcnt lgkmcnt(15)
    v_mfma_f32_16x16x32_bf16 v[88:91], v[20:23], v[176:179], v[88:91]
    ds_read_b64_tr_b16 v[44:45], v5 offset:40960
    v_mov_b32 v162, 0
    v_mov_b32 v163, 0
    v_mfma_f32_16x16x32_bf16 v[92:95], v[20:23], v[180:183], v[92:95]
    ds_read_b64_tr_b16 v[46:47], v5 offset:43008
    v_mov_b32 v164, 0
    v_mov_b32 v165, 0
    s_waitcnt lgkmcnt(15)
    v_mfma_f32_16x16x32_bf16 v[96:99], v[24:27], v[176:179], v[96:99]
    ds_read_b64_tr_b16 v[16:17], v2 offset:49152
    v_mov_b32 v166, 0
    v_mov_b32 v167, 0
    v_mfma_f32_16x16x32_bf16 v[100:103], v[24:27], v[180:183], v[100:103]
    ds_read_b64_tr_b16 v[18:19], v2 offset:51200
    v_mov_b32 v168, 0
    v_mov_b32 v169, 0
    s_waitcnt lgkmcnt(15)
    v_mfma_f32_16x16x32_bf16 v[104:107], v[28:31], v[176:179], v[104:107]
    ds_read_b64_tr_b16 v[20:21], v3 offset:49152
    v_mov_b32 v170, 0
    v_mov_b32 v171, 0
    v_mfma_f32_16x16x32_bf16 v[108:111], v[28:31], v[180:183], v[108:111]
    ds_read_b64_tr_b16 v[22:23], v3 offset:51200
    v_mov_b32 v172, 0
    v_mov_b32 v173, 0
    v_mov_b32 v174, 0
    v_mov_b32 v175, 0
    s_waitcnt lgkmcnt(6)
    v_cmp_gt_i32 vcc, v7, v8
    s_cbranch_vccnz SBs_112
SBb_113:
    s_setprio 1
    v_mfma_f32_16x16x32_bf16 v[80:83], v[32:35], v[184:187], v[80:83]
    ds_read_b64_tr_b16 v[24:25], v4 offset:49152
    ds_read_b128 v[208:211], v12 offset:0
    v_mfma_f32_16x16x32_bf16 v[84:87], v[32:35], v[188:191], v[84:87]
    ds_read_b64_tr_b16 v[26:27], v4 offset:51200
    ds_read_b128 v[212:215], v12 offset:1024
    v_mfma_f32_16x16x32_bf16 v[88:91], v[36:39], v[184:187], v[88:91]
    ds_read_b64_tr_b16 v[28:29], v5 offset:49152
    ds_read_b128 v[216:219], v12 offset:2048
    v_mfma_f32_16x16x32_bf16 v[92:95], v[36:39], v[188:191], v[92:95]
    ds_read_b64_tr_b16 v[30:31], v5 offset:51200
    ds_read_b128 v[220:223], v12 offset:3072
    v_mfma_f32_16x16x32_bf16 v[96:99], v[40:43], v[184:187], v[96:99]
    ds_read_b64_tr_b16 v[32:33], v240 offset:24576
    ds_read_b128 v[224:227], v12 offset:4096
    v_mfma_f32_16x16x32_bf16 v[100:103], v[40:43], v[188:191], v[100:103]
    ds_read_b64_tr_b16 v[34:35], v240 offset:26624
    ds_read_b128 v[228:231], v12 offset:5120
    s_waitcnt lgkmcnt(15)
    v_mfma_f32_16x16x32_bf16 v[104:107], v[44:47], v[184:187], v[104:107]
    ds_read_b64_tr_b16 v[36:37], v241 offset:24576
    ds_read_b128 v[232:235], v12 offset:6144
    v_mfma_f32_16x16x32_bf16 v[108:111], v[44:47], v[188:191], v[108:111]
    ds_read_b64_tr_b16 v[38:39], v241 offset:26624
    ds_read_b128 v[236:239], v12 offset:7168
    s_load_dwordx2 s[52:53], s[0:1], 104
    s_load_dwordx2 s[28:29], s[0:1], 0
    s_load_dwordx2 s[30:31], s[0:1], 64
    s_waitcnt lgkmcnt(15)
    v_mfma_f32_16x16x32_bf16 v[80:83], v[16:19], v[192:195], v[80:83]
    ds_read_b64_tr_b16 v[40:41], v242 offset:24576
    s_waitcnt lgkmcnt(15)
    v_add_f32 v48, v48, v208
    v_add_f32 v49, v49, v209
    v_mfma_f32_16x16x32_bf16 v[84:87], v[16:19], v[196:199], v[84:87]
    ds_read_b64_tr_b16 v[42:43], v242 offset:26624
    v_add_f32 v50, v50, v210
    v_add_f32 v51, v51, v211
    v_mfma_f32_16x16x32_bf16 v[88:91], v[20:23], v[192:195], v[88:91]
    ds_read_b64_tr_b16 v[44:45], v243 offset:24576
    s_waitcnt lgkmcnt(15)
    v_add_f32 v52, v52, v212
    v_add_f32 v53, v53, v213
    v_mfma_f32_16x16x32_bf16 v[92:95], v[20:23], v[196:199], v[92:95]
    ds_read_b64_tr_b16 v[46:47], v243 offset:26624
    v_add_f32 v54, v54, v214
    v_add_f32 v55, v55, v215
    v_mfma_f32_16x16x32_bf16 v[96:99], v[24:27], v[192:195], v[96:99]
    ds_read_b64_tr_b16 v[16:17], v240 offset:0
    s_waitcnt lgkmcnt(15)
    v_add_f32 v56, v56, v216
    v_add_f32 v57, v57, v217
    v_mfma_f32_16x16x32_bf16 v[100:103], v[24:27], v[196:199], v[100:103]
    ds_read_b64_tr_b16 v[18:19], v240 offset:2048
    v_add_f32 v58, v58, v218
    v_add_f32 v59, v59, v219
    s_waitcnt lgkmcnt(15)
    v_mfma_f32_16x16x32_bf16 v[104:107], v[28:31], v[192:195], v[104:107]
    ds_read_b64_tr_b16 v[20:21], v241 offset:0
    s_waitcnt lgkmcnt(15)
    v_add_f32 v60, v60, v220
    v_add_f32 v61, v61, v221
    v_mfma_f32_16x16x32_bf16 v[108:111], v[28:31], v[196:199], v[108:111]
    ds_read_b64_tr_b16 v[22:23], v241 offset:2048
    v_add_f32 v62, v62, v222
    v_add_f32 v63, v63, v223
    s_waitcnt vmcnt(0)
    s_mov_b32 m0, s46
    v_add_u32 v7, 1, v7
    ds_write_addtid_b32 v7
    s_setprio 0
    s_waitcnt lgkmcnt(14)
    v_mfma_f32_16x16x32_bf16 v[80:83], v[32:35], v[200:203], v[80:83]
    ds_read_b64_tr_b16 v[24:25], v242 offset:0
    v_mfma_f32_16x16x32_bf16 v[84:87], v[32:35], v[204:207], v[84:87]
    ds_read_b64_tr_b16 v[26:27], v242 offset:2048
    v_cvt_pk_bf16_f32 v208, v48, v49
    v_cvt_pk_bf16_f32 v209, v50, v51
    s_waitcnt lgkmcnt(12)
    v_mfma_f32_16x16x32_bf16 v[88:91], v[36:39], v[200:203], v[88:91]
    ds_read_b64_tr_b16 v[28:29], v243 offset:0
    v_cvt_pk_bf16_f32 v210, v56, v57
    v_cvt_pk_bf16_f32 v211, v58, v59
    v_mfma_f32_16x16x32_bf16 v[92:95], v[36:39], v[204:207], v[92:95]
    ds_read_b64_tr_b16 v[30:31], v243 offset:2048
    s_cmp_eq_u32 s49, 0
    s_cselect_b32 s44, 0x7ff00000, s54
    buffer_store_dwordx4 v[208:211], v1, s[4:7], s44 offen offset:0 sc1
    s_cbranch_scc0 K2_nx_114
    v_add_f32 v160, v160, v48
    v_add_f32 v161, v161, v49
    v_add_f32 v162, v162, v50
    v_add_f32 v163, v163, v51
    v_add_f32 v164, v164, v56
    v_add_f32 v165, v165, v57
    v_add_f32 v166, v166, v58
    v_add_f32 v167, v167, v59
K2_nx_114:
    s_waitcnt lgkmcnt(11)
    v_mfma_f32_16x16x32_bf16 v[96:99], v[40:43], v[200:203], v[96:99]
    ds_read_b64_tr_b16 v[32:33], v240 offset:8192
    v_mfma_f32_16x16x32_bf16 v[100:103], v[40:43], v[204:207], v[100:103]
    ds_read_b64_tr_b16 v[34:35], v240 offset:10240
    v_cvt_pk_bf16_f32 v212, v52, v53
    v_cvt_pk_bf16_f32 v213, v54, v55
    s_waitcnt lgkmcnt(11)
    v_mfma_f32_16x16x32_bf16 v[104:107], v[44:47], v[200:203], v[104:107]
    ds_read_b64_tr_b16 v[36:37], v241 offset:8192
    v_cvt_pk_bf16_f32 v214, v60, v61
    v_cvt_pk_bf16_f32 v215, v62, v63
    v_mfma_f32_16x16x32_bf16 v[108:111], v[44:47], v[204:207], v[108:111]
    ds_read_b64_tr_b16 v[38:39], v241 offset:10240
    s_cmp_eq_u32 s49, 1
    s_cselect_b32 s44, 0x7ff00000, s54
    buffer_store_dwordx4 v[212:215], v1, s[4:7], s44 offen offset:1024 sc1
    s_cbranch_scc0 K2_nx_115
    v_add_f32 v160, v160, v52
    v_add_f32 v161, v161, v53
    v_add_f32 v162, v162, v54
    v_add_f32 v163, v163, v55
    v_add_f32 v164, v164, v60
    v_add_f32 v165, v165, v61
    v_add_f32 v166, v166, v62
    v_add_f32 v167, v167, v63
K2_nx_115:
    s_waitcnt lgkmcnt(11)
    v_mfma_f32_16x16x32_bf16 v[80:83], v[16:19], v[112:115], v[80:83]
    ds_read_b64_tr_b16 v[40:41], v242 offset:8192
    v_add_f32 v64, v64, v224
    v_add_f32 v65, v65, v225
    v_add_f32 v66, v66, v226
    v_add_f32 v67, v67, v227
    v_add_f32 v68, v68, v228
    v_add_f32 v69, v69, v229
    v_mfma_f32_16x16x32_bf16 v[84:87], v[16:19], v[116:119], v[84:87]
    ds_read_b64_tr_b16 v[42:43], v242 offset:10240
    v_add_f32 v70, v70, v230
    v_add_f32 v71, v71, v231
    v_add_f32 v72, v72, v232
    v_add_f32 v73, v73, v233
    v_add_f32 v74, v74, v234
    v_add_f32 v75, v75, v235
    ds_read_b32 v8, v9
    s_waitcnt lgkmcnt(12)
    v_mfma_f32_16x16x32_bf16 v[88:91], v[20:23], v[112:115], v[88:91]
    ds_read_b64_tr_b16 v[44:45], v243 offset:8192
    v_add_f32 v76, v76, v236
    v_add_f32 v77, v77, v237
    v_add_f32 v78, v78, v238
    v_add_f32 v79, v79, v239
    v_lshrrev_b32 v176, 1, v10
    v_mfma_f32_16x16x32_bf16 v[92:95], v[20:23], v[116:119], v[92:95]
    ds_read_b64_tr_b16 v[46:47], v243 offset:10240
    v_lshrrev_b32 v179, 4, v0
    v_lshlrev_b32 v177, 3, v179
    v_lshrrev_b32 v178, 1, v179
    v_lshlrev_b32 v178, 8, v178
    s_waitcnt lgkmcnt(11)
    v_mfma_f32_16x16x32_bf16 v[96:99], v[24:27], v[112:115], v[96:99]
    ds_read_b64_tr_b16 v[16:17], v240 offset:16384
    v_and_b32 v180, 15, v0
    v_lshl_add_u32 v178, v180, 4, v178
    v_and_b32 v180, 1, v179
    v_mfma_f32_16x16x32_bf16 v[100:103], v[24:27], v[116:119], v[100:103]
    ds_read_b64_tr_b16 v[18:19], v240 offset:18432
    v_lshl_add_u32 v178, v180, 3, v178
    s_mul_i32 s32, s99, 6
    s_lshl_b32 s33, s42, 1
    s_waitcnt lgkmcnt(11)
    v_mfma_f32_16x16x32_bf16 v[104:107], v[28:31], v[112:115], v[104:107]
    ds_read_b64_tr_b16 v[20:21], v241 offset:16384
    s_add_u32 s34, s32, s33
    s_lshr_b32 s33, s49, 1
    s_add_u32 s34, s34, s33
    v_mfma_f32_16x16x32_bf16 v[108:111], v[28:31], v[116:119], v[108:111]
    ds_read_b64_tr_b16 v[22:23], v241 offset:18432
    s_add_u32 s35, s32, s42
    s_add_u32 s35, s35, 4
    s_lshl_b32 s32, s98, 2
    s_and_b32 s33, s16, 3
    s_waitcnt lgkmcnt(6)
    v_cmp_gt_i32 vcc, v7, v8
    s_cbranch_vccnz SBs_116
SBb_117:
    s_setprio 1
    v_mfma_f32_16x16x32_bf16 v[80:83], v[32:35], v[120:123], v[80:83]
    ds_read_b64_tr_b16 v[24:25], v242 offset:16384
    v_cvt_pk_bf16_f32 v224, v64, v65
    v_cvt_pk_bf16_f32 v225, v66, v67
    v_cvt_pk_bf16_f32 v226, v72, v73
    v_cvt_pk_bf16_f32 v227, v74, v75
    v_mfma_f32_16x16x32_bf16 v[84:87], v[32:35], v[124:127], v[84:87]
    ds_read_b64_tr_b16 v[26:27], v242 offset:18432
    s_cmp_eq_u32 s49, 2
    s_cselect_b32 s44, 0x7ff00000, s54
    buffer_store_dwordx4 v[224:227], v1, s[4:7], s44 offen offset:2048 sc1
    s_cbranch_scc0 K2_nx_118
    v_add_f32 v160, v160, v64
    v_add_f32 v161, v161, v65
    v_add_f32 v162, v162, v66
    v_add_f32 v163, v163, v67
    v_add_f32 v164, v164, v72
    v_add_f32 v165, v165, v73
    v_add_f32 v166, v166, v74
    v_add_f32 v167, v167, v75
K2_nx_118:
    v_cvt_pk_bf16_f32 v228, v68, v69
    v_cvt_pk_bf16_f32 v229, v70, v71
    v_cvt_pk_bf16_f32 v230, v76, v77
    v_cvt_pk_bf16_f32 v231, v78, v79
    v_mfma_f32_16x16x32_bf16 v[88:91], v[36:39], v[120:123], v[88:91]
    ds_read_b64_tr_b16 v[28:29], v243 offset:16384
    s_cmp_eq_u32 s49, 3
    s_cselect_b32 s44, 0x7ff00000, s55
    buffer_store_dwordx4 v[228:231], v1, s[4:7], s44 offen offset:0 sc1
    s_cbranch_scc0 K2_nx_119
    v_add_f32 v160, v160, v68
    v_add_f32 v161, v161, v69
    v_add_f32 v162, v162, v70
    v_add_f32 v163, v163, v71
    v_add_f32 v164, v164, v76
    v_add_f32 v165, v165, v77
    v_add_f32 v166, v166, v78
    v_add_f32 v167, v167, v79
K2_nx_119:
    s_add_u32 s32, s32, s33
    s_mul_i32 s32, s32, 36
    v_mfma_f32_16x16x32_bf16 v[92:95], v[36:39], v[124:127], v[92:95]
    ds_read_b64_tr_b16 v[30:31], v243 offset:18432
    s_and_b32 s33, s49, 1
    s_mul_i32 s33, s33, 18
    s_add_u32 s36, s32, s33
    v_mfma_f32_16x16x32_bf16 v[96:99], v[40:43], v[120:123], v[96:99]
    ds_read_b64_tr_b16 v[32:33], v2 offset:0
    s_add_u32 s36, s36, s34
    s_lshl_b32 s36, s36, 10
    s_cmp_eq_u32 s49, 0
    s_cselect_b32 s33, 18, 0
    v_mfma_f32_16x16x32_bf16 v[100:103], v[40:43], v[124:127], v[100:103]
    ds_read_b64_tr_b16 v[34:35], v2 offset:2048
    s_add_u32 s37, s32, s33
    s_add_u32 s37, s37, s35
    s_lshl_b32 s37, s37, 10
    s_waitcnt lgkmcnt(10)
    v_mfma_f32_16x16x32_bf16 v[104:107], v[44:47], v[120:123], v[104:107]
    ds_read_b64_tr_b16 v[36:37], v3 offset:0
    s_lshl_b32 s34, s34, 6
    s_lshl_b32 s35, s35, 6
    s_lshr_b32 s38, s60, 1
    v_mfma_f32_16x16x32_bf16 v[108:111], v[44:47], v[124:127], v[108:111]
    ds_read_b64_tr_b16 v[38:39], v3 offset:2048
    s_lshr_b32 s39, s61, 1
    s_cmp_eq_u32 s49, 4
    s_cselect_b32 s36, 0x7ff00000, s36
    s_and_b32 s33, s49, 3
    s_cselect_b32 s37, 0x7ff00000, s37
    s_waitcnt lgkmcnt(10)
    v_mfma_f32_16x16x32_bf16 v[80:83], v[16:19], v[128:131], v[80:83]
    ds_read_b64_tr_b16 v[40:41], v4 offset:0
    v_mfma_f32_16x16x32_bf16 v[84:87], v[16:19], v[132:135], v[84:87]
    ds_read_b64_tr_b16 v[42:43], v4 offset:2048
    s_waitcnt lgkmcnt(0)
    s_mov_b32 s8, s52
    s_mov_b32 s9, s53
    s_mov_b32 s10, 4718592
    s_mov_b32 s11, 0x20000
    s_mov_b32 s12, s28
    s_mov_b32 s13, s29
    s_mov_b32 s14, 2359296
    s_mov_b32 s15, 0x20000
    s_mov_b32 s20, s30
    s_mov_b32 s21, s31
    s_mov_b32 s22, 1152
    s_mov_b32 s23, 0x20000
    v_mfma_f32_16x16x32_bf16 v[88:91], v[20:23], v[128:131], v[88:91]
    ds_read_b64_tr_b16 v[44:45], v5 offset:0
    buffer_load_dwordx2 v[184:185], v176, s[12:15], s38 offen offset:0
    v_mfma_f32_16x16x32_bf16 v[92:95], v[20:23], v[132:135], v[92:95]
    ds_read_b64_tr_b16 v[46:47], v5 offset:2048
    buffer_load_dwordx2 v[186:187], v178, s[4:7], s36 offen offset:0 sc1
    v_mfma_f32_16x16x32_bf16 v[96:99], v[24:27], v[128:131], v[96:99]
    ds_read_b64_tr_b16 v[16:17], v2 offset:8192
    buffer_load_dwordx2 v[188:189], v177, s[20:23], s34 offen offset:0
    v_mfma_f32_16x16x32_bf16 v[100:103], v[24:27], v[132:135], v[100:103]
    ds_read_b64_tr_b16 v[18:19], v2 offset:10240
    buffer_load_dwordx2 v[190:191], v176, s[12:15], s38 offen offset:32
    v_mfma_f32_16x16x32_bf16 v[104:107], v[28:31], v[128:131], v[104:107]
    ds_read_b64_tr_b16 v[20:21], v3 offset:8192
    buffer_load_dwordx2 v[192:193], v178, s[4:7], s36 offen offset:512 sc1
    v_mfma_f32_16x16x32_bf16 v[108:111], v[28:31], v[132:135], v[108:111]
    ds_read_b64_tr_b16 v[22:23], v3 offset:10240
    buffer_load_dwordx2 v[194:195], v177, s[20:23], s34 offen offset:32
    v_mfma_f32_16x16x32_bf16 v[80:83], v[32:35], v[136:139], v[80:83]
    ds_read_b64_tr_b16 v[24:25], v4 offset:8192
    v_mfma_f32_16x16x32_bf16 v[84:87], v[32:35], v[140:143], v[84:87]
    ds_read_b64_tr_b16 v[26:27], v4 offset:10240
    buffer_load_dwordx2 v[196:197], v176, s[12:15], s39 offen offset:0
    v_mfma_f32_16x16x32_bf16 v[88:91], v[36:39], v[136:139], v[88:91]
    ds_read_b64_tr_b16 v[28:29], v5 offset:8192
    buffer_load_dwordx2 v[198:199], v178, s[4:7], s37 offen offset:0 sc1
    v_mfma_f32_16x16x32_bf16 v[92:95], v[36:39], v[140:143], v[92:95]
    ds_read_b64_tr_b16 v[30:31], v5 offset:10240
    buffer_load_dwordx2 v[200:201], v177, s[20:23], s35 offen offset:0
    v_mfma_f32_16x16x32_bf16 v[96:99], v[40:43], v[136:139], v[96:99]
    ds_read_b64_tr_b16 v[32:33], v2 offset:16384
    v_mfma_f32_16x16x32_bf16 v[100:103], v[40:43], v[140:143], v[100:103]
    ds_read_b64_tr_b16 v[34:35], v2 offset:18432
    buffer_load_dwordx2 v[202:203], v176, s[12:15], s39 offen offset:32
    s_waitcnt lgkmcnt(10)
    v_mfma_f32_16x16x32_bf16 v[104:107], v[44:47], v[136:139], v[104:107]
    ds_read_b64_tr_b16 v[36:37], v3 offset:16384
    buffer_load_dwordx2 v[204:205], v178, s[4:7], s37 offen offset:512 sc1
    v_mfma_f32_16x16x32_bf16 v[108:111], v[44:47], v[140:143], v[108:111]
    ds_read_b64_tr_b16 v[38:39], v3 offset:18432
    buffer_load_dwordx2 v[206:207], v177, s[20:23], s35 offen offset:32
    s_waitcnt lgkmcnt(10)
    v_mfma_f32_16x16x32_bf16 v[80:83], v[16:19], v[144:147], v[80:83]
    ds_read_b64_tr_b16 v[40:41], v4 offset:16384
    v_mfma_f32_16x16x32_bf16 v[84:87], v[16:19], v[148:151], v[84:87]
    ds_read_b64_tr_b16 v[42:43], v4 offset:18432
    s_waitcnt lgkmcnt(10)
    v_mfma_f32_16x16x32_bf16 v[88:91], v[20:23], v[144:147], v[88:91]
    ds_read_b64_tr_b16 v[44:45], v5 offset:16384
    v_mfma_f32_16x16x32_bf16 v[92:95], v[20:23], v[148:151], v[92:95]
    ds_read_b64_tr_b16 v[46:47], v5 offset:18432
    s_waitcnt lgkmcnt(10)
    v_mfma_f32_16x16x32_bf16 v[96:99], v[24:27], v[144:147], v[96:99]
    v_mfma_f32_16x16x32_bf16 v[100:103], v[24:27], v[148:151], v[100:103]
    s_waitcnt lgkmcnt(8)
    v_mfma_f32_16x16x32_bf16 v[104:107], v[28:31], v[144:147], v[104:107]
    v_mfma_f32_16x16x32_bf16 v[108:111], v[28:31], v[148:151], v[108:111]
    s_waitcnt lgkmcnt(6)
    v_mfma_f32_16x16x32_bf16 v[80:83], v[32:35], v[152:155], v[80:83]
    v_mfma_f32_16x16x32_bf16 v[84:87], v[32:35], v[156:159], v[84:87]
    s_waitcnt lgkmcnt(4)
    v_mfma_f32_16x16x32_bf16 v[88:91], v[36:39], v[152:155], v[88:91]
    v_mfma_f32_16x16x32_bf16 v[92:95], v[36:39], v[156:159], v[92:95]
    s_waitcnt lgkmcnt(2)
    v_mfma_f32_16x16x32_bf16 v[96:99], v[40:43], v[152:155], v[96:99]
    v_mfma_f32_16x16x32_bf16 v[100:103], v[40:43], v[156:159], v[100:103]
    s_waitcnt lgkmcnt(0)
    v_mfma_f32_16x16x32_bf16 v[104:107], v[44:47], v[152:155], v[104:107]
    v_mfma_f32_16x16x32_bf16 v[108:111], v[44:47], v[156:159], v[108:111]
    s_nop 7
    ds_write_b128 v11, v[80:83] offset:0
    ds_write_b128 v11, v[84:87] offset:1024
    ds_write_b128 v11, v[88:91] offset:2048
    ds_write_b128 v11, v[92:95] offset:3072
    s_waitcnt lgkmcnt(0)
    s_barrier
    ds_read_b128 v[80:83], v12 offset:0
    ds_read_b128 v[84:87], v12 offset:1024
    ds_read_b128 v[88:91], v12 offset:2048
    ds_read_b128 v[92:95], v12 offset:3072
    s_waitcnt lgkmcnt(3)
    v_add_f32 v96, v96, v80
    v_add_f32 v97, v97, v81
    v_add_f32 v98, v98, v82
    v_add_f32 v99, v99, v83
    s_waitcnt lgkmcnt(2)
    v_add_f32 v100, v100, v84
    v_add_f32 v101, v101, v85
    v_add_f32 v102, v102, v86
    v_add_f32 v103, v103, v87
    s_waitcnt lgkmcnt(1)
    v_add_f32 v104, v104, v88
    v_add_f32 v105, v105, v89
    v_add_f32 v106, v106, v90
    v_add_f32 v107, v107, v91
    s_waitcnt lgkmcnt(0)
    v_add_f32 v108, v108, v92
    v_add_f32 v109, v109, v93
    v_add_f32 v110, v110, v94
    v_add_f32 v111, v111, v95
    v_cvt_pk_bf16_f32 v80, v96, v97
    v_cvt_pk_bf16_f32 v81, v98, v99
    v_cvt_pk_bf16_f32 v82, v104, v105
    v_cvt_pk_bf16_f32 v83, v106, v107
    s_cmp_eq_u32 s49, 4
    s_cselect_b32 s44, 0x7ff00000, s55
    buffer_store_dwordx4 v[80:83], v1, s[4:7], s44 offen offset:1024 sc1
    s_cbranch_scc0 K2_nx_120
    v_add_f32 v168, v168, v96
    v_add_f32 v169, v169, v97
    v_add_f32 v170, v170, v98
    v_add_f32 v171, v171, v99
    v_add_f32 v172, v172, v104
    v_add_f32 v173, v173, v105
    v_add_f32 v174, v174, v106
    v_add_f32 v175, v175, v107
K2_nx_120:
    v_cvt_pk_bf16_f32 v84, v100, v101
    v_cvt_pk_bf16_f32 v85, v102, v103
    v_cvt_pk_bf16_f32 v86, v108, v109
    v_cvt_pk_bf16_f32 v87, v110, v111
    s_cmp_eq_u32 s49, 0
    s_cselect_b32 s44, 0x7ff00000, s55
    buffer_store_dwordx4 v[84:87], v1, s[4:7], s44 offen offset:2048 sc1
    s_cbranch_scc0 K2_nx_121
    v_add_f32 v168, v168, v100
    v_add_f32 v169, v169, v101
    v_add_f32 v170, v170, v102
    v_add_f32 v171, v171, v103
    v_add_f32 v172, v172, v108
    v_add_f32 v173, v173, v109
    v_add_f32 v174, v174, v110
    v_add_f32 v175, v175, v111
K2_nx_121:
    s_branch K2_fin
SBs_8:
    s_sleep 1
    ds_read_b32 v8, v9
    s_waitcnt lgkmcnt(0)
    v_cmp_gt_i32 vcc, v7, v8
    s_cbranch_vccnz SBs_8
    s_branch SBb_9
SBs_10:
    s_sleep 1
    ds_read_b32 v8, v9
    s_waitcnt lgkmcnt(0)
    v_cmp_gt_i32 vcc, v7, v8
    s_cbranch_vccnz SBs_10
    s_branch SBb_11
SBs_12:
    s_sleep 1
    ds_read_b32 v8, v9
    s_waitcnt lgkmcnt(0)
    v_cmp_gt_i32 vcc, v7, v8
    s_cbranch_vccnz SBs_12
    s_branch SBb_13
SBs_14:
    s_sleep 1
    ds_read_b32 v8, v9
    s_waitcnt lgkmcnt(0)
    v_cmp_gt_i32 vcc, v7, v8
    s_cbranch_vccnz SBs_14
    s_branch SBb_15
SBs_16:
    s_sleep 1
    ds_read_b32 v8, v9
    s_waitcnt lgkmcnt(0)
    v_cmp_gt_i32 vcc, v7, v8
    s_cbranch_vccnz SBs_16
    s_branch SBb_17
SBs_18:
    s_sleep 1
    ds_read_b32 v8, v9
    s_waitcnt lgkmcnt(0)
    v_cmp_gt_i32 vcc, v7, v8
    s_cbranch_vccnz SBs_18
    s_branch SBb_19
SBs_20:
    s_sleep 1
    ds_read_b32 v8, v9
    s_waitcnt lgkmcnt(0)
    v_cmp_gt_i32 vcc, v7, v8
    s_cbranch_vccnz SBs_20
    s_branch SBb_21
SBs_22:
    s_sleep 1
    ds_read_b32 v8, v9
    s_waitcnt lgkmcnt(0)
    v_cmp_gt_i32 vcc, v7, v8
    s_cbranch_vccnz SBs_22
    s_branch SBb_23
SBs_24:
    s_sleep 1
    ds_read_b32 v8, v9
    s_waitcnt lgkmcnt(0)
    v_cmp_gt_i32 vcc, v7, v8
    s_cbranch_vccnz SBs_24
    s_branch SBb_25
SBs_26:
    s_sleep 1
    ds_read_b32 v8, v9
    s_waitcnt lgkmcnt(0)
    v_cmp_gt_i32 vcc, v7, v8
    s_cbranch_vccnz SBs_26
    s_branch SBb_27
SBs_28:
    s_sleep 1
    ds_read_b32 v8, v9
    s_waitcnt lgkmcnt(0)
    v_cmp_gt_i32 vcc, v7, v8
    s_cbranch_vccnz SBs_28
    s_branch SBb_29
SBs_30:
    s_sleep 1
    ds_read_b32 v8, v9
    s_waitcnt lgkmcnt(0)
    v_cmp_gt_i32 vcc, v7, v8
    s_cbranch_vccnz SBs_30
    s_branch SBb_31
SBs_32:
    s_sleep 1
    ds_read_b32 v8, v9
    s_waitcnt lgkmcnt(0)
    v_cmp_gt_i32 vcc, v7, v8
    s_cbranch_vccnz SBs_32
    s_branch SBb_33
SBs_34:
    s_sleep 1
    ds_read_b32 v8, v9
    s_waitcnt lgkmcnt(0)
    v_cmp_gt_i32 vcc, v7, v8
    s_cbranch_vccnz SBs_34
    s_branch SBb_35
SBs_36:
    s_sleep 1
    ds_read_b32 v8, v9
    s_waitcnt lgkmcnt(0)
    v_cmp_gt_i32 vcc, v7, v8
    s_cbranch_vccnz SBs_36
    s_branch SBb_37
SBs_38:
    s_sleep 1
    ds_read_b32 v8, v9
    s_waitcnt lgkmcnt(0)
    v_cmp_gt_i32 vcc, v7, v8
    s_cbranch_vccnz SBs_38
    s_branch SBb_39
SBs_42:
    s_sleep 1
    ds_read_b32 v8, v9
    s_waitcnt lgkmcnt(0)
    v_cmp_gt_i32 vcc, v7, v8
    s_cbranch_vccnz SBs_42
    s_branch SBb_43
SBs_44:
    s_sleep 1
    ds_read_b32 v8, v9
    s_waitcnt lgkmcnt(0)
    v_cmp_gt_i32 vcc, v7, v8
    s_cbranch_vccnz SBs_44
    s_branch SBb_45
SBs_46:
    s_sleep 1
    ds_read_b32 v8, v9
    s_waitcnt lgkmcnt(0)
    v_cmp_gt_i32 vcc, v7, v8
    s_cbranch_vccnz SBs_46
    s_branch SBb_47
SBs_50:
    s_sleep 1
    ds_read_b32 v8, v9
    s_waitcnt lgkmcnt(0)
    v_cmp_gt_i32 vcc, v7, v8
    s_cbranch_vccnz SBs_50
    s_branch SBb_51
SBs_52:
    s_sleep 1
    ds_read_b32 v8, v9
    s_waitcnt lgkmcnt(0)
    v_cmp_gt_i32 vcc, v7, v8
    s_cbranch_vccnz SBs_52
    s_branch SBb_53
SBs_54:
    s_sleep 1
    ds_read_b32 v8, v9
    s_waitcnt lgkmcnt(0)
    v_cmp_gt_i32 vcc, v7, v8
    s_cbranch_vccnz SBs_54
    s_branch SBb_55
SBs_56:
    s_sleep 1
    ds_read_b32 v8, v9
    s_waitcnt lgkmcnt(0)
    v_cmp_gt_i32 vcc, v7, v8
    s_cbranch_vccnz SBs_56
    s_branch SBb_57
SBs_58:
    s_sleep 1
    ds_read_b32 v8, v9
    s_waitcnt lgkmcnt(0)
    v_cmp_gt_i32 vcc, v7, v8
    s_cbranch_vccnz SBs_58
    s_branch SBb_59
SBs_60:
    s_sleep 1
    ds_read_b32 v8, v9
    s_waitcnt lgkmcnt(0)
    v_cmp_gt_i32 vcc, v7, v8
    s_cbranch_vccnz SBs_60
    s_branch SBb_61
SBs_62:
    s_sleep 1
    ds_read_b32 v8, v9
    s_waitcnt lgkmcnt(0)
    v_cmp_gt_i32 vcc, v7, v8
    s_cbranch_vccnz SBs_62
    s_branch SBb_63
SBs_64:
    s_sleep 1
    ds_read_b32 v8, v9
    s_waitcnt lgkmcnt(0)
    v_cmp_gt_i32 vcc, v7, v8
    s_cbranch_vccnz SBs_64
    s_branch SBb_65
SBs_66:
    s_sleep 1
    ds_read_b32 v8, v9
    s_waitcnt lgkmcnt(0)
    v_cmp_gt_i32 vcc, v7, v8
    s_cbranch_vccnz SBs_66
    s_branch SBb_67
SBs_68:
    s_sleep 1
    ds_read_b32 v8, v9
    s_waitcnt lgkmcnt(0)
    v_cmp_gt_i32 vcc, v7, v8
    s_cbranch_vccnz SBs_68
    s_branch SBb_69
SBs_72:
    s_sleep 1
    ds_read_b32 v8, v9
    s_waitcnt lgkmcnt(0)
    v_cmp_gt_i32 vcc, v7, v8
    s_cbranch_vccnz SBs_72
    s_branch SBb_73
SBs_74:
    s_sleep 1
    ds_read_b32 v8, v9
    s_waitcnt lgkmcnt(0)
    v_cmp_gt_i32 vcc, v7, v8
    s_cbranch_vccnz SBs_74
    s_branch SBb_75
SBs_76:
    s_sleep 1
    ds_read_b32 v8, v9
    s_waitcnt lgkmcnt(0)
    v_cmp_gt_i32 vcc, v7, v8
    s_cbranch_vccnz SBs_76
    s_branch SBb_77
SBs_78:
    s_sleep 1
    ds_read_b32 v8, v9
    s_waitcnt lgkmcnt(0)
    v_cmp_gt_i32 vcc, v7, v8
    s_cbranch_vccnz SBs_78
    s_branch SBb_79
SBs_80:
    s_sleep 1
    ds_read_b32 v8, v9
    s_waitcnt lgkmcnt(0)
    v_cmp_gt_i32 vcc, v7, v8
    s_cbranch_vccnz SBs_80
    s_branch SBb_81
SBs_84:
    s_sleep 1
    ds_read_b32 v8, v9
    s_waitcnt lgkmcnt(0)
    v_cmp_gt_i32 vcc, v7, v8
    s_cbranch_vccnz SBs_84
    s_branch SBb_85
SBs_86:
    s_sleep 1
    ds_read_b32 v8, v9
    s_waitcnt lgkmcnt(0)
    v_cmp_gt_i32 vcc, v7, v8
    s_cbranch_vccnz SBs_86
    s_branch SBb_87
SBs_88:
    s_sleep 1
    ds_read_b32 v8, v9
    s_waitcnt lgkmcnt(0)
    v_cmp_gt_i32 vcc, v7, v8
    s_cbranch_vccnz SBs_88
    s_branch SBb_89
SBs_90:
    s_sleep 1
    ds_read_b32 v8, v9
    s_waitcnt lgkmcnt(0)
    v_cmp_gt_i32 vcc, v7, v8
    s_cbranch_vccnz SBs_90
    s_branch SBb_91
SBs_92:
    s_sleep 1
    ds_read_b32 v8, v9
    s_waitcnt lgkmcnt(0)
    v_cmp_gt_i32 vcc, v7, v8
    s_cbranch_vccnz SBs_92
    s_branch SBb_93
SBs_94:
    s_sleep 1
    ds_read_b32 v8, v9
    s_waitcnt lgkmcnt(0)
    v_cmp_gt_i32 vcc, v7, v8
    s_cbranch_vccnz SBs_94
    s_branch SBb_95
SBs_96:
    s_sleep 1
    ds_read_b32 v8, v9
    s_waitcnt lgkmcnt(0)
    v_cmp_gt_i32 vcc, v7, v8
    s_cbranch_vccnz SBs_96
    s_branch SBb_97
SBs_98:
    s_sleep 1
    ds_read_b32 v8, v9
    s_waitcnt lgkmcnt(0)
    v_cmp_gt_i32 vcc, v7, v8
    s_cbranch_vccnz SBs_98
    s_branch SBb_99
SBs_100:
    s_sleep 1
    ds_read_b32 v8, v9
    s_waitcnt lgkmcnt(0)
    v_cmp_gt_i32 vcc, v7, v8
    s_cbranch_vccnz SBs_100
    s_branch SBb_101
SBs_104:
    s_sleep 1
    ds_read_b32 v8, v9
    s_waitcnt lgkmcnt(0)
    v_cmp_gt_i32 vcc, v7, v8
    s_cbranch_vccnz SBs_104
    s_branch SBb_105
SBs_110:
    s_sleep 1
    ds_read_b32 v8, v9
    s_waitcnt lgkmcnt(0)
    v_cmp_gt_i32 vcc, v7, v8
    s_cbranch_vccnz SBs_110
    s_branch SBb_111
SBs_112:
    s_sleep 1
    ds_read_b32 v8, v9
    s_waitcnt lgkmcnt(0)
    v_cmp_gt_i32 vcc, v7, v8
    s_cbranch_vccnz SBs_112
    s_branch SBb_113
SBs_116:
    s_sleep 1
    ds_read_b32 v8, v9
    s_waitcnt lgkmcnt(0)
    v_cmp_gt_i32 vcc, v7, v8
    s_cbranch_vccnz SBs_116
    s_branch SBb_117
ASs_40:
    s_mov_b32 s47, 0
ASl_122:
    s_sleep 4
    buffer_load_dword v15, v13, s[24:27], 0 offen offset:128 sc1
    s_waitcnt vmcnt(0)
    v_cmp_ne_u32 vcc, 1, v15
    s_cbranch_vccz ASb_41
    s_add_u32 s47, s47, 1
    s_cmp_lt_u32 s47, 0x40000
    s_cbranch_scc1 ASl_122
    s_branch ASb_41
PLs_48:
    s_mov_b32 s47, 0
PLl_123:
    s_sleep 1
    buffer_load_dword v15, v13, s[4:7], s57 offen sc1
    s_waitcnt vmcnt(0)
    v_cmp_gt_u32 vcc, 1, v15
    s_cbranch_vccz PLb_49
    s_add_u32 s47, s47, 1
    s_cmp_lt_u32 s47, 0x40000
    s_cbranch_scc1 PLl_123
    s_branch PLb_49
PLs_70:
    s_mov_b32 s47, 0
PLl_124:
    s_sleep 1
    buffer_load_dword v14, v13, s[4:7], s57 offen sc1
    s_waitcnt vmcnt(0)
    v_cmp_gt_u32 vcc, 2, v14
    s_cbranch_vccz PLb_71
    s_add_u32 s47, s47, 1
    s_cmp_lt_u32 s47, 0x40000
    s_cbranch_scc1 PLl_124
    s_branch PLb_71
PLs_82:
    s_mov_b32 s47, 0
PLl_125:
    s_sleep 1
    buffer_load_dword v14, v13, s[4:7], s57 offen sc1
    s_waitcnt vmcnt(0)
    v_cmp_gt_u32 vcc, 3, v14
    s_cbranch_vccz PLb_83
    s_add_u32 s47, s47, 1
    s_cmp_lt_u32 s47, 0x40000
    s_cbranch_scc1 PLl_125
    s_branch PLb_83
K1_ssm:
    s_cmp_lt_u32 s16, 4
    s_cselect_b32 s22, s28, s30
    s_cselect_b32 s23, s29, s31
    s_mov_b32 s8, s22
    s_mov_b32 s9, s23
    s_mov_b32 s10, 663552
    s_mov_b32 s11, 0x20000
    s_load_dwordx4 s[28:31], s[0:1], 40
    s_mul_i32 s39, s3, 5
    s_and_b32 s40, s16, 3
    s_lshl_b32 s41, s40, 3
    s_lshl_b32 s38, s39, 4
    s_add_u32 s41, s41, s38
    v_lshrrev_b32 v8, 3, v0
    v_add_u32 v8, s41, v8
    v_mul_u32_u24 v8, 1152, v8
    s_and_b32 s41, s16, 1
    s_lshl_b32 s41, s41, 2
    v_lshrrev_b32 v9, 4, v0
    v_add_u32 v9, s41, v9
    v_and_b32 v10, 7, v0
    v_xor_b32 v9, v9, v10
    v_and_b32 v10, 15, v0
    v_lshrrev_b32 v11, 1, v10
    v_lshrrev_b32 v12, 4, v0
    v_xor_b32 v11, v11, v12
    v_lshlrev_b32 v11, 4, v11
    v_lshl_add_u32 v2, v10, 7, v11
    v_add_u32 v2, 2048, v2
    v_xor_b32 v3, 64, v2
    v_add_u32 v4, 49152, v2
    v_add_u32 v5, 49152, v3
    v_add_u32 v6, 98304, v2
    v_add_u32 v7, 98304, v3
    v_lshl_add_u32 v255, v9, 4, v8
    s_lshr_b32 s41, s16, 2
    s_mul_i32 s41, s41, 12288
    s_lshl_b32 s43, s40, 10
    s_add_u32 s43, s43, s41
    s_add_u32 s43, s43, 2048
    s_load_dwordx4 s[60:63], s[0:1], 8
    s_load_dwordx2 s[44:45], s[0:1], 56
    s_and_b32 s40, s16, 1
    s_lshl_b32 s40, s40, 6
    v_add_u32 v16, s40, v0
    v_min_u32 v16, 79, v16
    v_add_u32 v17, s38, v16
    v_lshlrev_b32 v17, 1, v17
    s_waitcnt lgkmcnt(0)
    s_mov_b32 s12, s60
    s_mov_b32 s13, s61
    s_mov_b32 s14, 1152
    s_mov_b32 s15, 0x20000
    buffer_load_ushort v19, v17, s[12:15], 0 offen
    s_mov_b32 s12, s62
    s_mov_b32 s13, s63
    s_mov_b32 s14, 1152
    s_mov_b32 s15, 0x20000
    buffer_load_ushort v20, v17, s[12:15], 0 offen
    s_mov_b32 s12, s44
    s_mov_b32 s13, s45
    s_mov_b32 s14, 1152
    s_mov_b32 s15, 0x20000
    buffer_load_ushort v21, v17, s[12:15], 0 offen
    s_lshl_b32 s41, s101, 7
    s_add_u32 s41, s41, 42618880
    v_and_b32 v100, 31, v0
    v_lshlrev_b32 v100, 7, v100
    s_lshl_b32 s40, s17, 12
    s_add_u32 s40, s40, 42618880
    s_waitcnt vmcnt(3)
    s_cmp_ge_u32 s16, 2
    s_cbranch_scc1 LNnn_130
    s_mov_b32 s47, 0
NCl_132:
    v_cmp_eq_u32 vcc, 0, v99
    s_cbranch_vccz NCs_131
    buffer_load_dwordx2 v[98:99], v97, s[24:27], 0 offen sc1
    s_waitcnt vmcnt(0)
    s_add_u32 s47, s47, 1
    s_cmp_lt_u32 s47, 0x40000
    s_cbranch_scc1 NCl_132
NCs_131:
LNnn_130:
    s_barrier
    s_cmp_lg_u32 s16, 0
    s_cbranch_scc1 LNw1_129
    v_lshrrev_b32 v100, 1, v1
    s_mov_b64 exec, 0xffff
    buffer_store_dwordx2 v[98:99], v100, s[4:7], s41 offen sc1
    s_mov_b64 exec, -1
LNw1_129:
    s_add_u32 m0, s43, 0
    s_mov_b32 s41, 0
    buffer_load_dwordx4 v255, s[8:11], s41 offen lds
    s_add_u32 m0, s43, 4096
    s_mov_b32 s41, 36864
    buffer_load_dwordx4 v255, s[8:11], s41 offen lds
    s_add_u32 m0, s43, 8192
    s_mov_b32 s41, 73728
    buffer_load_dwordx4 v255, s[8:11], s41 offen lds
    s_add_u32 m0, s43, 24576
    s_mov_b32 s41, 128
    buffer_load_dwordx4 v255, s[8:11], s41 offen lds
    s_add_u32 m0, s43, 28672
    s_mov_b32 s41, 36992
    buffer_load_dwordx4 v255, s[8:11], s41 offen lds
    s_add_u32 m0, s43, 32768
    s_mov_b32 s41, 73856
    buffer_load_dwordx4 v255, s[8:11], s41 offen lds
    s_cmp_lg_u32 s16, 1
    s_cbranch_scc1 LNgo_126
    s_mov_b32 s47, 0
    s_sleep 8
    buffer_load_dwordx2 v[102:103], v100, s[4:7], s40 offen sc1
    s_sleep 4
    buffer_load_dwordx2 v[104:105], v100, s[4:7], s40 offen sc1
    s_sleep 4
    buffer_load_dwordx2 v[106:107], v100, s[4:7], s40 offen sc1
    s_sleep 4
LNp_127:
    buffer_load_dwordx2 v[108:109], v100, s[4:7], s40 offen sc1
    s_waitcnt vmcnt(3)
    v_cmp_ne_u64 vcc, v[98:99], v[102:103]
    s_cbranch_vccz LNok_128
    buffer_load_dwordx2 v[102:103], v100, s[4:7], s40 offen sc1
    s_waitcnt vmcnt(3)
    v_cmp_ne_u64 vcc, v[98:99], v[104:105]
    s_cbranch_vccz LNok_128
    buffer_load_dwordx2 v[104:105], v100, s[4:7], s40 offen sc1
    s_waitcnt vmcnt(3)
    v_cmp_ne_u64 vcc, v[98:99], v[106:107]
    s_cbranch_vccz LNok_128
    buffer_load_dwordx2 v[106:107], v100, s[4:7], s40 offen sc1
    s_waitcnt vmcnt(3)
    v_cmp_ne_u64 vcc, v[98:99], v[108:109]
    s_cbranch_vccz LNok_128
    s_add_u32 s47, s47, 1
    s_cmp_lt_u32 s47, 0x20000
    s_cbranch_scc1 LNp_127
LNok_128:
    s_and_b32 s40, s101, 31
    s_cmp_lg_u32 s40, 0
    s_cbranch_scc1 LNgo_126
    s_lshl_b32 s40, s17, 2
    v_mov_b32 v100, 1
    s_mov_b64 exec, 1
    buffer_store_dword v100, v1, s[24:27], s40 offen offset:128 sc1
    s_mov_b64 exec, -1
LNgo_126:
    s_cmp_lt_u32 s16, 2
    s_cbranch_scc1 CTs_133
    s_waitcnt vmcnt(6)
    v_lshlrev_b32 v19, 16, v19
    v_lshlrev_b32 v20, 16, v20
    v_lshlrev_b32 v21, 16, v21
    v_mul_f32 v21, 0x3fb8aa3b, v21
    v_exp_f32 v21, v21
    s_nop 0
    v_cvt_pk_bf16_f32 v21, v21, v21
    v_and_b32 v21, 0xffff0000, v21
    v_mul_f32 v22, v21, v19
    v_mul_f32 v23, v21, v20
    v_mul_f32 v22, 0x3fb8aa3b, v22
    v_exp_f32 v22, v22
    v_mul_f32 v23, 0x3e22f983, v23
    v_fract_f32 v23, v23
    v_cos_f32 v24, v23
    v_sin_f32 v25, v23
    s_nop 0
    v_mul_f32 v32, v22, v24
    v_mul_f32 v33, v22, v25
    v_add_f32 v22, -1.0, v32
    v_mul_f32 v23, v19, v19
    v_fmac_f32 v23, v20, v20
    v_rcp_f32 v23, v23
    v_mul_f32 v24, v22, v19
    v_fmac_f32 v24, v33, v20
    v_mul_f32 v25, v33, v19
    v_fma_f32 v25, -v22, v20, v25
    v_add_f32 v23, v23, v23
    v_mul_f32 v34, v24, v23
    v_mul_f32 v35, v25, v23
    v_mul_f32 v26, v33, v33
    v_mul_f32 v27, v32, v33
    v_fma_f32 v22, v32, v32, -v26
    v_add_f32 v23, v27, v27
    v_mul_f32 v26, v23, v23
    v_mul_f32 v27, v22, v23
    v_fma_f32 v24, v22, v22, -v26
    v_add_f32 v25, v27, v27
    v_mul_f32 v26, v25, v25
    v_mul_f32 v27, v24, v25
    v_fma_f32 v42, v24, v24, -v26
    v_add_f32 v43, v27, v27
    v_mul_f32 v26, v43, v43
    v_mul_f32 v27, v42, v43
    v_fma_f32 v44, v42, v42, -v26
    v_add_f32 v45, v27, v27
    v_mul_f32 v26, v45, v43
    v_fma_f32 v46, v44, v42, -v26
    v_mul_f32 v26, v44, v43
    v_fma_f32 v47, v45, v42, v26
    v_mov_b32 v40, 1.0
    v_mov_b32 v41, 0
    v_mul_f32 v26, v45, v45
    v_mul_f32 v27, v44, v45
    v_fma_f32 v36, v44, v44, -v26
    v_add_f32 v37, v27, v27
    v_mul_f32 v26, v37, v37
    v_mul_f32 v27, v36, v37
    v_fma_f32 v22, v36, v36, -v26
    v_add_f32 v23, v27, v27
    v_mul_f32 v26, v23, v23
    v_mul_f32 v27, v22, v23
    v_fma_f32 v24, v22, v22, -v26
    v_add_f32 v25, v27, v27
    v_mul_f32 v26, v25, v25
    v_mul_f32 v27, v24, v25
    v_fma_f32 v38, v24, v24, -v26
    v_add_f32 v39, v27, v27
    v_lshlrev_b32 v16, 6, v16
    v_add_u32 v16, 149504, v16
    ds_write_b128 v16, v[32:35] offset:0
    ds_write_b128 v16, v[36:39] offset:16
    ds_write_b128 v16, v[40:43] offset:32
    ds_write_b128 v16, v[44:47] offset:48
CTs_133:
    s_add_u32 m0, s43, 49152
    s_mov_b32 s41, 256
    buffer_load_dwordx4 v255, s[8:11], s41 offen lds
    s_add_u32 m0, s43, 53248
    s_mov_b32 s41, 37120
    buffer_load_dwordx4 v255, s[8:11], s41 offen lds
    s_add_u32 m0, s43, 57344
    s_mov_b32 s41, 73984
    buffer_load_dwordx4 v255, s[8:11], s41 offen lds
    s_add_u32 m0, s43, 73728
    s_mov_b32 s41, 384
    buffer_load_dwordx4 v255, s[8:11], s41 offen lds
    s_add_u32 m0, s43, 77824
    s_mov_b32 s41, 37248
    buffer_load_dwordx4 v255, s[8:11], s41 offen lds
    s_add_u32 m0, s43, 81920
    s_mov_b32 s41, 74112
    buffer_load_dwordx4 v255, s[8:11], s41 offen lds
    s_add_u32 m0, s43, 98304
    s_mov_b32 s41, 512
    buffer_load_dwordx4 v255, s[8:11], s41 offen lds
    s_add_u32 m0, s43, 102400
    s_mov_b32 s41, 37376
    buffer_load_dwordx4 v255, s[8:11], s41 offen lds
    s_add_u32 m0, s43, 106496
    s_mov_b32 s41, 74240
    buffer_load_dwordx4 v255, s[8:11], s41 offen lds
    s_waitcnt vmcnt(12)
    s_waitcnt lgkmcnt(0)
    s_barrier
    s_add_u32 s36, s32, 0
    buffer_load_dwordx4 v[112:115], v1, s[4:7], s36 offen offset:0 sc1
    buffer_load_dwordx4 v[120:123], v1, s[4:7], s36 offen offset:1024 sc1
    s_add_u32 s37, s33, 0
    buffer_load_dwordx4 v[116:119], v1, s[4:7], s37 offen offset:0 sc1
    buffer_load_dwordx4 v[124:127], v1, s[4:7], s37 offen offset:1024 sc1
    s_add_u32 s36, s32, 2048
    buffer_load_dwordx4 v[128:131], v1, s[4:7], s36 offen offset:0 sc1
    buffer_load_dwordx4 v[136:139], v1, s[4:7], s36 offen offset:1024 sc1
    s_add_u32 s37, s33, 2048
    buffer_load_dwordx4 v[132:135], v1, s[4:7], s37 offen offset:0 sc1
    buffer_load_dwordx4 v[140:143], v1, s[4:7], s37 offen offset:1024 sc1
    s_cmp_lt_u32 s16, 4
    s_cselect_b32 s22, s52, s54
    s_cselect_b32 s23, s53, s55
    s_mov_b32 s12, s22
    s_mov_b32 s13, s23
    s_mov_b32 s14, 5308416
    s_mov_b32 s15, 0x20000
    v_mul_u32_u24 v8, 86, v0
    v_lshrrev_b32 v8, 8, v8
    v_mul_u32_u24 v9, 3, v8
    v_sub_u32 v9, v0, v9
    v_min_u32 v8, 17, v8
    v_mul_u32_u24 v8, 9216, v8
    v_mul_u32_u24 v9, 384, v9
    v_add_u32 v8, v8, v9
    s_lshl_b32 s40, s17, 2
    s_and_b32 s41, s16, 3
    s_add_u32 s40, s40, s41
    s_mul_i32 s40, s40, 165888
    s_mul_i32 s41, s3, 1152
    s_add_u32 s40, s40, s41
    s_mov_b32 m0, 157696
    s_nop 0
    buffer_load_dword v8, s[12:15], s40 offen offset:128 lds
    buffer_load_dword v8, s[12:15], s40 offen offset:256 lds
    ds_read_b128 v[8:11], v2 offset:0
    ds_read_b128 v[12:15], v3 offset:0
    ds_read_b128 v[16:19], v2 offset:12288
    ds_read_b128 v[20:23], v3 offset:12288
    s_waitcnt vmcnt(6)
    s_waitcnt lgkmcnt(2)
    v_mfma_f32_16x16x32_bf16 v[32:35], v[112:115], v[8:11], 0
    ds_read_b128 v[24:27], v2 offset:2048
    v_mfma_f32_16x16x32_bf16 v[32:35], v[120:123], v[12:15], v[32:35]
    v_mfma_f32_16x16x32_bf16 v[36:39], v[116:119], v[8:11], 0
    ds_read_b128 v[28:31], v3 offset:2048
    v_mfma_f32_16x16x32_bf16 v[36:39], v[124:127], v[12:15], v[36:39]
    s_waitcnt lgkmcnt(2)
    v_mfma_f32_16x16x32_bf16 v[40:43], v[112:115], v[16:19], 0
    ds_read_b128 v[8:11], v2 offset:14336
    v_mfma_f32_16x16x32_bf16 v[40:43], v[120:123], v[20:23], v[40:43]
    s_add_u32 s36, s32, 4096
    buffer_load_dwordx4 v[144:147], v1, s[4:7], s36 offen offset:0 sc1
    v_mfma_f32_16x16x32_bf16 v[44:47], v[116:119], v[16:19], 0
    ds_read_b128 v[12:15], v3 offset:14336
    v_mfma_f32_16x16x32_bf16 v[44:47], v[124:127], v[20:23], v[44:47]
    s_waitcnt lgkmcnt(2)
    v_mfma_f32_16x16x32_bf16 v[48:51], v[112:115], v[24:27], 0
    ds_read_b128 v[16:19], v2 offset:4096
    v_mfma_f32_16x16x32_bf16 v[48:51], v[120:123], v[28:31], v[48:51]
    buffer_load_dwordx4 v[152:155], v1, s[4:7], s36 offen offset:1024 sc1
    v_mfma_f32_16x16x32_bf16 v[52:55], v[116:119], v[24:27], 0
    ds_read_b128 v[20:23], v3 offset:4096
    v_mfma_f32_16x16x32_bf16 v[52:55], v[124:127], v[28:31], v[52:55]
    s_waitcnt lgkmcnt(2)
    v_mfma_f32_16x16x32_bf16 v[56:59], v[112:115], v[8:11], 0
    ds_read_b128 v[24:27], v2 offset:16384
    v_mfma_f32_16x16x32_bf16 v[56:59], v[120:123], v[12:15], v[56:59]
    v_mfma_f32_16x16x32_bf16 v[60:63], v[116:119], v[8:11], 0
    ds_read_b128 v[28:31], v3 offset:16384
    v_mfma_f32_16x16x32_bf16 v[60:63], v[124:127], v[12:15], v[60:63]
    s_waitcnt lgkmcnt(2)
    v_mfma_f32_16x16x32_bf16 v[64:67], v[112:115], v[16:19], 0
    ds_read_b128 v[8:11], v2 offset:6144
    v_mfma_f32_16x16x32_bf16 v[64:67], v[120:123], v[20:23], v[64:67]
    s_add_u32 s37, s33, 4096
    buffer_load_dwordx4 v[148:151], v1, s[4:7], s37 offen offset:0 sc1
    v_mfma_f32_16x16x32_bf16 v[68:71], v[116:119], v[16:19], 0
    ds_read_b128 v[12:15], v3 offset:6144
    v_mfma_f32_16x16x32_bf16 v[68:71], v[124:127], v[20:23], v[68:71]
    s_waitcnt lgkmcnt(2)
    v_mfma_f32_16x16x32_bf16 v[72:75], v[112:115], v[24:27], 0
    ds_read_b128 v[16:19], v2 offset:18432
    v_mfma_f32_16x16x32_bf16 v[72:75], v[120:123], v[28:31], v[72:75]
    buffer_load_dwordx4 v[156:159], v1, s[4:7], s37 offen offset:1024 sc1
    v_mfma_f32_16x16x32_bf16 v[76:79], v[116:119], v[24:27], 0
    ds_read_b128 v[20:23], v3 offset:18432
    v_mfma_f32_16x16x32_bf16 v[76:79], v[124:127], v[28:31], v[76:79]
    s_waitcnt lgkmcnt(2)
    v_mfma_f32_16x16x32_bf16 v[80:83], v[112:115], v[8:11], 0
    ds_read_b128 v[24:27], v2 offset:8192
    v_mfma_f32_16x16x32_bf16 v[80:83], v[120:123], v[12:15], v[80:83]
    v_mfma_f32_16x16x32_bf16 v[84:87], v[116:119], v[8:11], 0
    ds_read_b128 v[28:31], v3 offset:8192
    v_mfma_f32_16x16x32_bf16 v[84:87], v[124:127], v[12:15], v[84:87]
    s_waitcnt lgkmcnt(2)
    v_mfma_f32_16x16x32_bf16 v[88:91], v[112:115], v[16:19], 0
    ds_read_b128 v[8:11], v2 offset:20480
    v_mfma_f32_16x16x32_bf16 v[88:91], v[120:123], v[20:23], v[88:91]
    v_mfma_f32_16x16x32_bf16 v[92:95], v[116:119], v[16:19], 0
    ds_read_b128 v[12:15], v3 offset:20480
    v_mfma_f32_16x16x32_bf16 v[92:95], v[124:127], v[20:23], v[92:95]
    s_barrier
    s_waitcnt lgkmcnt(2)
    v_mfma_f32_16x16x32_bf16 v[96:99], v[112:115], v[24:27], 0
    ds_read_b128 v[16:19], v2 offset:24576
    v_mfma_f32_16x16x32_bf16 v[96:99], v[120:123], v[28:31], v[96:99]
    v_mfma_f32_16x16x32_bf16 v[100:103], v[116:119], v[24:27], 0
    ds_read_b128 v[20:23], v3 offset:24576
    v_mfma_f32_16x16x32_bf16 v[100:103], v[124:127], v[28:31], v[100:103]
    s_waitcnt lgkmcnt(2)
    v_mfma_f32_16x16x32_bf16 v[104:107], v[112:115], v[8:11], 0
    ds_read_b128 v[24:27], v2 offset:36864
    v_mfma_f32_16x16x32_bf16 v[104:107], v[120:123], v[12:15], v[104:107]
    v_mfma_f32_16x16x32_bf16 v[108:111], v[116:119], v[8:11], 0
    ds_read_b128 v[28:31], v3 offset:36864
    v_mfma_f32_16x16x32_bf16 v[108:111], v[124:127], v[12:15], v[108:111]
    s_waitcnt vmcnt(6)
    s_waitcnt lgkmcnt(2)
    v_mfma_f32_16x16x32_bf16 v[32:35], v[128:131], v[16:19], v[32:35]
    ds_read_b128 v[8:11], v2 offset:26624
    v_mfma_f32_16x16x32_bf16 v[32:35], v[136:139], v[20:23], v[32:35]
    s_add_u32 s36, s32, 6144
    buffer_load_dwordx4 v[160:163], v1, s[4:7], s36 offen offset:0 sc1
    v_mfma_f32_16x16x32_bf16 v[36:39], v[132:135], v[16:19], v[36:39]
    ds_read_b128 v[12:15], v3 offset:26624
    v_mfma_f32_16x16x32_bf16 v[36:39], v[140:143], v[20:23], v[36:39]
    s_waitcnt lgkmcnt(2)
    v_mfma_f32_16x16x32_bf16 v[40:43], v[128:131], v[24:27], v[40:43]
    ds_read_b128 v[16:19], v2 offset:38912
    v_mfma_f32_16x16x32_bf16 v[40:43], v[136:139], v[28:31], v[40:43]
    buffer_load_dwordx4 v[168:171], v1, s[4:7], s36 offen offset:1024 sc1
    v_mfma_f32_16x16x32_bf16 v[44:47], v[132:135], v[24:27], v[44:47]
    ds_read_b128 v[20:23], v3 offset:38912
    v_mfma_f32_16x16x32_bf16 v[44:47], v[140:143], v[28:31], v[44:47]
    s_waitcnt lgkmcnt(2)
    v_mfma_f32_16x16x32_bf16 v[48:51], v[128:131], v[8:11], v[48:51]
    ds_read_b128 v[24:27], v2 offset:28672
    v_mfma_f32_16x16x32_bf16 v[48:51], v[136:139], v[12:15], v[48:51]
    s_add_u32 s37, s33, 6144
    buffer_load_dwordx4 v[164:167], v1, s[4:7], s37 offen offset:0 sc1
    v_mfma_f32_16x16x32_bf16 v[52:55], v[132:135], v[8:11], v[52:55]
    ds_read_b128 v[28:31], v3 offset:28672
    v_mfma_f32_16x16x32_bf16 v[52:55], v[140:143], v[12:15], v[52:55]
    s_waitcnt lgkmcnt(2)
    v_mfma_f32_16x16x32_bf16 v[56:59], v[128:131], v[16:19], v[56:59]
    ds_read_b128 v[8:11], v2 offset:40960
    v_mfma_f32_16x16x32_bf16 v[56:59], v[136:139], v[20:23], v[56:59]
    buffer_load_dwordx4 v[172:175], v1, s[4:7], s37 offen offset:1024 sc1
    v_mfma_f32_16x16x32_bf16 v[60:63], v[132:135], v[16:19], v[60:63]
    ds_read_b128 v[12:15], v3 offset:40960
    v_mfma_f32_16x16x32_bf16 v[60:63], v[140:143], v[20:23], v[60:63]
    s_waitcnt lgkmcnt(2)
    v_mfma_f32_16x16x32_bf16 v[64:67], v[128:131], v[24:27], v[64:67]
    ds_read_b128 v[16:19], v2 offset:30720
    v_mfma_f32_16x16x32_bf16 v[64:67], v[136:139], v[28:31], v[64:67]
    s_add_u32 m0, s43, 122880
    s_mov_b32 s41, 640
    buffer_load_dwordx4 v255, s[8:11], s41 offen lds
    v_mfma_f32_16x16x32_bf16 v[68:71], v[132:135], v[24:27], v[68:71]
    ds_read_b128 v[20:23], v3 offset:30720
    v_mfma_f32_16x16x32_bf16 v[68:71], v[140:143], v[28:31], v[68:71]
    s_waitcnt lgkmcnt(2)
    v_mfma_f32_16x16x32_bf16 v[72:75], v[128:131], v[8:11], v[72:75]
    ds_read_b128 v[24:27], v2 offset:43008
    v_mfma_f32_16x16x32_bf16 v[72:75], v[136:139], v[12:15], v[72:75]
    s_add_u32 m0, s43, 126976
    s_mov_b32 s41, 37504
    buffer_load_dwordx4 v255, s[8:11], s41 offen lds
    s_add_u32 m0, s43, 131072
    s_mov_b32 s41, 74368
    buffer_load_dwordx4 v255, s[8:11], s41 offen lds
    v_mfma_f32_16x16x32_bf16 v[76:79], v[132:135], v[8:11], v[76:79]
    ds_read_b128 v[28:31], v3 offset:43008
    v_mfma_f32_16x16x32_bf16 v[76:79], v[140:143], v[12:15], v[76:79]
    s_waitcnt lgkmcnt(2)
    v_mfma_f32_16x16x32_bf16 v[80:83], v[128:131], v[16:19], v[80:83]
    ds_read_b128 v[8:11], v2 offset:32768
    v_mfma_f32_16x16x32_bf16 v[80:83], v[136:139], v[20:23], v[80:83]
    v_mfma_f32_16x16x32_bf16 v[84:87], v[132:135], v[16:19], v[84:87]
    ds_read_b128 v[12:15], v3 offset:32768
    v_mfma_f32_16x16x32_bf16 v[84:87], v[140:143], v[20:23], v[84:87]
    s_waitcnt lgkmcnt(2)
    v_mfma_f32_16x16x32_bf16 v[88:91], v[128:131], v[24:27], v[88:91]
    ds_read_b128 v[16:19], v2 offset:45056
    v_mfma_f32_16x16x32_bf16 v[88:91], v[136:139], v[28:31], v[88:91]
    v_mfma_f32_16x16x32_bf16 v[92:95], v[132:135], v[24:27], v[92:95]
    ds_read_b128 v[20:23], v3 offset:45056
    v_mfma_f32_16x16x32_bf16 v[92:95], v[140:143], v[28:31], v[92:95]
    s_waitcnt lgkmcnt(2)
    v_mfma_f32_16x16x32_bf16 v[96:99], v[128:131], v[8:11], v[96:99]
    ds_read_b128 v[24:27], v4 offset:0
    v_mfma_f32_16x16x32_bf16 v[96:99], v[136:139], v[12:15], v[96:99]
    v_mfma_f32_16x16x32_bf16 v[100:103], v[132:135], v[8:11], v[100:103]
    ds_read_b128 v[28:31], v5 offset:0
    v_mfma_f32_16x16x32_bf16 v[100:103], v[140:143], v[12:15], v[100:103]
    s_waitcnt lgkmcnt(2)
    v_mfma_f32_16x16x32_bf16 v[104:107], v[128:131], v[16:19], v[104:107]
    ds_read_b128 v[8:11], v4 offset:12288
    v_mfma_f32_16x16x32_bf16 v[104:107], v[136:139], v[20:23], v[104:107]
    v_mfma_f32_16x16x32_bf16 v[108:111], v[132:135], v[16:19], v[108:111]
    ds_read_b128 v[12:15], v5 offset:12288
    v_mfma_f32_16x16x32_bf16 v[108:111], v[140:143], v[20:23], v[108:111]
    s_waitcnt vmcnt(7)
    s_waitcnt lgkmcnt(2)
    v_mfma_f32_16x16x32_bf16 v[32:35], v[144:147], v[24:27], v[32:35]
    ds_read_b128 v[16:19], v4 offset:2048
    v_mfma_f32_16x16x32_bf16 v[32:35], v[152:155], v[28:31], v[32:35]
    v_mfma_f32_16x16x32_bf16 v[36:39], v[148:151], v[24:27], v[36:39]
    ds_read_b128 v[20:23], v5 offset:2048
    v_mfma_f32_16x16x32_bf16 v[36:39], v[156:159], v[28:31], v[36:39]
    s_waitcnt lgkmcnt(2)
    v_mfma_f32_16x16x32_bf16 v[40:43], v[144:147], v[8:11], v[40:43]
    ds_read_b128 v[24:27], v4 offset:14336
    v_mfma_f32_16x16x32_bf16 v[40:43], v[152:155], v[12:15], v[40:43]
    s_add_u32 s36, s32, 8192
    buffer_load_dwordx4 v[176:179], v1, s[4:7], s36 offen offset:0 sc1
    v_mfma_f32_16x16x32_bf16 v[44:47], v[148:151], v[8:11], v[44:47]
    ds_read_b128 v[28:31], v5 offset:14336
    v_mfma_f32_16x16x32_bf16 v[44:47], v[156:159], v[12:15], v[44:47]
    s_waitcnt lgkmcnt(2)
    v_mfma_f32_16x16x32_bf16 v[48:51], v[144:147], v[16:19], v[48:51]
    ds_read_b128 v[8:11], v4 offset:4096
    v_mfma_f32_16x16x32_bf16 v[48:51], v[152:155], v[20:23], v[48:51]
    buffer_load_dwordx4 v[184:187], v1, s[4:7], s36 offen offset:1024 sc1
    v_mfma_f32_16x16x32_bf16 v[52:55], v[148:151], v[16:19], v[52:55]
    ds_read_b128 v[12:15], v5 offset:4096
    v_mfma_f32_16x16x32_bf16 v[52:55], v[156:159], v[20:23], v[52:55]
    s_waitcnt lgkmcnt(2)
    v_mfma_f32_16x16x32_bf16 v[56:59], v[144:147], v[24:27], v[56:59]
    ds_read_b128 v[16:19], v4 offset:16384
    v_mfma_f32_16x16x32_bf16 v[56:59], v[152:155], v[28:31], v[56:59]
    v_mfma_f32_16x16x32_bf16 v[60:63], v[148:151], v[24:27], v[60:63]
    ds_read_b128 v[20:23], v5 offset:16384
    v_mfma_f32_16x16x32_bf16 v[60:63], v[156:159], v[28:31], v[60:63]
    s_waitcnt lgkmcnt(2)
    v_mfma_f32_16x16x32_bf16 v[64:67], v[144:147], v[8:11], v[64:67]
    ds_read_b128 v[24:27], v4 offset:6144
    v_mfma_f32_16x16x32_bf16 v[64:67], v[152:155], v[12:15], v[64:67]
    s_add_u32 s37, s33, 8192
    buffer_load_dwordx4 v[180:183], v1, s[4:7], s37 offen offset:0 sc1
    v_mfma_f32_16x16x32_bf16 v[68:71], v[148:151], v[8:11], v[68:71]
    ds_read_b128 v[28:31], v5 offset:6144
    v_mfma_f32_16x16x32_bf16 v[68:71], v[156:159], v[12:15], v[68:71]
    s_waitcnt lgkmcnt(2)
    v_mfma_f32_16x16x32_bf16 v[72:75], v[144:147], v[16:19], v[72:75]
    ds_read_b128 v[8:11], v4 offset:18432
    v_mfma_f32_16x16x32_bf16 v[72:75], v[152:155], v[20:23], v[72:75]
    buffer_load_dwordx4 v[188:191], v1, s[4:7], s37 offen offset:1024 sc1
    v_mfma_f32_16x16x32_bf16 v[76:79], v[148:151], v[16:19], v[76:79]
    ds_read_b128 v[12:15], v5 offset:18432
    v_mfma_f32_16x16x32_bf16 v[76:79], v[156:159], v[20:23], v[76:79]
    s_waitcnt lgkmcnt(2)
    v_mfma_f32_16x16x32_bf16 v[80:83], v[144:147], v[24:27], v[80:83]
    ds_read_b128 v[16:19], v4 offset:8192
    v_mfma_f32_16x16x32_bf16 v[80:83], v[152:155], v[28:31], v[80:83]
    v_mfma_f32_16x16x32_bf16 v[84:87], v[148:151], v[24:27], v[84:87]
    ds_read_b128 v[20:23], v5 offset:8192
    v_mfma_f32_16x16x32_bf16 v[84:87], v[156:159], v[28:31], v[84:87]
    s_waitcnt lgkmcnt(2)
    v_mfma_f32_16x16x32_bf16 v[88:91], v[144:147], v[8:11], v[88:91]
    ds_read_b128 v[24:27], v4 offset:20480
    v_mfma_f32_16x16x32_bf16 v[88:91], v[152:155], v[12:15], v[88:91]
    v_mfma_f32_16x16x32_bf16 v[92:95], v[148:151], v[8:11], v[92:95]
    ds_read_b128 v[28:31], v5 offset:20480
    v_mfma_f32_16x16x32_bf16 v[92:95], v[156:159], v[12:15], v[92:95]
    s_waitcnt vmcnt(4)
    s_waitcnt lgkmcnt(0)
    s_barrier
    v_mfma_f32_16x16x32_bf16 v[96:99], v[144:147], v[16:19], v[96:99]
    ds_read_b128 v[8:11], v4 offset:24576
    v_mfma_f32_16x16x32_bf16 v[96:99], v[152:155], v[20:23], v[96:99]
    v_mfma_f32_16x16x32_bf16 v[100:103], v[148:151], v[16:19], v[100:103]
    ds_read_b128 v[12:15], v5 offset:24576
    v_mfma_f32_16x16x32_bf16 v[100:103], v[156:159], v[20:23], v[100:103]
    v_mfma_f32_16x16x32_bf16 v[104:107], v[144:147], v[24:27], v[104:107]
    ds_read_b128 v[16:19], v4 offset:36864
    v_mfma_f32_16x16x32_bf16 v[104:107], v[152:155], v[28:31], v[104:107]
    v_mfma_f32_16x16x32_bf16 v[108:111], v[148:151], v[24:27], v[108:111]
    ds_read_b128 v[20:23], v5 offset:36864
    v_mfma_f32_16x16x32_bf16 v[108:111], v[156:159], v[28:31], v[108:111]
    s_waitcnt lgkmcnt(2)
    v_mfma_f32_16x16x32_bf16 v[32:35], v[160:163], v[8:11], v[32:35]
    ds_read_b128 v[24:27], v4 offset:26624
    v_mfma_f32_16x16x32_bf16 v[32:35], v[168:171], v[12:15], v[32:35]
    s_add_u32 s36, s32, 10240
    buffer_load_dwordx4 v[192:195], v1, s[4:7], s36 offen offset:0 sc1
    v_mfma_f32_16x16x32_bf16 v[36:39], v[164:167], v[8:11], v[36:39]
    ds_read_b128 v[28:31], v5 offset:26624
    v_mfma_f32_16x16x32_bf16 v[36:39], v[172:175], v[12:15], v[36:39]
    s_waitcnt lgkmcnt(2)
    v_mfma_f32_16x16x32_bf16 v[40:43], v[160:163], v[16:19], v[40:43]
    ds_read_b128 v[8:11], v4 offset:38912
    v_mfma_f32_16x16x32_bf16 v[40:43], v[168:171], v[20:23], v[40:43]
    buffer_load_dwordx4 v[200:203], v1, s[4:7], s36 offen offset:1024 sc1
    s_add_u32 s37, s33, 10240
    buffer_load_dwordx4 v[196:199], v1, s[4:7], s37 offen offset:0 sc1
    v_mfma_f32_16x16x32_bf16 v[44:47], v[164:167], v[16:19], v[44:47]
    ds_read_b128 v[12:15], v5 offset:38912
    v_mfma_f32_16x16x32_bf16 v[44:47], v[172:175], v[20:23], v[44:47]
    s_waitcnt lgkmcnt(2)
    v_mfma_f32_16x16x32_bf16 v[48:51], v[160:163], v[24:27], v[48:51]
    ds_read_b128 v[16:19], v4 offset:28672
    v_mfma_f32_16x16x32_bf16 v[48:51], v[168:171], v[28:31], v[48:51]
    buffer_load_dwordx4 v[204:207], v1, s[4:7], s37 offen offset:1024 sc1
    s_add_u32 m0, s43, 0
    s_mov_b32 s41, 768
    buffer_load_dwordx4 v255, s[8:11], s41 offen lds
    v_mfma_f32_16x16x32_bf16 v[52:55], v[164:167], v[24:27], v[52:55]
    ds_read_b128 v[20:23], v5 offset:28672
    v_mfma_f32_16x16x32_bf16 v[52:55], v[172:175], v[28:31], v[52:55]
    s_waitcnt lgkmcnt(2)
    v_mfma_f32_16x16x32_bf16 v[56:59], v[160:163], v[8:11], v[56:59]
    ds_read_b128 v[24:27], v4 offset:40960
    v_mfma_f32_16x16x32_bf16 v[56:59], v[168:171], v[12:15], v[56:59]
    s_add_u32 m0, s43, 4096
    s_mov_b32 s41, 37632
    buffer_load_dwordx4 v255, s[8:11], s41 offen lds
    v_mfma_f32_16x16x32_bf16 v[60:63], v[164:167], v[8:11], v[60:63]
    ds_read_b128 v[28:31], v5 offset:40960
    v_mfma_f32_16x16x32_bf16 v[60:63], v[172:175], v[12:15], v[60:63]
    s_waitcnt lgkmcnt(2)
    v_mfma_f32_16x16x32_bf16 v[64:67], v[160:163], v[16:19], v[64:67]
    ds_read_b128 v[8:11], v4 offset:30720
    v_mfma_f32_16x16x32_bf16 v[64:67], v[168:171], v[20:23], v[64:67]
    s_add_u32 m0, s43, 8192
    s_mov_b32 s41, 74496
    buffer_load_dwordx4 v255, s[8:11], s41 offen lds
    s_add_u32 m0, s43, 24576
    s_mov_b32 s41, 896
    buffer_load_dwordx4 v255, s[8:11], s41 offen lds
    v_mfma_f32_16x16x32_bf16 v[68:71], v[164:167], v[16:19], v[68:71]
    ds_read_b128 v[12:15], v5 offset:30720
    v_mfma_f32_16x16x32_bf16 v[68:71], v[172:175], v[20:23], v[68:71]
    s_waitcnt lgkmcnt(2)
    v_mfma_f32_16x16x32_bf16 v[72:75], v[160:163], v[24:27], v[72:75]
    ds_read_b128 v[16:19], v4 offset:43008
    v_mfma_f32_16x16x32_bf16 v[72:75], v[168:171], v[28:31], v[72:75]
    s_add_u32 m0, s43, 28672
    s_mov_b32 s41, 37760
    buffer_load_dwordx4 v255, s[8:11], s41 offen lds
    s_add_u32 m0, s43, 32768
    s_mov_b32 s41, 74624
    buffer_load_dwordx4 v255, s[8:11], s41 offen lds
    v_mfma_f32_16x16x32_bf16 v[76:79], v[164:167], v[24:27], v[76:79]
    ds_read_b128 v[20:23], v5 offset:43008
    v_mfma_f32_16x16x32_bf16 v[76:79], v[172:175], v[28:31], v[76:79]
    s_waitcnt lgkmcnt(2)
    v_mfma_f32_16x16x32_bf16 v[80:83], v[160:163], v[8:11], v[80:83]
    ds_read_b128 v[24:27], v4 offset:32768
    v_mfma_f32_16x16x32_bf16 v[80:83], v[168:171], v[12:15], v[80:83]
    v_mfma_f32_16x16x32_bf16 v[84:87], v[164:167], v[8:11], v[84:87]
    ds_read_b128 v[28:31], v5 offset:32768
    v_mfma_f32_16x16x32_bf16 v[84:87], v[172:175], v[12:15], v[84:87]
    s_waitcnt lgkmcnt(2)
    v_mfma_f32_16x16x32_bf16 v[88:91], v[160:163], v[16:19], v[88:91]
    ds_read_b128 v[8:11], v4 offset:45056
    v_mfma_f32_16x16x32_bf16 v[88:91], v[168:171], v[20:23], v[88:91]
    v_mfma_f32_16x16x32_bf16 v[92:95], v[164:167], v[16:19], v[92:95]
    ds_read_b128 v[12:15], v5 offset:45056
    v_mfma_f32_16x16x32_bf16 v[92:95], v[172:175], v[20:23], v[92:95]
    s_waitcnt lgkmcnt(2)
    v_mfma_f32_16x16x32_bf16 v[96:99], v[160:163], v[24:27], v[96:99]
    ds_read_b128 v[16:19], v6 offset:0
    v_mfma_f32_16x16x32_bf16 v[96:99], v[168:171], v[28:31], v[96:99]
    v_mfma_f32_16x16x32_bf16 v[100:103], v[164:167], v[24:27], v[100:103]
    ds_read_b128 v[20:23], v7 offset:0
    v_mfma_f32_16x16x32_bf16 v[100:103], v[172:175], v[28:31], v[100:103]
    s_waitcnt lgkmcnt(2)
    v_mfma_f32_16x16x32_bf16 v[104:107], v[160:163], v[8:11], v[104:107]
    ds_read_b128 v[24:27], v6 offset:12288
    v_mfma_f32_16x16x32_bf16 v[104:107], v[168:171], v[12:15], v[104:107]
    v_mfma_f32_16x16x32_bf16 v[108:111], v[164:167], v[8:11], v[108:111]
    ds_read_b128 v[28:31], v7 offset:12288
    v_mfma_f32_16x16x32_bf16 v[108:111], v[172:175], v[12:15], v[108:111]
    s_waitcnt vmcnt(10)
    s_waitcnt lgkmcnt(2)
    v_mfma_f32_16x16x32_bf16 v[32:35], v[176:179], v[16:19], v[32:35]
    ds_read_b128 v[8:11], v6 offset:2048
    v_mfma_f32_16x16x32_bf16 v[32:35], v[184:187], v[20:23], v[32:35]
    s_add_u32 s36, s32, 12288
    buffer_load_dwordx4 v[208:211], v1, s[4:7], s36 offen offset:0 sc1
    v_mfma_f32_16x16x32_bf16 v[36:39], v[180:183], v[16:19], v[36:39]
    ds_read_b128 v[12:15], v7 offset:2048
    v_mfma_f32_16x16x32_bf16 v[36:39], v[188:191], v[20:23], v[36:39]
    s_waitcnt lgkmcnt(2)
    v_mfma_f32_16x16x32_bf16 v[40:43], v[176:179], v[24:27], v[40:43]
    ds_read_b128 v[16:19], v6 offset:14336
    v_mfma_f32_16x16x32_bf16 v[40:43], v[184:187], v[28:31], v[40:43]
    buffer_load_dwordx4 v[216:219], v1, s[4:7], s36 offen offset:1024 sc1
    v_mfma_f32_16x16x32_bf16 v[44:47], v[180:183], v[24:27], v[44:47]
    ds_read_b128 v[20:23], v7 offset:14336
    v_mfma_f32_16x16x32_bf16 v[44:47], v[188:191], v[28:31], v[44:47]
    s_waitcnt lgkmcnt(2)
    v_mfma_f32_16x16x32_bf16 v[48:51], v[176:179], v[8:11], v[48:51]
    ds_read_b128 v[24:27], v6 offset:4096
    v_mfma_f32_16x16x32_bf16 v[48:51], v[184:187], v[12:15], v[48:51]
    s_add_u32 s37, s33, 12288
    buffer_load_dwordx4 v[212:215], v1, s[4:7], s37 offen offset:0 sc1
    v_mfma_f32_16x16x32_bf16 v[52:55], v[180:183], v[8:11], v[52:55]
    ds_read_b128 v[28:31], v7 offset:4096
    v_mfma_f32_16x16x32_bf16 v[52:55], v[188:191], v[12:15], v[52:55]
    s_waitcnt lgkmcnt(2)
    v_mfma_f32_16x16x32_bf16 v[56:59], v[176:179], v[16:19], v[56:59]
    ds_read_b128 v[8:11], v6 offset:16384
    v_mfma_f32_16x16x32_bf16 v[56:59], v[184:187], v[20:23], v[56:59]
    buffer_load_dwordx4 v[220:223], v1, s[4:7], s37 offen offset:1024 sc1
    v_mfma_f32_16x16x32_bf16 v[60:63], v[180:183], v[16:19], v[60:63]
    ds_read_b128 v[12:15], v7 offset:16384
    v_mfma_f32_16x16x32_bf16 v[60:63], v[188:191], v[20:23], v[60:63]
    s_waitcnt lgkmcnt(2)
    v_mfma_f32_16x16x32_bf16 v[64:67], v[176:179], v[24:27], v[64:67]
    ds_read_b128 v[16:19], v6 offset:6144
    v_mfma_f32_16x16x32_bf16 v[64:67], v[184:187], v[28:31], v[64:67]
    s_add_u32 m0, s43, 49152
    s_mov_b32 s41, 1024
    buffer_load_dwordx4 v255, s[8:11], s41 offen lds
    v_mfma_f32_16x16x32_bf16 v[68:71], v[180:183], v[24:27], v[68:71]
    ds_read_b128 v[20:23], v7 offset:6144
    v_mfma_f32_16x16x32_bf16 v[68:71], v[188:191], v[28:31], v[68:71]
    s_waitcnt lgkmcnt(2)
    v_mfma_f32_16x16x32_bf16 v[72:75], v[176:179], v[8:11], v[72:75]
    ds_read_b128 v[24:27], v6 offset:18432
    v_mfma_f32_16x16x32_bf16 v[72:75], v[184:187], v[12:15], v[72:75]
    s_add_u32 m0, s43, 53248
    s_mov_b32 s41, 37888
    buffer_load_dwordx4 v255, s[8:11], s41 offen lds
    s_add_u32 m0, s43, 57344
    s_mov_b32 s41, 74752
    buffer_load_dwordx4 v255, s[8:11], s41 offen lds
    v_mfma_f32_16x16x32_bf16 v[76:79], v[180:183], v[8:11], v[76:79]
    ds_read_b128 v[28:31], v7 offset:18432
    v_mfma_f32_16x16x32_bf16 v[76:79], v[188:191], v[12:15], v[76:79]
    s_waitcnt lgkmcnt(2)
    v_mfma_f32_16x16x32_bf16 v[80:83], v[176:179], v[16:19], v[80:83]
    ds_read_b128 v[8:11], v6 offset:8192
    v_mfma_f32_16x16x32_bf16 v[80:83], v[184:187], v[20:23], v[80:83]
    v_mfma_f32_16x16x32_bf16 v[84:87], v[180:183], v[16:19], v[84:87]
    ds_read_b128 v[12:15], v7 offset:8192
    v_mfma_f32_16x16x32_bf16 v[84:87], v[188:191], v[20:23], v[84:87]
    s_waitcnt lgkmcnt(2)
    v_mfma_f32_16x16x32_bf16 v[88:91], v[176:179], v[24:27], v[88:91]
    ds_read_b128 v[16:19], v6 offset:20480
    v_mfma_f32_16x16x32_bf16 v[88:91], v[184:187], v[28:31], v[88:91]
    v_mfma_f32_16x16x32_bf16 v[92:95], v[180:183], v[24:27], v[92:95]
    ds_read_b128 v[20:23], v7 offset:20480
    v_mfma_f32_16x16x32_bf16 v[92:95], v[188:191], v[28:31], v[92:95]
    s_waitcnt lgkmcnt(2)
    v_mfma_f32_16x16x32_bf16 v[96:99], v[176:179], v[8:11], v[96:99]
    ds_read_b128 v[24:27], v6 offset:24576
    v_mfma_f32_16x16x32_bf16 v[96:99], v[184:187], v[12:15], v[96:99]
    v_mfma_f32_16x16x32_bf16 v[100:103], v[180:183], v[8:11], v[100:103]
    ds_read_b128 v[28:31], v7 offset:24576
    v_mfma_f32_16x16x32_bf16 v[100:103], v[188:191], v[12:15], v[100:103]
    s_waitcnt lgkmcnt(2)
    v_mfma_f32_16x16x32_bf16 v[104:107], v[176:179], v[16:19], v[104:107]
    ds_read_b128 v[8:11], v6 offset:36864
    v_mfma_f32_16x16x32_bf16 v[104:107], v[184:187], v[20:23], v[104:107]
    v_mfma_f32_16x16x32_bf16 v[108:111], v[180:183], v[16:19], v[108:111]
    ds_read_b128 v[12:15], v7 offset:36864
    v_mfma_f32_16x16x32_bf16 v[108:111], v[188:191], v[20:23], v[108:111]
    s_waitcnt vmcnt(13)
    s_waitcnt lgkmcnt(2)
    v_mfma_f32_16x16x32_bf16 v[32:35], v[192:195], v[24:27], v[32:35]
    ds_read_b128 v[16:19], v6 offset:26624
    v_mfma_f32_16x16x32_bf16 v[32:35], v[200:203], v[28:31], v[32:35]
    v_mfma_f32_16x16x32_bf16 v[36:39], v[196:199], v[24:27], v[36:39]
    ds_read_b128 v[20:23], v7 offset:26624
    v_mfma_f32_16x16x32_bf16 v[36:39], v[204:207], v[28:31], v[36:39]
    s_waitcnt lgkmcnt(2)
    v_mfma_f32_16x16x32_bf16 v[40:43], v[192:195], v[8:11], v[40:43]
    ds_read_b128 v[24:27], v6 offset:38912
    v_mfma_f32_16x16x32_bf16 v[40:43], v[200:203], v[12:15], v[40:43]
    s_add_u32 s36, s32, 14336
    buffer_load_dwordx4 v[224:227], v1, s[4:7], s36 offen offset:0 sc1
    v_mfma_f32_16x16x32_bf16 v[44:47], v[196:199], v[8:11], v[44:47]
    ds_read_b128 v[28:31], v7 offset:38912
    v_mfma_f32_16x16x32_bf16 v[44:47], v[204:207], v[12:15], v[44:47]
    s_waitcnt lgkmcnt(2)
    v_mfma_f32_16x16x32_bf16 v[48:51], v[192:195], v[16:19], v[48:51]
    ds_read_b128 v[8:11], v6 offset:28672
    v_mfma_f32_16x16x32_bf16 v[48:51], v[200:203], v[20:23], v[48:51]
    buffer_load_dwordx4 v[232:235], v1, s[4:7], s36 offen offset:1024 sc1
    v_mfma_f32_16x16x32_bf16 v[52:55], v[196:199], v[16:19], v[52:55]
    ds_read_b128 v[12:15], v7 offset:28672
    v_mfma_f32_16x16x32_bf16 v[52:55], v[204:207], v[20:23], v[52:55]
    s_waitcnt lgkmcnt(2)
    v_mfma_f32_16x16x32_bf16 v[56:59], v[192:195], v[24:27], v[56:59]
    ds_read_b128 v[16:19], v6 offset:40960
    v_mfma_f32_16x16x32_bf16 v[56:59], v[200:203], v[28:31], v[56:59]
    v_mfma_f32_16x16x32_bf16 v[60:63], v[196:199], v[24:27], v[60:63]
    ds_read_b128 v[20:23], v7 offset:40960
    v_mfma_f32_16x16x32_bf16 v[60:63], v[204:207], v[28:31], v[60:63]
    s_waitcnt lgkmcnt(2)
    v_mfma_f32_16x16x32_bf16 v[64:67], v[192:195], v[8:11], v[64:67]
    ds_read_b128 v[24:27], v6 offset:30720
    v_mfma_f32_16x16x32_bf16 v[64:67], v[200:203], v[12:15], v[64:67]
    s_add_u32 s37, s33, 14336
    buffer_load_dwordx4 v[228:231], v1, s[4:7], s37 offen offset:0 sc1
    v_mfma_f32_16x16x32_bf16 v[68:71], v[196:199], v[8:11], v[68:71]
    ds_read_b128 v[28:31], v7 offset:30720
    v_mfma_f32_16x16x32_bf16 v[68:71], v[204:207], v[12:15], v[68:71]
    s_waitcnt lgkmcnt(2)
    v_mfma_f32_16x16x32_bf16 v[72:75], v[192:195], v[16:19], v[72:75]
    ds_read_b128 v[8:11], v6 offset:43008
    v_mfma_f32_16x16x32_bf16 v[72:75], v[200:203], v[20:23], v[72:75]
    buffer_load_dwordx4 v[236:239], v1, s[4:7], s37 offen offset:1024 sc1
    v_mfma_f32_16x16x32_bf16 v[76:79], v[196:199], v[16:19], v[76:79]
    ds_read_b128 v[12:15], v7 offset:43008
    v_mfma_f32_16x16x32_bf16 v[76:79], v[204:207], v[20:23], v[76:79]
    s_waitcnt lgkmcnt(2)
    v_mfma_f32_16x16x32_bf16 v[80:83], v[192:195], v[24:27], v[80:83]
    ds_read_b128 v[16:19], v6 offset:32768
    v_mfma_f32_16x16x32_bf16 v[80:83], v[200:203], v[28:31], v[80:83]
    v_mfma_f32_16x16x32_bf16 v[84:87], v[196:199], v[24:27], v[84:87]
    ds_read_b128 v[20:23], v7 offset:32768
    v_mfma_f32_16x16x32_bf16 v[84:87], v[204:207], v[28:31], v[84:87]
    s_waitcnt lgkmcnt(2)
    v_mfma_f32_16x16x32_bf16 v[88:91], v[192:195], v[8:11], v[88:91]
    ds_read_b128 v[24:27], v6 offset:45056
    v_mfma_f32_16x16x32_bf16 v[88:91], v[200:203], v[12:15], v[88:91]
    v_mfma_f32_16x16x32_bf16 v[92:95], v[196:199], v[8:11], v[92:95]
    ds_read_b128 v[28:31], v7 offset:45056
    v_mfma_f32_16x16x32_bf16 v[92:95], v[204:207], v[12:15], v[92:95]
    s_waitcnt vmcnt(4)
    s_barrier
    s_waitcnt lgkmcnt(2)
    v_mfma_f32_16x16x32_bf16 v[96:99], v[192:195], v[16:19], v[96:99]
    ds_read_b128 v[8:11], v2 offset:0
    v_mfma_f32_16x16x32_bf16 v[96:99], v[200:203], v[20:23], v[96:99]
    v_mfma_f32_16x16x32_bf16 v[100:103], v[196:199], v[16:19], v[100:103]
    ds_read_b128 v[12:15], v3 offset:0
    v_mfma_f32_16x16x32_bf16 v[100:103], v[204:207], v[20:23], v[100:103]
    s_waitcnt lgkmcnt(2)
    v_mfma_f32_16x16x32_bf16 v[104:107], v[192:195], v[24:27], v[104:107]
    ds_read_b128 v[16:19], v2 offset:12288
    v_mfma_f32_16x16x32_bf16 v[104:107], v[200:203], v[28:31], v[104:107]
    v_mfma_f32_16x16x32_bf16 v[108:111], v[196:199], v[24:27], v[108:111]
    ds_read_b128 v[20:23], v3 offset:12288
    v_mfma_f32_16x16x32_bf16 v[108:111], v[204:207], v[28:31], v[108:111]
    s_waitcnt lgkmcnt(2)
    v_mfma_f32_16x16x32_bf16 v[32:35], v[208:211], v[8:11], v[32:35]
    ds_read_b128 v[24:27], v2 offset:2048
    v_mfma_f32_16x16x32_bf16 v[32:35], v[216:219], v[12:15], v[32:35]
    v_mfma_f32_16x16x32_bf16 v[36:39], v[212:215], v[8:11], v[36:39]
    ds_read_b128 v[28:31], v3 offset:2048
    v_mfma_f32_16x16x32_bf16 v[36:39], v[220:223], v[12:15], v[36:39]
    s_waitcnt lgkmcnt(2)
    v_mfma_f32_16x16x32_bf16 v[40:43], v[208:211], v[16:19], v[40:43]
    ds_read_b128 v[8:11], v2 offset:14336
    v_mfma_f32_16x16x32_bf16 v[40:43], v[216:219], v[20:23], v[40:43]
    s_add_u32 s36, s32, 16384
    buffer_load_dwordx4 v[240:243], v1, s[4:7], s36 offen offset:0 sc1
    v_mfma_f32_16x16x32_bf16 v[44:47], v[212:215], v[16:19], v[44:47]
    ds_read_b128 v[12:15], v3 offset:14336
    v_mfma_f32_16x16x32_bf16 v[44:47], v[220:223], v[20:23], v[44:47]
    s_waitcnt lgkmcnt(2)
    v_mfma_f32_16x16x32_bf16 v[48:51], v[208:211], v[24:27], v[48:51]
    ds_read_b128 v[16:19], v2 offset:4096
    v_mfma_f32_16x16x32_bf16 v[48:51], v[216:219], v[28:31], v[48:51]
    buffer_load_dwordx4 v[248:251], v1, s[4:7], s36 offen offset:1024 sc1
    v_mfma_f32_16x16x32_bf16 v[52:55], v[212:215], v[24:27], v[52:55]
    ds_read_b128 v[20:23], v3 offset:4096
    v_mfma_f32_16x16x32_bf16 v[52:55], v[220:223], v[28:31], v[52:55]
    s_waitcnt lgkmcnt(2)
    v_mfma_f32_16x16x32_bf16 v[56:59], v[208:211], v[8:11], v[56:59]
    ds_read_b128 v[24:27], v2 offset:16384
    v_mfma_f32_16x16x32_bf16 v[56:59], v[216:219], v[12:15], v[56:59]
    v_mfma_f32_16x16x32_bf16 v[60:63], v[212:215], v[8:11], v[60:63]
    ds_read_b128 v[28:31], v3 offset:16384
    v_mfma_f32_16x16x32_bf16 v[60:63], v[220:223], v[12:15], v[60:63]
    s_waitcnt lgkmcnt(2)
    v_mfma_f32_16x16x32_bf16 v[64:67], v[208:211], v[16:19], v[64:67]
    ds_read_b128 v[8:11], v2 offset:6144
    v_mfma_f32_16x16x32_bf16 v[64:67], v[216:219], v[20:23], v[64:67]
    s_add_u32 s37, s33, 16384
    buffer_load_dwordx4 v[244:247], v1, s[4:7], s37 offen offset:0 sc1
    v_mfma_f32_16x16x32_bf16 v[68:71], v[212:215], v[16:19], v[68:71]
    ds_read_b128 v[12:15], v3 offset:6144
    v_mfma_f32_16x16x32_bf16 v[68:71], v[220:223], v[20:23], v[68:71]
    s_waitcnt lgkmcnt(2)
    v_mfma_f32_16x16x32_bf16 v[72:75], v[208:211], v[24:27], v[72:75]
    ds_read_b128 v[16:19], v2 offset:18432
    v_mfma_f32_16x16x32_bf16 v[72:75], v[216:219], v[28:31], v[72:75]
    buffer_load_dwordx4 v[252:255], v1, s[4:7], s37 offen offset:1024 sc1
    v_mfma_f32_16x16x32_bf16 v[76:79], v[212:215], v[24:27], v[76:79]
    ds_read_b128 v[20:23], v3 offset:18432
    v_mfma_f32_16x16x32_bf16 v[76:79], v[220:223], v[28:31], v[76:79]
    s_waitcnt lgkmcnt(2)
    v_mfma_f32_16x16x32_bf16 v[80:83], v[208:211], v[8:11], v[80:83]
    ds_read_b128 v[24:27], v2 offset:8192
    v_mfma_f32_16x16x32_bf16 v[80:83], v[216:219], v[12:15], v[80:83]
    v_mfma_f32_16x16x32_bf16 v[84:87], v[212:215], v[8:11], v[84:87]
    ds_read_b128 v[28:31], v3 offset:8192
    v_mfma_f32_16x16x32_bf16 v[84:87], v[220:223], v[12:15], v[84:87]
    s_waitcnt lgkmcnt(2)
    v_mfma_f32_16x16x32_bf16 v[88:91], v[208:211], v[16:19], v[88:91]
    ds_read_b128 v[8:11], v2 offset:20480
    v_mfma_f32_16x16x32_bf16 v[88:91], v[216:219], v[20:23], v[88:91]
    v_mfma_f32_16x16x32_bf16 v[92:95], v[212:215], v[16:19], v[92:95]
    ds_read_b128 v[12:15], v3 offset:20480
    v_mfma_f32_16x16x32_bf16 v[92:95], v[220:223], v[20:23], v[92:95]
    v_and_b32 v156, 15, v0
    v_lshlrev_b32 v156, 6, v156
    v_add_u32 v156, 149504, v156
    v_lshrrev_b32 v157, 4, v0
    v_lshl_add_u32 v157, v157, 3, v156
    s_min_u32 s46, s16, 4
    s_lshl_b32 s41, s46, 10
    v_add_u32 v158, s41, v156
    ds_read_b128 v[112:115], v156 offset:0
    ds_read_b64 v[116:117], v156 offset:40
    ds_read_b64 v[118:119], v157 offset:32
    ds_read_b128 v[120:123], v156 offset:1024
    ds_read_b64 v[124:125], v156 offset:1064
    ds_read_b64 v[126:127], v157 offset:1056
    ds_read_b128 v[128:131], v156 offset:2048
    ds_read_b64 v[132:133], v156 offset:2088
    ds_read_b64 v[134:135], v157 offset:2080
    ds_read_b128 v[136:139], v156 offset:3072
    ds_read_b64 v[140:141], v156 offset:3112
    ds_read_b64 v[142:143], v157 offset:3104
    ds_read_b128 v[144:147], v156 offset:4096
    ds_read_b64 v[148:149], v156 offset:4136
    ds_read_b64 v[150:151], v157 offset:4128
    ds_read_b128 v[152:155], v158 offset:16
    s_mov_b32 s8, s28
    s_mov_b32 s9, s29
    s_mov_b32 s10, 663552
    s_mov_b32 s11, 0x20000
    s_mov_b32 s12, s30
    s_mov_b32 s13, s31
    s_mov_b32 s14, 663552
    s_mov_b32 s15, 0x20000
    s_mul_i32 s40, s19, 10368
    v_min_u32 v159, 40, v0
    v_lshlrev_b32 v159, 7, v159
    s_add_u32 s41, s40, 5120
    s_mov_b32 m0, 157696
    v_and_b32 v161, 7, v0
    v_lshlrev_b32 v161, 2, v161
    buffer_load_dword v160, v161, s[24:27], 0 offen offset:128 sc1
    buffer_load_dword v159, s[8:11], s40 offen lds
    buffer_load_dword v159, s[8:11], s41 offen lds
    buffer_load_dword v159, s[12:15], s40 offen lds
    buffer_load_dword v159, s[12:15], s41 offen lds
    s_waitcnt lgkmcnt(15)
    v_mfma_f32_16x16x32_bf16 v[96:99], v[208:211], v[24:27], v[96:99]
    ds_read_b128 v[16:19], v2 offset:24576
    v_mfma_f32_16x16x32_bf16 v[96:99], v[216:219], v[28:31], v[96:99]
    v_mfma_f32_16x16x32_bf16 v[100:103], v[212:215], v[24:27], v[100:103]
    ds_read_b128 v[20:23], v3 offset:24576
    v_mfma_f32_16x16x32_bf16 v[100:103], v[220:223], v[28:31], v[100:103]
    v_mfma_f32_16x16x32_bf16 v[104:107], v[208:211], v[8:11], v[104:107]
    ds_read_b128 v[24:27], v2 offset:36864
    v_mfma_f32_16x16x32_bf16 v[104:107], v[216:219], v[12:15], v[104:107]
    v_mfma_f32_16x16x32_bf16 v[108:111], v[212:215], v[8:11], v[108:111]
    ds_read_b128 v[28:31], v3 offset:36864
    v_mfma_f32_16x16x32_bf16 v[108:111], v[220:223], v[12:15], v[108:111]
    s_waitcnt vmcnt(9)
    s_waitcnt lgkmcnt(2)
    v_mfma_f32_16x16x32_bf16 v[32:35], v[224:227], v[16:19], v[32:35]
    ds_read_b128 v[8:11], v2 offset:26624
    v_mfma_f32_16x16x32_bf16 v[32:35], v[232:235], v[20:23], v[32:35]
    v_mfma_f32_16x16x32_bf16 v[36:39], v[228:231], v[16:19], v[36:39]
    ds_read_b128 v[12:15], v3 offset:26624
    v_mfma_f32_16x16x32_bf16 v[36:39], v[236:239], v[20:23], v[36:39]
    s_waitcnt lgkmcnt(2)
    v_mfma_f32_16x16x32_bf16 v[40:43], v[224:227], v[24:27], v[40:43]
    ds_read_b128 v[16:19], v2 offset:38912
    v_mfma_f32_16x16x32_bf16 v[40:43], v[232:235], v[28:31], v[40:43]
    v_mfma_f32_16x16x32_bf16 v[44:47], v[228:231], v[24:27], v[44:47]
    ds_read_b128 v[20:23], v3 offset:38912
    v_mfma_f32_16x16x32_bf16 v[44:47], v[236:239], v[28:31], v[44:47]
    s_waitcnt lgkmcnt(2)
    v_mfma_f32_16x16x32_bf16 v[48:51], v[224:227], v[8:11], v[48:51]
    ds_read_b128 v[24:27], v2 offset:28672
    v_mfma_f32_16x16x32_bf16 v[48:51], v[232:235], v[12:15], v[48:51]
    v_mfma_f32_16x16x32_bf16 v[52:55], v[228:231], v[8:11], v[52:55]
    ds_read_b128 v[28:31], v3 offset:28672
    v_mfma_f32_16x16x32_bf16 v[52:55], v[236:239], v[12:15], v[52:55]
    s_waitcnt lgkmcnt(2)
    v_mfma_f32_16x16x32_bf16 v[56:59], v[224:227], v[16:19], v[56:59]
    ds_read_b128 v[8:11], v2 offset:40960
    v_mfma_f32_16x16x32_bf16 v[56:59], v[232:235], v[20:23], v[56:59]
    v_mfma_f32_16x16x32_bf16 v[60:63], v[228:231], v[16:19], v[60:63]
    ds_read_b128 v[12:15], v3 offset:40960
    v_mfma_f32_16x16x32_bf16 v[60:63], v[236:239], v[20:23], v[60:63]
    s_waitcnt lgkmcnt(2)
    v_mfma_f32_16x16x32_bf16 v[64:67], v[224:227], v[24:27], v[64:67]
    ds_read_b128 v[16:19], v2 offset:30720
    v_mfma_f32_16x16x32_bf16 v[64:67], v[232:235], v[28:31], v[64:67]
    v_mfma_f32_16x16x32_bf16 v[68:71], v[228:231], v[24:27], v[68:71]
    ds_read_b128 v[20:23], v3 offset:30720
    v_mfma_f32_16x16x32_bf16 v[68:71], v[236:239], v[28:31], v[68:71]
    s_waitcnt lgkmcnt(2)
    v_mfma_f32_16x16x32_bf16 v[72:75], v[224:227], v[8:11], v[72:75]
    ds_read_b128 v[24:27], v2 offset:43008
    v_mfma_f32_16x16x32_bf16 v[72:75], v[232:235], v[12:15], v[72:75]
    v_mfma_f32_16x16x32_bf16 v[76:79], v[228:231], v[8:11], v[76:79]
    ds_read_b128 v[28:31], v3 offset:43008
    v_mfma_f32_16x16x32_bf16 v[76:79], v[236:239], v[12:15], v[76:79]
    s_waitcnt lgkmcnt(2)
    v_mfma_f32_16x16x32_bf16 v[80:83], v[224:227], v[16:19], v[80:83]
    ds_read_b128 v[8:11], v2 offset:32768
    v_mfma_f32_16x16x32_bf16 v[80:83], v[232:235], v[20:23], v[80:83]
    v_mfma_f32_16x16x32_bf16 v[84:87], v[228:231], v[16:19], v[84:87]
    ds_read_b128 v[12:15], v3 offset:32768
    v_mfma_f32_16x16x32_bf16 v[84:87], v[236:239], v[20:23], v[84:87]
    s_waitcnt lgkmcnt(2)
    v_mfma_f32_16x16x32_bf16 v[88:91], v[224:227], v[24:27], v[88:91]
    ds_read_b128 v[16:19], v2 offset:45056
    v_mfma_f32_16x16x32_bf16 v[88:91], v[232:235], v[28:31], v[88:91]
    v_mfma_f32_16x16x32_bf16 v[92:95], v[228:231], v[24:27], v[92:95]
    ds_read_b128 v[20:23], v3 offset:45056
    v_mfma_f32_16x16x32_bf16 v[92:95], v[236:239], v[28:31], v[92:95]
    s_waitcnt lgkmcnt(2)
    v_mfma_f32_16x16x32_bf16 v[96:99], v[224:227], v[8:11], v[96:99]
    ds_read_b128 v[24:27], v4 offset:0
    v_mfma_f32_16x16x32_bf16 v[96:99], v[232:235], v[12:15], v[96:99]
    v_mfma_f32_16x16x32_bf16 v[100:103], v[228:231], v[8:11], v[100:103]
    ds_read_b128 v[28:31], v5 offset:0
    v_mfma_f32_16x16x32_bf16 v[100:103], v[236:239], v[12:15], v[100:103]
    s_waitcnt lgkmcnt(2)
    v_mfma_f32_16x16x32_bf16 v[104:107], v[224:227], v[16:19], v[104:107]
    ds_read_b128 v[8:11], v4 offset:12288
    v_mfma_f32_16x16x32_bf16 v[104:107], v[232:235], v[20:23], v[104:107]
    v_mfma_f32_16x16x32_bf16 v[108:111], v[228:231], v[16:19], v[108:111]
    ds_read_b128 v[12:15], v5 offset:12288
    v_mfma_f32_16x16x32_bf16 v[108:111], v[236:239], v[20:23], v[108:111]
    s_waitcnt vmcnt(5)
    s_waitcnt lgkmcnt(2)
    v_mfma_f32_16x16x32_bf16 v[32:35], v[240:243], v[24:27], v[32:35]
    ds_read_b128 v[16:19], v4 offset:2048
    v_mfma_f32_16x16x32_bf16 v[32:35], v[248:251], v[28:31], v[32:35]
    v_mfma_f32_16x16x32_bf16 v[36:39], v[244:247], v[24:27], v[36:39]
    ds_read_b128 v[20:23], v5 offset:2048
    v_mfma_f32_16x16x32_bf16 v[36:39], v[252:255], v[28:31], v[36:39]
    s_waitcnt lgkmcnt(2)
    v_mfma_f32_16x16x32_bf16 v[40:43], v[240:243], v[8:11], v[40:43]
    ds_read_b128 v[24:27], v4 offset:14336
    v_mfma_f32_16x16x32_bf16 v[40:43], v[248:251], v[12:15], v[40:43]
    v_mfma_f32_16x16x32_bf16 v[44:47], v[244:247], v[8:11], v[44:47]
    ds_read_b128 v[28:31], v5 offset:14336
    v_mfma_f32_16x16x32_bf16 v[44:47], v[252:255], v[12:15], v[44:47]
    s_waitcnt lgkmcnt(2)
    v_mfma_f32_16x16x32_bf16 v[48:51], v[240:243], v[16:19], v[48:51]
    ds_read_b128 v[8:11], v4 offset:4096
    v_mfma_f32_16x16x32_bf16 v[48:51], v[248:251], v[20:23], v[48:51]
    v_mfma_f32_16x16x32_bf16 v[52:55], v[244:247], v[16:19], v[52:55]
    ds_read_b128 v[12:15], v5 offset:4096
    v_mfma_f32_16x16x32_bf16 v[52:55], v[252:255], v[20:23], v[52:55]
    s_waitcnt lgkmcnt(2)
    v_mfma_f32_16x16x32_bf16 v[56:59], v[240:243], v[24:27], v[56:59]
    ds_read_b128 v[16:19], v4 offset:16384
    v_mfma_f32_16x16x32_bf16 v[56:59], v[248:251], v[28:31], v[56:59]
    v_mfma_f32_16x16x32_bf16 v[60:63], v[244:247], v[24:27], v[60:63]
    ds_read_b128 v[20:23], v5 offset:16384
    v_mfma_f32_16x16x32_bf16 v[60:63], v[252:255], v[28:31], v[60:63]
    s_waitcnt lgkmcnt(2)
    v_mfma_f32_16x16x32_bf16 v[64:67], v[240:243], v[8:11], v[64:67]
    ds_read_b128 v[24:27], v4 offset:6144
    v_mfma_f32_16x16x32_bf16 v[64:67], v[248:251], v[12:15], v[64:67]
    v_mfma_f32_16x16x32_bf16 v[68:71], v[244:247], v[8:11], v[68:71]
    ds_read_b128 v[28:31], v5 offset:6144
    v_mfma_f32_16x16x32_bf16 v[68:71], v[252:255], v[12:15], v[68:71]
    s_waitcnt lgkmcnt(2)
    v_mfma_f32_16x16x32_bf16 v[72:75], v[240:243], v[16:19], v[72:75]
    ds_read_b128 v[8:11], v4 offset:18432
    v_mfma_f32_16x16x32_bf16 v[72:75], v[248:251], v[20:23], v[72:75]
    v_mfma_f32_16x16x32_bf16 v[76:79], v[244:247], v[16:19], v[76:79]
    ds_read_b128 v[12:15], v5 offset:18432
    v_mfma_f32_16x16x32_bf16 v[76:79], v[252:255], v[20:23], v[76:79]
    s_waitcnt lgkmcnt(2)
    v_mfma_f32_16x16x32_bf16 v[80:83], v[240:243], v[24:27], v[80:83]
    ds_read_b128 v[16:19], v4 offset:8192
    v_mfma_f32_16x16x32_bf16 v[80:83], v[248:251], v[28:31], v[80:83]
    v_mfma_f32_16x16x32_bf16 v[84:87], v[244:247], v[24:27], v[84:87]
    ds_read_b128 v[20:23], v5 offset:8192
    v_mfma_f32_16x16x32_bf16 v[84:87], v[252:255], v[28:31], v[84:87]
    s_waitcnt lgkmcnt(2)
    v_mfma_f32_16x16x32_bf16 v[88:91], v[240:243], v[8:11], v[88:91]
    ds_read_b128 v[24:27], v4 offset:20480
    v_mfma_f32_16x16x32_bf16 v[88:91], v[248:251], v[12:15], v[88:91]
    v_mfma_f32_16x16x32_bf16 v[92:95], v[244:247], v[8:11], v[92:95]
    ds_read_b128 v[28:31], v5 offset:20480
    v_mfma_f32_16x16x32_bf16 v[92:95], v[252:255], v[12:15], v[92:95]
    s_waitcnt lgkmcnt(2)
    v_mfma_f32_16x16x32_bf16 v[96:99], v[240:243], v[16:19], v[96:99]
    v_mfma_f32_16x16x32_bf16 v[96:99], v[248:251], v[20:23], v[96:99]
    v_mfma_f32_16x16x32_bf16 v[100:103], v[244:247], v[16:19], v[100:103]
    v_mfma_f32_16x16x32_bf16 v[100:103], v[252:255], v[20:23], v[100:103]
    s_waitcnt lgkmcnt(0)
    v_mfma_f32_16x16x32_bf16 v[104:107], v[240:243], v[24:27], v[104:107]
    v_mfma_f32_16x16x32_bf16 v[104:107], v[248:251], v[28:31], v[104:107]
    v_mfma_f32_16x16x32_bf16 v[108:111], v[244:247], v[24:27], v[108:111]
    v_mfma_f32_16x16x32_bf16 v[108:111], v[252:255], v[28:31], v[108:111]
    s_waitcnt lgkmcnt(0)
    s_waitcnt vmcnt(4)
    v_cmp_ne_u32 vcc, 1, v160
    s_cbranch_vccnz ASs_134
ASb_135:
    s_nop 7
    v_sub_f32 v248, 0, v113
    v_sub_f32 v249, 0, v121
    v_sub_f32 v250, 0, v129
    v_sub_f32 v251, 0, v137
    v_sub_f32 v252, 0, v145
    v_fma_f32 v170, v112, v32, v33
    v_fma_f32 v171, v112, v40, v41
    v_fmac_f32 v170, v248, v40
    v_fmac_f32 v171, v113, v32
    v_fma_f32 v172, v120, v48, v49
    v_fma_f32 v173, v120, v56, v57
    v_fmac_f32 v172, v249, v56
    v_fmac_f32 v173, v121, v48
    v_fma_f32 v174, v128, v64, v65
    v_fma_f32 v175, v128, v72, v73
    v_fmac_f32 v174, v250, v72
    v_fmac_f32 v175, v129, v64
    v_fma_f32 v176, v136, v80, v81
    v_fma_f32 v177, v136, v88, v89
    v_fmac_f32 v176, v251, v88
    v_fmac_f32 v177, v137, v80
    v_fma_f32 v178, v144, v96, v97
    v_fma_f32 v179, v144, v104, v105
    v_fmac_f32 v178, v252, v104
    v_fmac_f32 v179, v145, v96
    v_fma_f32 v188, v112, v170, v34
    v_fma_f32 v189, v112, v171, v42
    v_fmac_f32 v188, v248, v171
    v_fmac_f32 v189, v113, v170
    v_fma_f32 v190, v120, v172, v50
    v_fma_f32 v191, v120, v173, v58
    v_fmac_f32 v190, v249, v173
    v_fmac_f32 v191, v121, v172
    v_fma_f32 v192, v128, v174, v66
    v_fma_f32 v193, v128, v175, v74
    v_fmac_f32 v192, v250, v175
    v_fmac_f32 v193, v129, v174
    v_fma_f32 v194, v136, v176, v82
    v_fma_f32 v195, v136, v177, v90
    v_fmac_f32 v194, v251, v177
    v_fmac_f32 v195, v137, v176
    v_fma_f32 v196, v144, v178, v98
    v_fma_f32 v197, v144, v179, v106
    v_fmac_f32 v196, v252, v179
    v_fmac_f32 v197, v145, v178
    v_fma_f32 v170, v112, v188, v35
    v_fma_f32 v171, v112, v189, v43
    v_fmac_f32 v170, v248, v189
    v_fmac_f32 v171, v113, v188
    v_fma_f32 v172, v120, v190, v51
    v_fma_f32 v173, v120, v191, v59
    v_fmac_f32 v172, v249, v191
    v_fmac_f32 v173, v121, v190
    v_fma_f32 v174, v128, v192, v67
    v_fma_f32 v175, v128, v193, v75
    v_fmac_f32 v174, v250, v193
    v_fmac_f32 v175, v129, v192
    v_fma_f32 v176, v136, v194, v83
    v_fma_f32 v177, v136, v195, v91
    v_fmac_f32 v176, v251, v195
    v_fmac_f32 v177, v137, v194
    v_fma_f32 v178, v144, v196, v99
    v_fma_f32 v179, v144, v197, v107
    v_fmac_f32 v178, v252, v197
    v_fmac_f32 v179, v145, v196
    v_fma_f32 v188, v112, v170, v36
    v_fma_f32 v189, v112, v171, v44
    v_fmac_f32 v188, v248, v171
    v_fmac_f32 v189, v113, v170
    v_fma_f32 v190, v120, v172, v52
    v_fma_f32 v191, v120, v173, v60
    v_fmac_f32 v190, v249, v173
    v_fmac_f32 v191, v121, v172
    v_fma_f32 v192, v128, v174, v68
    v_fma_f32 v193, v128, v175, v76
    v_fmac_f32 v192, v250, v175
    v_fmac_f32 v193, v129, v174
    v_fma_f32 v194, v136, v176, v84
    v_fma_f32 v195, v136, v177, v92
    v_fmac_f32 v194, v251, v177
    v_fmac_f32 v195, v137, v176
    v_fma_f32 v196, v144, v178, v100
    v_fma_f32 v197, v144, v179, v108
    v_fmac_f32 v196, v252, v179
    v_fmac_f32 v197, v145, v178
    v_fma_f32 v170, v112, v188, v37
    v_fma_f32 v171, v112, v189, v45
    v_fmac_f32 v170, v248, v189
    v_fmac_f32 v171, v113, v188
    v_fma_f32 v172, v120, v190, v53
    v_fma_f32 v173, v120, v191, v61
    v_fmac_f32 v172, v249, v191
    v_fmac_f32 v173, v121, v190
    v_fma_f32 v174, v128, v192, v69
    v_fma_f32 v175, v128, v193, v77
    v_fmac_f32 v174, v250, v193
    v_fmac_f32 v175, v129, v192
    v_fma_f32 v176, v136, v194, v85
    v_fma_f32 v177, v136, v195, v93
    v_fmac_f32 v176, v251, v195
    v_fmac_f32 v177, v137, v194
    v_fma_f32 v178, v144, v196, v101
    v_fma_f32 v179, v144, v197, v109
    v_fmac_f32 v178, v252, v197
    v_fmac_f32 v179, v145, v196
    v_fma_f32 v188, v112, v170, v38
    v_fma_f32 v189, v112, v171, v46
    v_fmac_f32 v188, v248, v171
    v_fmac_f32 v189, v113, v170
    v_fma_f32 v190, v120, v172, v54
    v_fma_f32 v191, v120, v173, v62
    v_fmac_f32 v190, v249, v173
    v_fmac_f32 v191, v121, v172
    v_fma_f32 v192, v128, v174, v70
    v_fma_f32 v193, v128, v175, v78
    v_fmac_f32 v192, v250, v175
    v_fmac_f32 v193, v129, v174
    v_fma_f32 v194, v136, v176, v86
    v_fma_f32 v195, v136, v177, v94
    v_fmac_f32 v194, v251, v177
    v_fmac_f32 v195, v137, v176
    v_fma_f32 v196, v144, v178, v102
    v_fma_f32 v197, v144, v179, v110
    v_fmac_f32 v196, v252, v179
    v_fmac_f32 v197, v145, v178
    v_fma_f32 v170, v112, v188, v39
    v_fma_f32 v171, v112, v189, v47
    v_fmac_f32 v170, v248, v189
    v_fmac_f32 v171, v113, v188
    v_fma_f32 v172, v120, v190, v55
    v_fma_f32 v173, v120, v191, v63
    v_fmac_f32 v172, v249, v191
    v_fmac_f32 v173, v121, v190
    v_fma_f32 v174, v128, v192, v71
    v_fma_f32 v175, v128, v193, v79
    v_fmac_f32 v174, v250, v193
    v_fmac_f32 v175, v129, v192
    v_fma_f32 v176, v136, v194, v87
    v_fma_f32 v177, v136, v195, v95
    v_fmac_f32 v176, v251, v195
    v_fmac_f32 v177, v137, v194
    v_fma_f32 v178, v144, v196, v103
    v_fma_f32 v179, v144, v197, v111
    v_fmac_f32 v178, v252, v197
    v_fmac_f32 v179, v145, v196
    v_mul_f32 v188, v115, v171
    v_mul_f32 v189, v115, v170
    v_fma_f32 v170, v114, v170, -v188
    v_fma_f32 v171, v114, v171, v189
    v_mul_f32 v190, v123, v173
    v_mul_f32 v191, v123, v172
    v_fma_f32 v172, v122, v172, -v190
    v_fma_f32 v173, v122, v173, v191
    v_mul_f32 v192, v131, v175
    v_mul_f32 v193, v131, v174
    v_fma_f32 v174, v130, v174, -v192
    v_fma_f32 v175, v130, v175, v193
    v_mul_f32 v194, v139, v177
    v_mul_f32 v195, v139, v176
    v_fma_f32 v176, v138, v176, -v194
    v_fma_f32 v177, v138, v177, v195
    v_mul_f32 v196, v147, v179
    v_mul_f32 v197, v147, v178
    v_fma_f32 v178, v146, v178, -v196
    v_fma_f32 v179, v146, v179, v197
    v_and_b32 v200, 15, v0
    v_lshrrev_b32 v201, 4, v0
    s_mul_i32 s40, s16, 768
    s_add_u32 s40, s40, 75776
    v_mul_u32_u24 v198, 48, v200
    v_add_u32 v198, s40, v198
    v_lshl_add_u32 v199, v201, 3, v198
    v_cmp_eq_u32 s[50:51], 1, v201
    v_cmp_eq_u32 s[52:53], 2, v201
    v_cmp_eq_u32 s[54:55], 3, v201
    ds_write_b64 v199, v[170:171] offset:0
    ds_write_b64 v199, v[172:173] offset:6144
    ds_write_b64 v199, v[174:175] offset:12288
    ds_write_b64 v199, v[176:177] offset:18432
    ds_write_b64 v199, v[178:179] offset:24576
    ds_read_b128 v[204:207], v198 offset:0
    ds_read_b128 v[208:211], v198 offset:16
    ds_read_b128 v[212:215], v198 offset:6144
    ds_read_b128 v[216:219], v198 offset:6160
    ds_read_b128 v[220:223], v198 offset:12288
    ds_read_b128 v[224:227], v198 offset:12304
    ds_read_b128 v[228:231], v198 offset:18432
    ds_read_b128 v[232:235], v198 offset:18448
    ds_read_b128 v[236:239], v198 offset:24576
    ds_read_b128 v[240:243], v198 offset:24592
    s_lshl_b32 s40, s16, 3
    s_add_u32 s40, s40, 106496
    v_mul_u32_u24 v199, 80, v200
    v_add_u32 v199, s40, v199
    s_waitcnt lgkmcnt(0)
    v_fmac_f32 v206, v116, v204
    v_fmac_f32 v207, v116, v205
    v_fma_f32 v206, -v117, v205, v206
    v_fmac_f32 v207, v117, v204
    v_fmac_f32 v214, v124, v212
    v_fmac_f32 v215, v124, v213
    v_fma_f32 v214, -v125, v213, v214
    v_fmac_f32 v215, v125, v212
    v_fmac_f32 v222, v132, v220
    v_fmac_f32 v223, v132, v221
    v_fma_f32 v222, -v133, v221, v222
    v_fmac_f32 v223, v133, v220
    v_fmac_f32 v230, v140, v228
    v_fmac_f32 v231, v140, v229
    v_fma_f32 v230, -v141, v229, v230
    v_fmac_f32 v231, v141, v228
    v_fmac_f32 v238, v148, v236
    v_fmac_f32 v239, v148, v237
    v_fma_f32 v238, -v149, v237, v238
    v_fmac_f32 v239, v149, v236
    v_fmac_f32 v208, v116, v206
    v_fmac_f32 v209, v116, v207
    v_fma_f32 v208, -v117, v207, v208
    v_fmac_f32 v209, v117, v206
    v_fmac_f32 v216, v124, v214
    v_fmac_f32 v217, v124, v215
    v_fma_f32 v216, -v125, v215, v216
    v_fmac_f32 v217, v125, v214
    v_fmac_f32 v224, v132, v222
    v_fmac_f32 v225, v132, v223
    v_fma_f32 v224, -v133, v223, v224
    v_fmac_f32 v225, v133, v222
    v_fmac_f32 v232, v140, v230
    v_fmac_f32 v233, v140, v231
    v_fma_f32 v232, -v141, v231, v232
    v_fmac_f32 v233, v141, v230
    v_fmac_f32 v240, v148, v238
    v_fmac_f32 v241, v148, v239
    v_fma_f32 v240, -v149, v239, v240
    v_fmac_f32 v241, v149, v238
    v_fmac_f32 v210, v116, v208
    v_fmac_f32 v211, v116, v209
    v_fma_f32 v210, -v117, v209, v210
    v_fmac_f32 v211, v117, v208
    v_fmac_f32 v218, v124, v216
    v_fmac_f32 v219, v124, v217
    v_fma_f32 v218, -v125, v217, v218
    v_fmac_f32 v219, v125, v216
    v_fmac_f32 v226, v132, v224
    v_fmac_f32 v227, v132, v225
    v_fma_f32 v226, -v133, v225, v226
    v_fmac_f32 v227, v133, v224
    v_fmac_f32 v234, v140, v232
    v_fmac_f32 v235, v140, v233
    v_fma_f32 v234, -v141, v233, v234
    v_fmac_f32 v235, v141, v232
    v_fmac_f32 v242, v148, v240
    v_fmac_f32 v243, v148, v241
    v_fma_f32 v242, -v149, v241, v242
    v_fmac_f32 v243, v149, v240
    s_mov_b64 exec, 0xffff
    ds_write_b64 v199, v[210:211] offset:0
    ds_write_b64 v199, v[218:219] offset:1280
    ds_write_b64 v199, v[226:227] offset:2560
    ds_write_b64 v199, v[234:235] offset:3840
    ds_write_b64 v199, v[242:243] offset:5120
    s_mov_b64 exec, -1
    s_waitcnt lgkmcnt(0)
    s_barrier
    s_cmp_ge_u32 s16, 5
    s_cbranch_scc1 K1_pub
    s_setprio 3
    s_mul_i32 s40, s16, 1280
    s_add_u32 s40, s40, 106496
    v_mul_u32_u24 v199, 80, v200
    v_add_u32 v199, s40, v199
    ds_read_b128 v[8:11], v199 offset:0
    ds_read_b128 v[12:15], v199 offset:16
    ds_read_b128 v[16:19], v199 offset:32
    ds_read_b128 v[20:23], v199 offset:48
    s_add_u32 s40, s57, s16
    s_lshl_b32 s40, s40, 11
    s_add_u32 s40, s40, 30707712
    v_lshlrev_b32 v198, 4, v200
    v_mov_b32 v25, 1
    v_mov_b32 v27, 1
    s_lshl_b32 s41, s17, 8
    s_add_u32 s41, s41, s40
    s_waitcnt lgkmcnt(0)
    v_fma_f32 v182, v152, v8, v10
    v_fma_f32 v183, v152, v9, v11
    v_fma_f32 v182, -v153, v9, v182
    v_fmac_f32 v183, v153, v8
    v_fma_f32 v180, v152, v182, v12
    v_fma_f32 v181, v152, v183, v13
    v_fma_f32 v180, -v153, v183, v180
    v_fmac_f32 v181, v153, v182
    v_fma_f32 v182, v152, v180, v14
    v_fma_f32 v183, v152, v181, v15
    v_fma_f32 v182, -v153, v181, v182
    v_fmac_f32 v183, v153, v180
    v_fma_f32 v180, v152, v182, v16
    v_fma_f32 v181, v152, v183, v17
    v_fma_f32 v180, -v153, v183, v180
    v_fmac_f32 v181, v153, v182
    v_fma_f32 v182, v152, v180, v18
    v_fma_f32 v183, v152, v181, v19
    v_fma_f32 v182, -v153, v181, v182
    v_fmac_f32 v183, v153, v180
    v_fma_f32 v180, v152, v182, v20
    v_fma_f32 v181, v152, v183, v21
    v_fma_f32 v180, -v153, v183, v180
    v_fmac_f32 v181, v153, v182
    v_fma_f32 v24, v152, v180, v22
    v_fma_f32 v26, v152, v181, v23
    v_fma_f32 v24, -v153, v181, v24
    v_fmac_f32 v26, v153, v180
    s_mov_b64 exec, 0xffff
    buffer_store_dwordx4 v[24:27], v198, s[4:7], s41 offen sc1
    s_mov_b64 exec, -1
    s_setprio 0
K1_pub:
    v_cndmask_b32 v160, 0, v204, s[50:51]
    v_cndmask_b32 v160, v160, v206, s[52:53]
    v_cndmask_b32 v160, v160, v208, s[54:55]
    v_cndmask_b32 v161, 0, v205, s[50:51]
    v_cndmask_b32 v161, v161, v207, s[52:53]
    v_cndmask_b32 v161, v161, v209, s[54:55]
    v_cndmask_b32 v162, 0, v212, s[50:51]
    v_cndmask_b32 v162, v162, v214, s[52:53]
    v_cndmask_b32 v162, v162, v216, s[54:55]
    v_cndmask_b32 v163, 0, v213, s[50:51]
    v_cndmask_b32 v163, v163, v215, s[52:53]
    v_cndmask_b32 v163, v163, v217, s[54:55]
    v_cndmask_b32 v164, 0, v220, s[50:51]
    v_cndmask_b32 v164, v164, v222, s[52:53]
    v_cndmask_b32 v164, v164, v224, s[54:55]
    v_cndmask_b32 v165, 0, v221, s[50:51]
    v_cndmask_b32 v165, v165, v223, s[52:53]
    v_cndmask_b32 v165, v165, v225, s[54:55]
    v_cndmask_b32 v166, 0, v228, s[50:51]
    v_cndmask_b32 v166, v166, v230, s[52:53]
    v_cndmask_b32 v166, v166, v232, s[54:55]
    v_cndmask_b32 v167, 0, v229, s[50:51]
    v_cndmask_b32 v167, v167, v231, s[52:53]
    v_cndmask_b32 v167, v167, v233, s[54:55]
    v_cndmask_b32 v168, 0, v236, s[50:51]
    v_cndmask_b32 v168, v168, v238, s[52:53]
    v_cndmask_b32 v168, v168, v240, s[54:55]
    v_cndmask_b32 v169, 0, v237, s[50:51]
    v_cndmask_b32 v169, v169, v239, s[52:53]
    v_cndmask_b32 v169, v169, v241, s[54:55]
    v_mul_f32 v188, v115, v40
    v_mul_f32 v189, v115, v32
    v_fma_f32 v32, v114, v32, -v188
    v_fma_f32 v40, v114, v40, v189
    v_mul_f32 v190, v115, v41
    v_mul_f32 v191, v115, v33
    v_fma_f32 v33, v114, v33, -v190
    v_fma_f32 v41, v114, v41, v191
    v_mul_f32 v192, v115, v42
    v_mul_f32 v193, v115, v34
    v_fma_f32 v34, v114, v34, -v192
    v_fma_f32 v42, v114, v42, v193
    v_mul_f32 v194, v115, v43
    v_mul_f32 v195, v115, v35
    v_fma_f32 v35, v114, v35, -v194
    v_fma_f32 v43, v114, v43, v195
    v_mul_f32 v188, v115, v44
    v_mul_f32 v189, v115, v36
    v_fma_f32 v36, v114, v36, -v188
    v_fma_f32 v44, v114, v44, v189
    v_mul_f32 v190, v115, v45
    v_mul_f32 v191, v115, v37
    v_fma_f32 v37, v114, v37, -v190
    v_fma_f32 v45, v114, v45, v191
    v_mul_f32 v192, v115, v46
    v_mul_f32 v193, v115, v38
    v_fma_f32 v38, v114, v38, -v192
    v_fma_f32 v46, v114, v46, v193
    v_mul_f32 v194, v115, v47
    v_mul_f32 v195, v115, v39
    v_fma_f32 v39, v114, v39, -v194
    v_fma_f32 v47, v114, v47, v195
    v_mul_f32 v188, v123, v56
    v_mul_f32 v189, v123, v48
    v_fma_f32 v48, v122, v48, -v188
    v_fma_f32 v56, v122, v56, v189
    v_mul_f32 v190, v123, v57
    v_mul_f32 v191, v123, v49
    v_fma_f32 v49, v122, v49, -v190
    v_fma_f32 v57, v122, v57, v191
    v_mul_f32 v192, v123, v58
    v_mul_f32 v193, v123, v50
    v_fma_f32 v50, v122, v50, -v192
    v_fma_f32 v58, v122, v58, v193
    v_mul_f32 v194, v123, v59
    v_mul_f32 v195, v123, v51
    v_fma_f32 v51, v122, v51, -v194
    v_fma_f32 v59, v122, v59, v195
    v_mul_f32 v188, v123, v60
    v_mul_f32 v189, v123, v52
    v_fma_f32 v52, v122, v52, -v188
    v_fma_f32 v60, v122, v60, v189
    v_mul_f32 v190, v123, v61
    v_mul_f32 v191, v123, v53
    v_fma_f32 v53, v122, v53, -v190
    v_fma_f32 v61, v122, v61, v191
    v_mul_f32 v192, v123, v62
    v_mul_f32 v193, v123, v54
    v_fma_f32 v54, v122, v54, -v192
    v_fma_f32 v62, v122, v62, v193
    v_mul_f32 v194, v123, v63
    v_mul_f32 v195, v123, v55
    v_fma_f32 v55, v122, v55, -v194
    v_fma_f32 v63, v122, v63, v195
    v_mul_f32 v188, v131, v72
    v_mul_f32 v189, v131, v64
    v_fma_f32 v64, v130, v64, -v188
    v_fma_f32 v72, v130, v72, v189
    v_mul_f32 v190, v131, v73
    v_mul_f32 v191, v131, v65
    v_fma_f32 v65, v130, v65, -v190
    v_fma_f32 v73, v130, v73, v191
    v_mul_f32 v192, v131, v74
    v_mul_f32 v193, v131, v66
    v_fma_f32 v66, v130, v66, -v192
    v_fma_f32 v74, v130, v74, v193
    v_mul_f32 v194, v131, v75
    v_mul_f32 v195, v131, v67
    v_fma_f32 v67, v130, v67, -v194
    v_fma_f32 v75, v130, v75, v195
    v_mul_f32 v188, v131, v76
    v_mul_f32 v189, v131, v68
    v_fma_f32 v68, v130, v68, -v188
    v_fma_f32 v76, v130, v76, v189
    v_mul_f32 v190, v131, v77
    v_mul_f32 v191, v131, v69
    v_fma_f32 v69, v130, v69, -v190
    v_fma_f32 v77, v130, v77, v191
    v_mul_f32 v192, v131, v78
    v_mul_f32 v193, v131, v70
    v_fma_f32 v70, v130, v70, -v192
    v_fma_f32 v78, v130, v78, v193
    v_mul_f32 v194, v131, v79
    v_mul_f32 v195, v131, v71
    v_fma_f32 v71, v130, v71, -v194
    v_fma_f32 v79, v130, v79, v195
    v_mul_f32 v188, v139, v88
    v_mul_f32 v189, v139, v80
    v_fma_f32 v80, v138, v80, -v188
    v_fma_f32 v88, v138, v88, v189
    v_mul_f32 v190, v139, v89
    v_mul_f32 v191, v139, v81
    v_fma_f32 v81, v138, v81, -v190
    v_fma_f32 v89, v138, v89, v191
    v_mul_f32 v192, v139, v90
    v_mul_f32 v193, v139, v82
    v_fma_f32 v82, v138, v82, -v192
    v_fma_f32 v90, v138, v90, v193
    v_mul_f32 v194, v139, v91
    v_mul_f32 v195, v139, v83
    v_fma_f32 v83, v138, v83, -v194
    v_fma_f32 v91, v138, v91, v195
    v_mul_f32 v188, v139, v92
    v_mul_f32 v189, v139, v84
    v_fma_f32 v84, v138, v84, -v188
    v_fma_f32 v92, v138, v92, v189
    v_mul_f32 v190, v139, v93
    v_mul_f32 v191, v139, v85
    v_fma_f32 v85, v138, v85, -v190
    v_fma_f32 v93, v138, v93, v191
    v_mul_f32 v192, v139, v94
    v_mul_f32 v193, v139, v86
    v_fma_f32 v86, v138, v86, -v192
    v_fma_f32 v94, v138, v94, v193
    v_mul_f32 v194, v139, v95
    v_mul_f32 v195, v139, v87
    v_fma_f32 v87, v138, v87, -v194
    v_fma_f32 v95, v138, v95, v195
    v_mul_f32 v188, v147, v104
    v_mul_f32 v189, v147, v96
    v_fma_f32 v96, v146, v96, -v188
    v_fma_f32 v104, v146, v104, v189
    v_mul_f32 v190, v147, v105
    v_mul_f32 v191, v147, v97
    v_fma_f32 v97, v146, v97, -v190
    v_fma_f32 v105, v146, v105, v191
    v_mul_f32 v192, v147, v106
    v_mul_f32 v193, v147, v98
    v_fma_f32 v98, v146, v98, -v192
    v_fma_f32 v106, v146, v106, v193
    v_mul_f32 v194, v147, v107
    v_mul_f32 v195, v147, v99
    v_fma_f32 v99, v146, v99, -v194
    v_fma_f32 v107, v146, v107, v195
    v_mul_f32 v188, v147, v108
    v_mul_f32 v189, v147, v100
    v_fma_f32 v100, v146, v100, -v188
    v_fma_f32 v108, v146, v108, v189
    v_mul_f32 v190, v147, v109
    v_mul_f32 v191, v147, v101
    v_fma_f32 v101, v146, v101, -v190
    v_fma_f32 v109, v146, v109, v191
    v_mul_f32 v192, v147, v110
    v_mul_f32 v193, v147, v102
    v_fma_f32 v102, v146, v102, -v192
    v_fma_f32 v110, v146, v110, v193
    v_mul_f32 v194, v147, v111
    v_mul_f32 v195, v147, v103
    v_fma_f32 v103, v146, v103, -v194
    v_fma_f32 v111, v146, v111, v195
    s_cmp_ge_u32 s16, 5
    s_cbranch_scc1 K1_join
    s_setprio 3
    v_mov_b32 v180, 0
    v_mov_b32 v181, 0
    s_mov_b32 s47, 0
    s_cmp_eq_u32 s17, 0
    s_cbranch_scc1 K1_lbdone
K1_lbloop:
    buffer_load_dwordx4 v[204:207], v198, s[4:7], s40 offen offset:0 sc1
    buffer_load_dwordx4 v[208:211], v198, s[4:7], s40 offen offset:256 sc1
    buffer_load_dwordx4 v[212:215], v198, s[4:7], s40 offen offset:512 sc1
    buffer_load_dwordx4 v[216:219], v198, s[4:7], s40 offen offset:768 sc1
    buffer_load_dwordx4 v[220:223], v198, s[4:7], s40 offen offset:1024 sc1
    buffer_load_dwordx4 v[224:227], v198, s[4:7], s40 offen offset:1280 sc1
    buffer_load_dwordx4 v[228:231], v198, s[4:7], s40 offen offset:1536 sc1
    v_mov_b32 v180, 0
    v_mov_b32 v181, 0
    v_mov_b32 v184, 1
    s_waitcnt vmcnt(0)
    v_and_b32 v184, v184, v205
    v_and_b32 v184, v184, v207
    v_fma_f32 v182, v154, v180, v204
    v_fma_f32 v183, v154, v181, v206
    v_fma_f32 v183, v155, v180, v183
    v_fma_f32 v180, -v155, v181, v182
    v_mov_b32 v181, v183
    s_cmp_eq_u32 s17, 1
    s_cbranch_scc1 K1_lbchk
    v_and_b32 v184, v184, v209
    v_and_b32 v184, v184, v211
    v_fma_f32 v182, v154, v180, v208
    v_fma_f32 v183, v154, v181, v210
    v_fma_f32 v183, v155, v180, v183
    v_fma_f32 v180, -v155, v181, v182
    v_mov_b32 v181, v183
    s_cmp_eq_u32 s17, 2
    s_cbranch_scc1 K1_lbchk
    v_and_b32 v184, v184, v213
    v_and_b32 v184, v184, v215
    v_fma_f32 v182, v154, v180, v212
    v_fma_f32 v183, v154, v181, v214
    v_fma_f32 v183, v155, v180, v183
    v_fma_f32 v180, -v155, v181, v182
    v_mov_b32 v181, v183
    s_cmp_eq_u32 s17, 3
    s_cbranch_scc1 K1_lbchk
    v_and_b32 v184, v184, v217
    v_and_b32 v184, v184, v219
    v_fma_f32 v182, v154, v180, v216
    v_fma_f32 v183, v154, v181, v218
    v_fma_f32 v183, v155, v180, v183
    v_fma_f32 v180, -v155, v181, v182
    v_mov_b32 v181, v183
    s_cmp_eq_u32 s17, 4
    s_cbranch_scc1 K1_lbchk
    v_and_b32 v184, v184, v221
    v_and_b32 v184, v184, v223
    v_fma_f32 v182, v154, v180, v220
    v_fma_f32 v183, v154, v181, v222
    v_fma_f32 v183, v155, v180, v183
    v_fma_f32 v180, -v155, v181, v182
    v_mov_b32 v181, v183
    s_cmp_eq_u32 s17, 5
    s_cbranch_scc1 K1_lbchk
    v_and_b32 v184, v184, v225
    v_and_b32 v184, v184, v227
    v_fma_f32 v182, v154, v180, v224
    v_fma_f32 v183, v154, v181, v226
    v_fma_f32 v183, v155, v180, v183
    v_fma_f32 v180, -v155, v181, v182
    v_mov_b32 v181, v183
    s_cmp_eq_u32 s17, 6
    s_cbranch_scc1 K1_lbchk
    v_and_b32 v184, v184, v229
    v_and_b32 v184, v184, v231
    v_fma_f32 v182, v154, v180, v228
    v_fma_f32 v183, v154, v181, v230
    v_fma_f32 v183, v155, v180, v183
    v_fma_f32 v180, -v155, v181, v182
    v_mov_b32 v181, v183
K1_lbchk:
    v_cmp_ne_u32 vcc, 1, v184
    s_cbranch_vccz K1_lbdone
    s_add_u32 s47, s47, 1
    s_cmp_lt_u32 s47, 0x40000
    s_cbranch_scc1 K1_lbloop
K1_lbdone:
    s_lshl_b32 s40, s16, 10
    s_add_u32 s40, s40, 158720
    v_lshl_add_u32 v199, v200, 3, s40
    s_mov_b64 exec, 0xffff
    ds_write_b64 v199, v[180:181]
    v_fmac_f32 v8, v152, v180
    v_fmac_f32 v9, v152, v181
    v_fma_f32 v8, -v153, v181, v8
    v_fmac_f32 v9, v153, v180
    ds_write_b64 v199, v[8:9] offset:128
    v_fmac_f32 v10, v152, v8
    v_fmac_f32 v11, v152, v9
    v_fma_f32 v10, -v153, v9, v10
    v_fmac_f32 v11, v153, v8
    ds_write_b64 v199, v[10:11] offset:256
    v_fmac_f32 v12, v152, v10
    v_fmac_f32 v13, v152, v11
    v_fma_f32 v12, -v153, v11, v12
    v_fmac_f32 v13, v153, v10
    ds_write_b64 v199, v[12:13] offset:384
    v_fmac_f32 v14, v152, v12
    v_fmac_f32 v15, v152, v13
    v_fma_f32 v14, -v153, v13, v14
    v_fmac_f32 v15, v153, v12
    ds_write_b64 v199, v[14:15] offset:512
    v_fmac_f32 v16, v152, v14
    v_fmac_f32 v17, v152, v15
    v_fma_f32 v16, -v153, v15, v16
    v_fmac_f32 v17, v153, v14
    ds_write_b64 v199, v[16:17] offset:640
    v_fmac_f32 v18, v152, v16
    v_fmac_f32 v19, v152, v17
    v_fma_f32 v18, -v153, v17, v18
    v_fmac_f32 v19, v153, v16
    ds_write_b64 v199, v[18:19] offset:768
    v_fmac_f32 v20, v152, v18
    v_fmac_f32 v21, v152, v19
    v_fma_f32 v20, -v153, v19, v20
    v_fmac_f32 v21, v153, v18
    ds_write_b64 v199, v[20:21] offset:896
    s_mov_b64 exec, -1
    s_setprio 0
K1_join:
    s_lshl_b32 s40, s16, 7
    s_add_u32 s40, s40, 158720
    v_lshl_add_u32 v188, v200, 3, s40
    s_mul_i32 s40, s16, 12800
    s_add_u32 s40, s40, 2048
    v_mul_u32_u24 v198, 80, v200
    v_lshl_add_u32 v198, v201, 4, v198
    v_add_u32 v198, s40, v198
    v_bfe_u32 v200, v0, 2, 2
    v_lshl_add_u32 v199, v201, 3, v200
    v_mul_u32_u24 v199, 80, v199
    v_and_b32 v200, 3, v0
    v_lshl_add_u32 v199, v200, 4, v199
    v_add_u32 v199, s40, v199
    v_lshrrev_b32 v200, 5, v0
    v_lshlrev_b32 v200, 11, v200
    v_and_b32 v201, 31, v0
    v_lshl_add_u32 v200, v201, 4, v200
    s_waitcnt lgkmcnt(0)
    s_barrier
    ds_read_b64 v[170:171], v188 offset:0
    ds_read_b64 v[172:173], v188 offset:1024
    ds_read_b64 v[174:175], v188 offset:2048
    ds_read_b64 v[176:177], v188 offset:3072
    ds_read_b64 v[178:179], v188 offset:4096
    s_mul_i32 s40, s99, 192
    s_lshl_b32 s41, s16, 3
    s_add_u32 s40, s40, s41
    v_lshrrev_b32 v6, 3, v0
    v_add_u32 v6, s40, v6
    v_mul_u32_u24 v6, 1152, v6
    s_and_b32 s41, s16, 1
    s_lshl_b32 s41, s41, 2
    v_lshrrev_b32 v15, 4, v0
    v_add_u32 v15, s41, v15
    v_and_b32 v14, 7, v0
    v_xor_b32 v15, v15, v14
    v_lshl_add_u32 v6, v15, 4, v6
    s_cmp_lt_u32 s17, 6
    s_cselect_b32 s28, 0, 0x7ff00000
    s_add_u32 m0, s35, 147456
    s_add_u32 s41, s28, 0
    buffer_load_dwordx4 v6, s[8:11], s41 offen lds
    s_add_u32 m0, s35, 139264
    s_add_u32 s41, s28, 73728
    buffer_load_dwordx4 v6, s[8:11], s41 offen lds
    s_add_u32 m0, s35, 131072
    s_add_u32 s41, s28, 147456
    buffer_load_dwordx4 v6, s[8:11], s41 offen lds
    s_add_u32 m0, s35, 122880
    s_add_u32 s41, s28, 0
    buffer_load_dwordx4 v6, s[12:15], s41 offen lds
    s_add_u32 m0, s35, 114688
    s_add_u32 s41, s28, 73728
    buffer_load_dwordx4 v6, s[12:15], s41 offen lds
    s_add_u32 m0, s35, 106496
    s_add_u32 s41, s28, 147456
    buffer_load_dwordx4 v6, s[12:15], s41 offen lds
    s_waitcnt lgkmcnt(0)
    v_fmac_f32 v160, v118, v170
    v_fmac_f32 v161, v118, v171
    v_fma_f32 v160, -v119, v171, v160
    v_fmac_f32 v161, v119, v170
    v_fmac_f32 v162, v126, v172
    v_fmac_f32 v163, v126, v173
    v_fma_f32 v162, -v127, v173, v162
    v_fmac_f32 v163, v127, v172
    v_fmac_f32 v164, v134, v174
    v_fmac_f32 v165, v134, v175
    v_fma_f32 v164, -v135, v175, v164
    v_fmac_f32 v165, v135, v174
    v_fmac_f32 v166, v142, v176
    v_fmac_f32 v167, v142, v177
    v_fma_f32 v166, -v143, v177, v166
    v_fmac_f32 v167, v143, v176
    v_fmac_f32 v168, v150, v178
    v_fmac_f32 v169, v150, v179
    v_fma_f32 v168, -v151, v179, v168
    v_fmac_f32 v169, v151, v178
    v_fmac_f32 v32, v112, v160
    v_fmac_f32 v40, v112, v161
    v_fmac_f32 v32, v248, v161
    v_fmac_f32 v40, v113, v160
    v_fmac_f32 v48, v120, v162
    v_fmac_f32 v56, v120, v163
    v_fmac_f32 v48, v249, v163
    v_fmac_f32 v56, v121, v162
    v_fmac_f32 v64, v128, v164
    v_fmac_f32 v72, v128, v165
    v_fmac_f32 v64, v250, v165
    v_fmac_f32 v72, v129, v164
    v_fmac_f32 v33, v112, v32
    v_fmac_f32 v41, v112, v40
    v_fmac_f32 v33, v248, v40
    v_fmac_f32 v41, v113, v32
    v_fmac_f32 v49, v120, v48
    v_fmac_f32 v57, v120, v56
    v_fmac_f32 v49, v249, v56
    v_fmac_f32 v57, v121, v48
    v_fmac_f32 v65, v128, v64
    v_fmac_f32 v73, v128, v72
    v_fmac_f32 v65, v250, v72
    v_fmac_f32 v73, v129, v64
    v_fmac_f32 v34, v112, v33
    v_fmac_f32 v42, v112, v41
    v_fmac_f32 v34, v248, v41
    v_fmac_f32 v42, v113, v33
    v_fmac_f32 v50, v120, v49
    v_fmac_f32 v58, v120, v57
    v_fmac_f32 v50, v249, v57
    v_fmac_f32 v58, v121, v49
    v_fmac_f32 v66, v128, v65
    v_fmac_f32 v74, v128, v73
    v_fmac_f32 v66, v250, v73
    v_fmac_f32 v74, v129, v65
    v_fmac_f32 v35, v112, v34
    v_fmac_f32 v43, v112, v42
    v_fmac_f32 v35, v248, v42
    v_fmac_f32 v43, v113, v34
    v_fmac_f32 v51, v120, v50
    v_fmac_f32 v59, v120, v58
    v_fmac_f32 v51, v249, v58
    v_fmac_f32 v59, v121, v50
    v_fmac_f32 v67, v128, v66
    v_fmac_f32 v75, v128, v74
    v_fmac_f32 v67, v250, v74
    v_fmac_f32 v75, v129, v66
    v_fmac_f32 v36, v112, v35
    v_fmac_f32 v44, v112, v43
    v_fmac_f32 v36, v248, v43
    v_fmac_f32 v44, v113, v35
    v_fmac_f32 v52, v120, v51
    v_fmac_f32 v60, v120, v59
    v_fmac_f32 v52, v249, v59
    v_fmac_f32 v60, v121, v51
    v_fmac_f32 v68, v128, v67
    v_fmac_f32 v76, v128, v75
    v_fmac_f32 v68, v250, v75
    v_fmac_f32 v76, v129, v67
    v_fmac_f32 v37, v112, v36
    v_fmac_f32 v45, v112, v44
    v_fmac_f32 v37, v248, v44
    v_fmac_f32 v45, v113, v36
    v_fmac_f32 v53, v120, v52
    v_fmac_f32 v61, v120, v60
    v_fmac_f32 v53, v249, v60
    v_fmac_f32 v61, v121, v52
    v_fmac_f32 v69, v128, v68
    v_fmac_f32 v77, v128, v76
    v_fmac_f32 v69, v250, v76
    v_fmac_f32 v77, v129, v68
    v_fmac_f32 v38, v112, v37
    v_fmac_f32 v46, v112, v45
    v_fmac_f32 v38, v248, v45
    v_fmac_f32 v46, v113, v37
    v_fmac_f32 v54, v120, v53
    v_fmac_f32 v62, v120, v61
    v_fmac_f32 v54, v249, v61
    v_fmac_f32 v62, v121, v53
    v_fmac_f32 v70, v128, v69
    v_fmac_f32 v78, v128, v77
    v_fmac_f32 v70, v250, v77
    v_fmac_f32 v78, v129, v69
    v_fmac_f32 v39, v112, v38
    v_fmac_f32 v47, v112, v46
    v_fmac_f32 v39, v248, v46
    v_fmac_f32 v47, v113, v38
    v_fmac_f32 v55, v120, v54
    v_fmac_f32 v63, v120, v62
    v_fmac_f32 v55, v249, v62
    v_fmac_f32 v63, v121, v54
    v_fmac_f32 v71, v128, v70
    v_fmac_f32 v79, v128, v78
    v_fmac_f32 v71, v250, v78
    v_fmac_f32 v79, v129, v70
    v_cvt_pk_bf16_f32 v204, v32, v33
    v_cvt_pk_bf16_f32 v208, -v40, -v41
    v_cvt_pk_bf16_f32 v205, v34, v35
    v_cvt_pk_bf16_f32 v209, -v42, -v43
    v_cvt_pk_bf16_f32 v206, v36, v37
    v_cvt_pk_bf16_f32 v210, -v44, -v45
    v_cvt_pk_bf16_f32 v207, v38, v39
    v_cvt_pk_bf16_f32 v211, -v46, -v47
    ds_write_b128 v198, v[204:207] offset:0
    ds_write_b128 v198, v[208:211] offset:1280
    ds_read_b64_tr_b16 v[32:33], v199 offset:0
    ds_read_b64_tr_b16 v[34:35], v199 offset:320
    ds_read_b64_tr_b16 v[36:37], v199 offset:8
    ds_read_b64_tr_b16 v[38:39], v199 offset:328
    v_cvt_pk_bf16_f32 v212, v48, v49
    v_cvt_pk_bf16_f32 v216, -v56, -v57
    v_cvt_pk_bf16_f32 v213, v50, v51
    v_cvt_pk_bf16_f32 v217, -v58, -v59
    v_cvt_pk_bf16_f32 v214, v52, v53
    v_cvt_pk_bf16_f32 v218, -v60, -v61
    v_cvt_pk_bf16_f32 v215, v54, v55
    v_cvt_pk_bf16_f32 v219, -v62, -v63
    ds_write_b128 v198, v[212:215] offset:2560
    ds_write_b128 v198, v[216:219] offset:3840
    ds_read_b64_tr_b16 v[48:49], v199 offset:2560
    ds_read_b64_tr_b16 v[50:51], v199 offset:2880
    ds_read_b64_tr_b16 v[52:53], v199 offset:2568
    ds_read_b64_tr_b16 v[54:55], v199 offset:2888
    v_cvt_pk_bf16_f32 v220, v64, v65
    v_cvt_pk_bf16_f32 v224, -v72, -v73
    v_cvt_pk_bf16_f32 v221, v66, v67
    v_cvt_pk_bf16_f32 v225, -v74, -v75
    v_cvt_pk_bf16_f32 v222, v68, v69
    v_cvt_pk_bf16_f32 v226, -v76, -v77
    v_cvt_pk_bf16_f32 v223, v70, v71
    v_cvt_pk_bf16_f32 v227, -v78, -v79
    ds_write_b128 v198, v[220:223] offset:5120
    ds_write_b128 v198, v[224:227] offset:6400
    ds_read_b64_tr_b16 v[64:65], v199 offset:5120
    ds_read_b64_tr_b16 v[66:67], v199 offset:5440
    ds_read_b64_tr_b16 v[68:69], v199 offset:5128
    ds_read_b64_tr_b16 v[70:71], v199 offset:5448
    v_fmac_f32 v80, v136, v166
    v_fmac_f32 v88, v136, v167
    v_fmac_f32 v80, v251, v167
    v_fmac_f32 v88, v137, v166
    v_fmac_f32 v96, v144, v168
    v_fmac_f32 v104, v144, v169
    v_fmac_f32 v96, v252, v169
    v_fmac_f32 v104, v145, v168
    v_fmac_f32 v81, v136, v80
    v_fmac_f32 v89, v136, v88
    v_fmac_f32 v81, v251, v88
    v_fmac_f32 v89, v137, v80
    v_fmac_f32 v97, v144, v96
    v_fmac_f32 v105, v144, v104
    v_fmac_f32 v97, v252, v104
    v_fmac_f32 v105, v145, v96
    v_fmac_f32 v82, v136, v81
    v_fmac_f32 v90, v136, v89
    v_fmac_f32 v82, v251, v89
    v_fmac_f32 v90, v137, v81
    v_fmac_f32 v98, v144, v97
    v_fmac_f32 v106, v144, v105
    v_fmac_f32 v98, v252, v105
    v_fmac_f32 v106, v145, v97
    v_fmac_f32 v83, v136, v82
    v_fmac_f32 v91, v136, v90
    v_fmac_f32 v83, v251, v90
    v_fmac_f32 v91, v137, v82
    v_fmac_f32 v99, v144, v98
    v_fmac_f32 v107, v144, v106
    v_fmac_f32 v99, v252, v106
    v_fmac_f32 v107, v145, v98
    v_fmac_f32 v84, v136, v83
    v_fmac_f32 v92, v136, v91
    v_fmac_f32 v84, v251, v91
    v_fmac_f32 v92, v137, v83
    v_fmac_f32 v100, v144, v99
    v_fmac_f32 v108, v144, v107
    v_fmac_f32 v100, v252, v107
    v_fmac_f32 v108, v145, v99
    v_fmac_f32 v85, v136, v84
    v_fmac_f32 v93, v136, v92
    v_fmac_f32 v85, v251, v92
    v_fmac_f32 v93, v137, v84
    v_fmac_f32 v101, v144, v100
    v_fmac_f32 v109, v144, v108
    v_fmac_f32 v101, v252, v108
    v_fmac_f32 v109, v145, v100
    v_fmac_f32 v86, v136, v85
    v_fmac_f32 v94, v136, v93
    v_fmac_f32 v86, v251, v93
    v_fmac_f32 v94, v137, v85
    v_fmac_f32 v102, v144, v101
    v_fmac_f32 v110, v144, v109
    v_fmac_f32 v102, v252, v109
    v_fmac_f32 v110, v145, v101
    v_fmac_f32 v87, v136, v86
    v_fmac_f32 v95, v136, v94
    v_fmac_f32 v87, v251, v94
    v_fmac_f32 v95, v137, v86
    v_fmac_f32 v103, v144, v102
    v_fmac_f32 v111, v144, v110
    v_fmac_f32 v103, v252, v110
    v_fmac_f32 v111, v145, v102
    s_waitcnt lgkmcnt(0)
    s_add_u32 s40, s39, 0
    s_lshr_b32 s41, s40, 2
    s_lshl_b32 s41, s41, 12
    s_and_b32 s42, s40, 3
    s_lshl_b32 s42, s42, 9
    s_add_u32 s41, s41, s42
    s_add_u32 s41, s41, s34
    s_add_u32 s41, s41, 147456
    s_cmp_lt_u32 s40, 36
    s_cselect_b32 s41, s41, 0x7ff00000
    s_add_u32 s42, s41, 184320
    buffer_store_dwordx4 v[32:35], v200, s[4:7], s41 offen sc1
    buffer_store_dwordx4 v[36:39], v200, s[4:7], s42 offen sc1
    s_add_u32 s40, s39, 1
    s_lshr_b32 s41, s40, 2
    s_lshl_b32 s41, s41, 12
    s_and_b32 s42, s40, 3
    s_lshl_b32 s42, s42, 9
    s_add_u32 s41, s41, s42
    s_add_u32 s41, s41, s34
    s_add_u32 s41, s41, 147456
    s_cmp_lt_u32 s40, 36
    s_cselect_b32 s41, s41, 0x7ff00000
    s_add_u32 s42, s41, 184320
    buffer_store_dwordx4 v[48:51], v200, s[4:7], s41 offen sc1
    buffer_store_dwordx4 v[52:55], v200, s[4:7], s42 offen sc1
    s_add_u32 s40, s39, 2
    s_lshr_b32 s41, s40, 2
    s_lshl_b32 s41, s41, 12
    s_and_b32 s42, s40, 3
    s_lshl_b32 s42, s42, 9
    s_add_u32 s41, s41, s42
    s_add_u32 s41, s41, s34
    s_add_u32 s41, s41, 147456
    s_cmp_lt_u32 s40, 36
    s_cselect_b32 s41, s41, 0x7ff00000
    s_add_u32 s42, s41, 184320
    buffer_store_dwordx4 v[64:67], v200, s[4:7], s41 offen sc1
    buffer_store_dwordx4 v[68:71], v200, s[4:7], s42 offen sc1
    v_cvt_pk_bf16_f32 v228, v80, v81
    v_cvt_pk_bf16_f32 v232, -v88, -v89
    v_cvt_pk_bf16_f32 v229, v82, v83
    v_cvt_pk_bf16_f32 v233, -v90, -v91
    v_cvt_pk_bf16_f32 v230, v84, v85
    v_cvt_pk_bf16_f32 v234, -v92, -v93
    v_cvt_pk_bf16_f32 v231, v86, v87
    v_cvt_pk_bf16_f32 v235, -v94, -v95
    ds_write_b128 v198, v[228:231] offset:7680
    ds_write_b128 v198, v[232:235] offset:8960
    ds_read_b64_tr_b16 v[80:81], v199 offset:7680
    ds_read_b64_tr_b16 v[82:83], v199 offset:8000
    ds_read_b64_tr_b16 v[84:85], v199 offset:7688
    ds_read_b64_tr_b16 v[86:87], v199 offset:8008
    v_cvt_pk_bf16_f32 v236, v96, v97
    v_cvt_pk_bf16_f32 v240, -v104, -v105
    v_cvt_pk_bf16_f32 v237, v98, v99
    v_cvt_pk_bf16_f32 v241, -v106, -v107
    v_cvt_pk_bf16_f32 v238, v100, v101
    v_cvt_pk_bf16_f32 v242, -v108, -v109
    v_cvt_pk_bf16_f32 v239, v102, v103
    v_cvt_pk_bf16_f32 v243, -v110, -v111
    ds_write_b128 v198, v[236:239] offset:10240
    ds_write_b128 v198, v[240:243] offset:11520
    ds_read_b64_tr_b16 v[96:97], v199 offset:10240
    ds_read_b64_tr_b16 v[98:99], v199 offset:10560
    ds_read_b64_tr_b16 v[100:101], v199 offset:10248
    ds_read_b64_tr_b16 v[102:103], v199 offset:10568
    s_waitcnt lgkmcnt(0)
    s_add_u32 s40, s39, 3
    s_lshr_b32 s41, s40, 2
    s_lshl_b32 s41, s41, 12
    s_and_b32 s42, s40, 3
    s_lshl_b32 s42, s42, 9
    s_add_u32 s41, s41, s42
    s_add_u32 s41, s41, s34
    s_add_u32 s41, s41, 147456
    s_cmp_lt_u32 s40, 36
    s_cselect_b32 s41, s41, 0x7ff00000
    s_add_u32 s42, s41, 184320
    buffer_store_dwordx4 v[80:83], v200, s[4:7], s41 offen sc1
    buffer_store_dwordx4 v[84:87], v200, s[4:7], s42 offen sc1
    s_add_u32 s40, s39, 4
    s_lshr_b32 s41, s40, 2
    s_lshl_b32 s41, s41, 12
    s_and_b32 s42, s40, 3
    s_lshl_b32 s42, s42, 9
    s_add_u32 s41, s41, s42
    s_add_u32 s41, s41, s34
    s_add_u32 s41, s41, 147456
    s_cmp_lt_u32 s40, 36
    s_cselect_b32 s41, s41, 0x7ff00000
    s_add_u32 s42, s41, 184320
    buffer_store_dwordx4 v[96:99], v200, s[4:7], s41 offen sc1
    buffer_store_dwordx4 v[100:103], v200, s[4:7], s42 offen sc1
    s_and_b32 s23, s16, 3
    s_lshr_b32 s42, s16, 2
    s_lshl_b32 s30, s98, 2
    s_add_u32 s30, s30, s23
    s_mul_i32 s30, s30, 360
    s_mul_i32 s31, s97, 36
    s_add_u32 s30, s30, s31
    s_add_u32 s30, s30, s42
    s_lshl_b32 s30, s30, 10
    s_add_u32 s30, s30, 2359296
    s_add_u32 s31, s30, 184320
    s_lshl_b32 s57, s98, 2
    s_add_u32 s57, s57, s23
    s_mul_i32 s57, s57, 640
    s_lshl_b32 s47, s97, 7
    s_add_u32 s57, s57, s47
    s_add_u32 s57, s57, 42717184
    s_mul_i32 s43, s98, 3
    s_add_u32 s43, s43, s99
    s_add_u32 s49, s97, 10
    s_sub_u32 s49, s49, s16
    s_mul_i32 s47, s49, 52
    s_lshr_b32 s47, s47, 8
    s_mul_i32 s47, s47, 5
    s_sub_u32 s49, s49, s47
    s_lshl_b32 s47, s98, 7
    s_lshl_b32 s50, s23, 5
    s_add_u32 s47, s47, s50
    s_mul_i32 s47, s47, 2304
    s_mul_i32 s50, s99, 768
    s_add_u32 s47, s47, s50
    s_lshl_b32 s50, s42, 8
    s_add_u32 s60, s47, s50
    s_and_b32 s50, s49, 1
    s_mul_i32 s50, s50, 9216
    s_add_u32 s60, s60, s50
    s_lshr_b32 s50, s49, 1
    s_lshl_b32 s50, s50, 7
    s_add_u32 s60, s60, s50
    s_lshl_b32 s50, s42, 7
    s_add_u32 s61, s47, s50
    s_add_u32 s61, s61, 512
    s_cmp_eq_u32 s49, 0
    s_cselect_b32 s50, 9216, 0
    s_add_u32 s61, s61, s50
    s_lshl_b32 s47, s43, 3
    s_add_u32 s47, s47, s16
    s_mul_i32 s47, s47, 6144
    s_add_u32 s47, s47, 30789632
    s_mul_i32 s54, s97, 2359296
    s_add_u32 s54, s54, s47
    s_add_u32 s55, s54, 3072
    s_lshl_b32 s50, s49, 10
    s_add_u32 s62, s47, s50
    s_cmp_eq_u32 s49, 0
    s_mov_b32 s50, 4096
    s_cselect_b32 s50, 5120, s50
    s_add_u32 s63, s47, s50
    s_cmp_lt_u32 s49, 4
    s_cselect_b32 s60, s60, 0x7ff00000
    s_cselect_b32 s62, s62, 0x7ff00000
    s_and_b32 s50, s49, 3
    s_cmp_eq_u32 s50, 0
    s_cselect_b32 s61, s61, 0x7ff00000
    s_cselect_b32 s63, s63, 0x7ff00000
    s_lshl_b32 s47, s43, 3
    s_add_u32 s47, s47, 0
    s_lshl_b32 s47, s47, 7
    s_add_u32 s48, s47, 42651648
    v_bfe_u32 v10, v0, 2, 2
    v_lshlrev_b32 v10, 3, v10
    v_and_b32 v15, 3, v0
    v_add_u32 v10, v10, v15
    v_mul_u32_u24 v10, 2304, v10
    v_lshrrev_b32 v15, 4, v0
    v_lshl_add_u32 v10, v15, 4, v10
    s_lshl_b32 s47, s16, 13
    s_add_u32 s47, s47, 92160
    v_add_u32 v11, s47, v1
    s_xor_b32 s50, s16, 4
    s_lshl_b32 s50, s50, 13
    s_add_u32 s50, s50, 92160
    v_add_u32 v12, s50, v1
    v_min_u32 v13, 7, v0
    v_lshlrev_b32 v13, 2, v13
    v_and_b32 v14, 15, v0
    v_lshrrev_b32 v15, 1, v14
    v_lshrrev_b32 v3, 4, v0
    s_lshl_b32 s40, s42, 2
    v_add_u32 v3, s40, v3
    v_xor_b32 v15, v15, v3
    v_lshlrev_b32 v15, 4, v15
    v_lshl_add_u32 v2, v14, 7, v15
    v_add_u32 v2, 2048, v2
    v_add_u32 v3, 57344, v2
    v_add_u32 v4, 114688, v2
    s_lshl_b32 s46, s16, 8
    v_mov_b32 v7, 0
    s_mov_b32 m0, s46
    v_and_b32 v9, 7, v0
    v_mul_u32_u24 v9, 260, v9
    ds_write_addtid_b32 v7
    s_waitcnt vmcnt(0)
    v_mov_b32 v15, 3
    s_mov_b64 exec, 1
    buffer_store_dword v15, v1, s[4:7], s56 offen sc1
    s_mov_b64 exec, -1
    s_cmp_ge_u32 s17, 6
    s_cbranch_scc1 K1_done
    s_waitcnt lgkmcnt(0)
    s_barrier
    buffer_load_dword v248, v13, s[4:7], s57 offen sc1
    ds_read_b128 v[16:19], v4 offset:32768
    ds_read_b128 v[20:23], v4 offset:34816
    ds_read_b128 v[24:27], v4 offset:36864
    ds_read_b128 v[28:31], v4 offset:38912
    ds_read_b128 v[32:35], v4 offset:24576
    ds_read_b128 v[36:39], v4 offset:26624
    s_waitcnt vmcnt(0)
    v_cmp_gt_u32 vcc, 3, v248
    s_cbranch_vccnz PLs_136
PLb_137:
    s_add_u32 s36, s30, 0
    buffer_load_dwordx4 v[112:115], v1, s[4:7], s36 offen sc1
    s_add_u32 s36, s31, 0
    buffer_load_dwordx4 v[116:119], v1, s[4:7], s36 offen sc1
    s_add_u32 s36, s30, 2048
    buffer_load_dwordx4 v[120:123], v1, s[4:7], s36 offen sc1
    s_add_u32 s36, s31, 2048
    buffer_load_dwordx4 v[124:127], v1, s[4:7], s36 offen sc1
    s_add_u32 s36, s30, 4096
    buffer_load_dwordx4 v[128:131], v1, s[4:7], s36 offen sc1
    s_add_u32 s36, s31, 4096
    buffer_load_dwordx4 v[132:135], v1, s[4:7], s36 offen sc1
    s_mov_b32 m0, s46
    v_add_u32 v7, 1, v7
    ds_write_addtid_b32 v7
    s_setprio 0
    s_waitcnt vmcnt(4)
    s_waitcnt lgkmcnt(6)
    v_mfma_f32_16x16x32_bf16 v[208:211], v[16:19], v[112:115], 0
    ds_read_b128 v[40:43], v4 offset:28672
    v_mfma_f32_16x16x32_bf16 v[212:215], v[16:19], v[116:119], 0
    s_add_u32 s36, s30, 6144
    buffer_load_dwordx4 v[136:139], v1, s[4:7], s36 offen sc1
    s_waitcnt lgkmcnt(6)
    v_mfma_f32_16x16x32_bf16 v[216:219], v[20:23], v[112:115], 0
    ds_read_b128 v[44:47], v4 offset:30720
    v_mfma_f32_16x16x32_bf16 v[220:223], v[20:23], v[116:119], 0
    s_add_u32 s36, s31, 6144
    buffer_load_dwordx4 v[140:143], v1, s[4:7], s36 offen sc1
    s_waitcnt lgkmcnt(6)
    v_mfma_f32_16x16x32_bf16 v[224:227], v[24:27], v[112:115], 0
    ds_read_b128 v[16:19], v4 offset:16384
    v_mfma_f32_16x16x32_bf16 v[228:231], v[24:27], v[116:119], 0
    s_add_u32 m0, s35, 98304
    s_add_u32 s41, s28, 128
    buffer_load_dwordx4 v6, s[8:11], s41 offen lds
    s_waitcnt lgkmcnt(6)
    v_mfma_f32_16x16x32_bf16 v[232:235], v[28:31], v[112:115], 0
    ds_read_b128 v[20:23], v4 offset:18432
    v_mfma_f32_16x16x32_bf16 v[236:239], v[28:31], v[116:119], 0
    s_add_u32 m0, s35, 90112
    s_add_u32 s41, s28, 73856
    buffer_load_dwordx4 v6, s[8:11], s41 offen lds
    s_waitcnt lgkmcnt(6)
    v_mfma_f32_16x16x32_bf16 v[48:51], v[32:35], v[112:115], 0
    ds_read_b128 v[24:27], v4 offset:20480
    v_mfma_f32_16x16x32_bf16 v[52:55], v[32:35], v[116:119], 0
    s_add_u32 s36, s30, 8192
    buffer_load_dwordx4 v[144:147], v1, s[4:7], s36 offen sc1
    ds_read_b32 v8, v9
    s_waitcnt lgkmcnt(7)
    v_mfma_f32_16x16x32_bf16 v[56:59], v[36:39], v[112:115], 0
    ds_read_b128 v[28:31], v4 offset:22528
    v_mfma_f32_16x16x32_bf16 v[60:63], v[36:39], v[116:119], 0
    s_add_u32 s36, s31, 8192
    buffer_load_dwordx4 v[148:151], v1, s[4:7], s36 offen sc1
    s_waitcnt lgkmcnt(6)
    v_mfma_f32_16x16x32_bf16 v[64:67], v[40:43], v[112:115], 0
    ds_read_b128 v[32:35], v4 offset:8192
    v_mfma_f32_16x16x32_bf16 v[68:71], v[40:43], v[116:119], 0
    s_add_u32 m0, s35, 81920
    s_add_u32 s41, s28, 147584
    buffer_load_dwordx4 v6, s[8:11], s41 offen lds
    s_waitcnt lgkmcnt(6)
    v_mfma_f32_16x16x32_bf16 v[72:75], v[44:47], v[112:115], 0
    ds_read_b128 v[36:39], v4 offset:10240
    v_mfma_f32_16x16x32_bf16 v[76:79], v[44:47], v[116:119], 0
    s_add_u32 m0, s35, 73728
    s_add_u32 s41, s28, 128
    buffer_load_dwordx4 v6, s[12:15], s41 offen lds
    s_waitcnt lgkmcnt(3)
    v_cmp_gt_i32 vcc, v7, v8
    s_cbranch_vccnz SBs_138
SBb_139:
    s_setprio 1
    s_waitcnt vmcnt(1)
    s_mov_b32 m0, s46
    v_add_u32 v7, 1, v7
    ds_write_addtid_b32 v7
    s_setprio 0
    v_mfma_f32_16x16x32_bf16 v[80:83], v[16:19], v[112:115], 0
    ds_read_b128 v[40:43], v4 offset:12288
    v_mfma_f32_16x16x32_bf16 v[84:87], v[16:19], v[116:119], 0
    v_mfma_f32_16x16x32_bf16 v[88:91], v[20:23], v[112:115], 0
    ds_read_b128 v[44:47], v4 offset:14336
    v_mfma_f32_16x16x32_bf16 v[92:95], v[20:23], v[116:119], 0
    s_add_u32 m0, s35, 147456
    s_add_u32 s41, s28, 73856
    buffer_load_dwordx4 v6, s[12:15], s41 offen lds
    v_mfma_f32_16x16x32_bf16 v[96:99], v[24:27], v[112:115], 0
    ds_read_b128 v[16:19], v4 offset:0
    v_mfma_f32_16x16x32_bf16 v[100:103], v[24:27], v[116:119], 0
    s_waitcnt lgkmcnt(6)
    v_mfma_f32_16x16x32_bf16 v[104:107], v[28:31], v[112:115], 0
    ds_read_b128 v[20:23], v4 offset:2048
    v_mfma_f32_16x16x32_bf16 v[108:111], v[28:31], v[116:119], 0
    s_add_u32 m0, s35, 65536
    s_add_u32 s41, s28, 147584
    buffer_load_dwordx4 v6, s[12:15], s41 offen lds
    s_waitcnt lgkmcnt(6)
    v_mfma_f32_16x16x32_bf16 v[208:211], v[32:35], v[120:123], v[208:211]
    ds_read_b128 v[24:27], v4 offset:4096
    v_mfma_f32_16x16x32_bf16 v[212:215], v[32:35], v[124:127], v[212:215]
    s_add_u32 s36, s30, 10240
    buffer_load_dwordx4 v[152:155], v1, s[4:7], s36 offen sc1
    ds_read_b32 v8, v9
    s_waitcnt lgkmcnt(7)
    v_mfma_f32_16x16x32_bf16 v[216:219], v[36:39], v[120:123], v[216:219]
    ds_read_b128 v[28:31], v4 offset:6144
    v_mfma_f32_16x16x32_bf16 v[220:223], v[36:39], v[124:127], v[220:223]
    s_add_u32 s36, s31, 10240
    buffer_load_dwordx4 v[156:159], v1, s[4:7], s36 offen sc1
    s_waitcnt lgkmcnt(6)
    v_mfma_f32_16x16x32_bf16 v[224:227], v[40:43], v[120:123], v[224:227]
    ds_read_b128 v[32:35], v3 offset:49152
    v_mfma_f32_16x16x32_bf16 v[228:231], v[40:43], v[124:127], v[228:231]
    s_add_u32 m0, s35, 57344
    s_add_u32 s41, s28, 256
    buffer_load_dwordx4 v6, s[8:11], s41 offen lds
    s_waitcnt lgkmcnt(6)
    v_mfma_f32_16x16x32_bf16 v[232:235], v[44:47], v[120:123], v[232:235]
    ds_read_b128 v[36:39], v3 offset:51200
    v_mfma_f32_16x16x32_bf16 v[236:239], v[44:47], v[124:127], v[236:239]
    s_add_u32 m0, s35, 49152
    s_add_u32 s41, s28, 73984
    buffer_load_dwordx4 v6, s[8:11], s41 offen lds
    s_waitcnt lgkmcnt(3)
    v_cmp_gt_i32 vcc, v7, v8
    s_cbranch_vccnz SBs_140
SBb_141:
    s_setprio 1
    v_mfma_f32_16x16x32_bf16 v[48:51], v[16:19], v[120:123], v[48:51]
    ds_read_b128 v[40:43], v3 offset:53248
    v_mfma_f32_16x16x32_bf16 v[52:55], v[16:19], v[124:127], v[52:55]
    v_mfma_f32_16x16x32_bf16 v[56:59], v[20:23], v[120:123], v[56:59]
    ds_read_b128 v[44:47], v3 offset:55296
    v_mfma_f32_16x16x32_bf16 v[60:63], v[20:23], v[124:127], v[60:63]
    s_add_u32 m0, s35, 139264
    s_add_u32 s41, s28, 147712
    buffer_load_dwordx4 v6, s[8:11], s41 offen lds
    v_mfma_f32_16x16x32_bf16 v[64:67], v[24:27], v[120:123], v[64:67]
    ds_read_b128 v[16:19], v3 offset:40960
    v_mfma_f32_16x16x32_bf16 v[68:71], v[24:27], v[124:127], v[68:71]
    s_waitcnt lgkmcnt(5)
    v_mfma_f32_16x16x32_bf16 v[72:75], v[28:31], v[120:123], v[72:75]
    ds_read_b128 v[20:23], v3 offset:43008
    v_mfma_f32_16x16x32_bf16 v[76:79], v[28:31], v[124:127], v[76:79]
    s_add_u32 m0, s35, 131072
    s_add_u32 s41, s28, 256
    buffer_load_dwordx4 v6, s[12:15], s41 offen lds
    s_waitcnt vmcnt(6)
    s_mov_b32 m0, s46
    v_add_u32 v7, 1, v7
    ds_write_addtid_b32 v7
    s_setprio 0
    s_waitcnt lgkmcnt(6)
    v_mfma_f32_16x16x32_bf16 v[80:83], v[32:35], v[120:123], v[80:83]
    ds_read_b128 v[24:27], v3 offset:45056
    v_mfma_f32_16x16x32_bf16 v[84:87], v[32:35], v[124:127], v[84:87]
    s_waitcnt lgkmcnt(6)
    v_mfma_f32_16x16x32_bf16 v[88:91], v[36:39], v[120:123], v[88:91]
    ds_read_b128 v[28:31], v3 offset:47104
    v_mfma_f32_16x16x32_bf16 v[92:95], v[36:39], v[124:127], v[92:95]
    s_add_u32 m0, s35, 40960
    s_add_u32 s41, s28, 73984
    buffer_load_dwordx4 v6, s[12:15], s41 offen lds
    s_waitcnt lgkmcnt(6)
    v_mfma_f32_16x16x32_bf16 v[96:99], v[40:43], v[120:123], v[96:99]
    ds_read_b128 v[32:35], v3 offset:32768
    v_mfma_f32_16x16x32_bf16 v[100:103], v[40:43], v[124:127], v[100:103]
    s_waitcnt lgkmcnt(6)
    v_mfma_f32_16x16x32_bf16 v[104:107], v[44:47], v[120:123], v[104:107]
    ds_read_b128 v[36:39], v3 offset:34816
    v_mfma_f32_16x16x32_bf16 v[108:111], v[44:47], v[124:127], v[108:111]
    s_add_u32 m0, s35, 32768
    s_add_u32 s41, s28, 147712
    buffer_load_dwordx4 v6, s[12:15], s41 offen lds
    s_waitcnt lgkmcnt(6)
    v_mfma_f32_16x16x32_bf16 v[208:211], v[16:19], v[128:131], v[208:211]
    ds_read_b128 v[40:43], v3 offset:36864
    v_mfma_f32_16x16x32_bf16 v[212:215], v[16:19], v[132:135], v[212:215]
    s_add_u32 s36, s30, 12288
    buffer_load_dwordx4 v[160:163], v1, s[4:7], s36 offen sc1
    ds_read_b32 v8, v9
    s_waitcnt lgkmcnt(7)
    v_mfma_f32_16x16x32_bf16 v[216:219], v[20:23], v[128:131], v[216:219]
    ds_read_b128 v[44:47], v3 offset:38912
    v_mfma_f32_16x16x32_bf16 v[220:223], v[20:23], v[132:135], v[220:223]
    s_add_u32 s36, s31, 12288
    buffer_load_dwordx4 v[164:167], v1, s[4:7], s36 offen sc1
    s_waitcnt lgkmcnt(6)
    v_mfma_f32_16x16x32_bf16 v[224:227], v[24:27], v[128:131], v[224:227]
    ds_read_b128 v[16:19], v3 offset:24576
    v_mfma_f32_16x16x32_bf16 v[228:231], v[24:27], v[132:135], v[228:231]
    s_add_u32 m0, s35, 24576
    s_add_u32 s41, s28, 384
    buffer_load_dwordx4 v6, s[8:11], s41 offen lds
    s_waitcnt lgkmcnt(6)
    v_mfma_f32_16x16x32_bf16 v[232:235], v[28:31], v[128:131], v[232:235]
    ds_read_b128 v[20:23], v3 offset:26624
    v_mfma_f32_16x16x32_bf16 v[236:239], v[28:31], v[132:135], v[236:239]
    s_add_u32 m0, s35, 16384
    s_add_u32 s41, s28, 74112
    buffer_load_dwordx4 v6, s[8:11], s41 offen lds
    s_waitcnt lgkmcnt(3)
    v_cmp_gt_i32 vcc, v7, v8
    s_cbranch_vccnz SBs_142
SBb_143:
    s_setprio 1
    v_mfma_f32_16x16x32_bf16 v[48:51], v[32:35], v[128:131], v[48:51]
    ds_read_b128 v[24:27], v3 offset:28672
    v_mfma_f32_16x16x32_bf16 v[52:55], v[32:35], v[132:135], v[52:55]
    v_mfma_f32_16x16x32_bf16 v[56:59], v[36:39], v[128:131], v[56:59]
    ds_read_b128 v[28:31], v3 offset:30720
    v_mfma_f32_16x16x32_bf16 v[60:63], v[36:39], v[132:135], v[60:63]
    s_add_u32 m0, s35, 122880
    s_add_u32 s41, s28, 384
    buffer_load_dwordx4 v6, s[12:15], s41 offen lds
    v_mfma_f32_16x16x32_bf16 v[64:67], v[40:43], v[128:131], v[64:67]
    ds_read_b128 v[32:35], v3 offset:16384
    v_mfma_f32_16x16x32_bf16 v[68:71], v[40:43], v[132:135], v[68:71]
    s_waitcnt lgkmcnt(5)
    v_mfma_f32_16x16x32_bf16 v[72:75], v[44:47], v[128:131], v[72:75]
    ds_read_b128 v[36:39], v3 offset:18432
    v_mfma_f32_16x16x32_bf16 v[76:79], v[44:47], v[132:135], v[76:79]
    s_add_u32 m0, s35, 114688
    s_add_u32 s41, s28, 74112
    buffer_load_dwordx4 v6, s[12:15], s41 offen lds
    s_waitcnt vmcnt(9)
    s_mov_b32 m0, s46
    v_add_u32 v7, 1, v7
    ds_write_addtid_b32 v7
    s_setprio 0
    s_waitcnt lgkmcnt(6)
    v_mfma_f32_16x16x32_bf16 v[80:83], v[16:19], v[128:131], v[80:83]
    ds_read_b128 v[40:43], v3 offset:20480
    v_mfma_f32_16x16x32_bf16 v[84:87], v[16:19], v[132:135], v[84:87]
    s_waitcnt lgkmcnt(6)
    v_mfma_f32_16x16x32_bf16 v[88:91], v[20:23], v[128:131], v[88:91]
    ds_read_b128 v[44:47], v3 offset:22528
    v_mfma_f32_16x16x32_bf16 v[92:95], v[20:23], v[132:135], v[92:95]
    s_waitcnt lgkmcnt(6)
    v_mfma_f32_16x16x32_bf16 v[96:99], v[24:27], v[128:131], v[96:99]
    ds_read_b128 v[16:19], v4 offset:32768
    v_mfma_f32_16x16x32_bf16 v[100:103], v[24:27], v[132:135], v[100:103]
    s_waitcnt lgkmcnt(6)
    v_mfma_f32_16x16x32_bf16 v[104:107], v[28:31], v[128:131], v[104:107]
    ds_read_b128 v[20:23], v4 offset:34816
    v_mfma_f32_16x16x32_bf16 v[108:111], v[28:31], v[132:135], v[108:111]
    s_add_u32 m0, s35, 106496
    s_add_u32 s41, s28, 512
    buffer_load_dwordx4 v6, s[8:11], s41 offen lds
    s_waitcnt lgkmcnt(6)
    v_mfma_f32_16x16x32_bf16 v[208:211], v[32:35], v[136:139], v[208:211]
    ds_read_b128 v[24:27], v4 offset:36864
    v_mfma_f32_16x16x32_bf16 v[212:215], v[32:35], v[140:143], v[212:215]
    ds_read_b32 v8, v9
    s_waitcnt lgkmcnt(7)
    v_mfma_f32_16x16x32_bf16 v[216:219], v[36:39], v[136:139], v[216:219]
    ds_read_b128 v[28:31], v4 offset:38912
    s_add_u32 s36, s30, 14336
    buffer_load_dwordx4 v[168:171], v1, s[4:7], s36 offen sc1
    v_mfma_f32_16x16x32_bf16 v[220:223], v[36:39], v[140:143], v[220:223]
    s_waitcnt lgkmcnt(6)
    v_mfma_f32_16x16x32_bf16 v[224:227], v[40:43], v[136:139], v[224:227]
    ds_read_b128 v[32:35], v3 offset:8192
    v_mfma_f32_16x16x32_bf16 v[228:231], v[40:43], v[140:143], v[228:231]
    s_add_u32 s36, s31, 14336
    buffer_load_dwordx4 v[172:175], v1, s[4:7], s36 offen sc1
    s_waitcnt lgkmcnt(6)
    v_mfma_f32_16x16x32_bf16 v[232:235], v[44:47], v[136:139], v[232:235]
    ds_read_b128 v[36:39], v3 offset:10240
    v_mfma_f32_16x16x32_bf16 v[236:239], v[44:47], v[140:143], v[236:239]
    s_add_u32 m0, s35, 8192
    s_add_u32 s41, s28, 74240
    buffer_load_dwordx4 v6, s[8:11], s41 offen lds
    s_waitcnt lgkmcnt(3)
    v_cmp_gt_i32 vcc, v7, v8
    s_cbranch_vccnz SBs_144
SBb_145:
    s_setprio 1
    v_mfma_f32_16x16x32_bf16 v[48:51], v[16:19], v[136:139], v[48:51]
    ds_read_b128 v[40:43], v3 offset:12288
    v_mfma_f32_16x16x32_bf16 v[52:55], v[16:19], v[140:143], v[52:55]
    v_mfma_f32_16x16x32_bf16 v[56:59], v[20:23], v[136:139], v[56:59]
    ds_read_b128 v[44:47], v3 offset:14336
    v_mfma_f32_16x16x32_bf16 v[60:63], v[20:23], v[140:143], v[60:63]
    v_mfma_f32_16x16x32_bf16 v[64:67], v[24:27], v[136:139], v[64:67]
    ds_read_b128 v[16:19], v3 offset:0
    v_mfma_f32_16x16x32_bf16 v[68:71], v[24:27], v[140:143], v[68:71]
    s_waitcnt lgkmcnt(5)
    v_mfma_f32_16x16x32_bf16 v[72:75], v[28:31], v[136:139], v[72:75]
    ds_read_b128 v[20:23], v3 offset:2048
    v_mfma_f32_16x16x32_bf16 v[76:79], v[28:31], v[140:143], v[76:79]
    s_add_u32 m0, s35, 98304
    s_add_u32 s41, s28, 512
    buffer_load_dwordx4 v6, s[12:15], s41 offen lds
    s_waitcnt vmcnt(11)
    s_mov_b32 m0, s46
    v_add_u32 v7, 1, v7
    ds_write_addtid_b32 v7
    s_setprio 0
    s_waitcnt lgkmcnt(6)
    v_mfma_f32_16x16x32_bf16 v[80:83], v[32:35], v[136:139], v[80:83]
    ds_read_b128 v[24:27], v3 offset:4096
    v_mfma_f32_16x16x32_bf16 v[84:87], v[32:35], v[140:143], v[84:87]
    s_waitcnt lgkmcnt(6)
    v_mfma_f32_16x16x32_bf16 v[88:91], v[36:39], v[136:139], v[88:91]
    ds_read_b128 v[28:31], v3 offset:6144
    v_mfma_f32_16x16x32_bf16 v[92:95], v[36:39], v[140:143], v[92:95]
    s_waitcnt lgkmcnt(6)
    v_mfma_f32_16x16x32_bf16 v[96:99], v[40:43], v[136:139], v[96:99]
    ds_read_b128 v[32:35], v2 offset:49152
    v_mfma_f32_16x16x32_bf16 v[100:103], v[40:43], v[140:143], v[100:103]
    s_waitcnt lgkmcnt(6)
    v_mfma_f32_16x16x32_bf16 v[104:107], v[44:47], v[136:139], v[104:107]
    ds_read_b128 v[36:39], v2 offset:51200
    v_mfma_f32_16x16x32_bf16 v[108:111], v[44:47], v[140:143], v[108:111]
    s_add_u32 m0, s35, 90112
    s_add_u32 s41, s28, 74240
    buffer_load_dwordx4 v6, s[12:15], s41 offen lds
    s_waitcnt lgkmcnt(6)
    v_mfma_f32_16x16x32_bf16 v[208:211], v[16:19], v[144:147], v[208:211]
    ds_read_b128 v[40:43], v2 offset:53248
    v_mfma_f32_16x16x32_bf16 v[212:215], v[16:19], v[148:151], v[212:215]
    ds_read_b32 v8, v9
    s_waitcnt lgkmcnt(7)
    v_mfma_f32_16x16x32_bf16 v[216:219], v[20:23], v[144:147], v[216:219]
    ds_read_b128 v[44:47], v2 offset:55296
    s_add_u32 s36, s30, 16384
    buffer_load_dwordx4 v[176:179], v1, s[4:7], s36 offen sc1
    v_mfma_f32_16x16x32_bf16 v[220:223], v[20:23], v[148:151], v[220:223]
    s_waitcnt lgkmcnt(6)
    v_mfma_f32_16x16x32_bf16 v[224:227], v[24:27], v[144:147], v[224:227]
    ds_read_b128 v[16:19], v4 offset:24576
    v_mfma_f32_16x16x32_bf16 v[228:231], v[24:27], v[148:151], v[228:231]
    s_add_u32 s36, s31, 16384
    buffer_load_dwordx4 v[180:183], v1, s[4:7], s36 offen sc1
    s_waitcnt lgkmcnt(6)
    v_mfma_f32_16x16x32_bf16 v[232:235], v[28:31], v[144:147], v[232:235]
    ds_read_b128 v[20:23], v4 offset:26624
    v_mfma_f32_16x16x32_bf16 v[236:239], v[28:31], v[148:151], v[236:239]
    s_add_u32 m0, s35, 81920
    s_add_u32 s41, s28, 640
    buffer_load_dwordx4 v6, s[8:11], s41 offen lds
    s_waitcnt lgkmcnt(3)
    v_cmp_gt_i32 vcc, v7, v8
    s_cbranch_vccnz SBs_146
SBb_147:
    s_setprio 1
    v_mfma_f32_16x16x32_bf16 v[48:51], v[32:35], v[144:147], v[48:51]
    ds_read_b128 v[24:27], v4 offset:28672
    v_mfma_f32_16x16x32_bf16 v[52:55], v[32:35], v[148:151], v[52:55]
    v_mfma_f32_16x16x32_bf16 v[56:59], v[36:39], v[144:147], v[56:59]
    ds_read_b128 v[28:31], v4 offset:30720
    v_mfma_f32_16x16x32_bf16 v[60:63], v[36:39], v[148:151], v[60:63]
    v_mfma_f32_16x16x32_bf16 v[64:67], v[40:43], v[144:147], v[64:67]
    ds_read_b128 v[32:35], v4 offset:16384
    v_mfma_f32_16x16x32_bf16 v[68:71], v[40:43], v[148:151], v[68:71]
    s_waitcnt lgkmcnt(5)
    v_mfma_f32_16x16x32_bf16 v[72:75], v[44:47], v[144:147], v[72:75]
    ds_read_b128 v[36:39], v4 offset:18432
    v_mfma_f32_16x16x32_bf16 v[76:79], v[44:47], v[148:151], v[76:79]
    s_add_u32 m0, s35, 147456
    s_add_u32 s41, s28, 74368
    buffer_load_dwordx4 v6, s[8:11], s41 offen lds
    s_waitcnt vmcnt(11)
    s_mov_b32 m0, s46
    v_add_u32 v7, 1, v7
    ds_write_addtid_b32 v7
    s_setprio 0
    s_waitcnt lgkmcnt(6)
    v_mfma_f32_16x16x32_bf16 v[80:83], v[16:19], v[144:147], v[80:83]
    ds_read_b128 v[40:43], v4 offset:20480
    v_mfma_f32_16x16x32_bf16 v[84:87], v[16:19], v[148:151], v[84:87]
    s_waitcnt lgkmcnt(6)
    v_mfma_f32_16x16x32_bf16 v[88:91], v[20:23], v[144:147], v[88:91]
    ds_read_b128 v[44:47], v4 offset:22528
    v_mfma_f32_16x16x32_bf16 v[92:95], v[20:23], v[148:151], v[92:95]
    s_waitcnt lgkmcnt(6)
    v_mfma_f32_16x16x32_bf16 v[96:99], v[24:27], v[144:147], v[96:99]
    ds_read_b128 v[16:19], v2 offset:40960
    v_mfma_f32_16x16x32_bf16 v[100:103], v[24:27], v[148:151], v[100:103]
    s_waitcnt lgkmcnt(6)
    v_mfma_f32_16x16x32_bf16 v[104:107], v[28:31], v[144:147], v[104:107]
    ds_read_b128 v[20:23], v2 offset:43008
    v_mfma_f32_16x16x32_bf16 v[108:111], v[28:31], v[148:151], v[108:111]
    s_waitcnt lgkmcnt(6)
    v_mfma_f32_16x16x32_bf16 v[208:211], v[32:35], v[152:155], v[208:211]
    ds_read_b128 v[24:27], v2 offset:45056
    v_mfma_f32_16x16x32_bf16 v[212:215], v[32:35], v[156:159], v[212:215]
    ds_read_b32 v8, v9
    s_waitcnt lgkmcnt(7)
    v_mfma_f32_16x16x32_bf16 v[216:219], v[36:39], v[152:155], v[216:219]
    ds_read_b128 v[28:31], v2 offset:47104
    v_mfma_f32_16x16x32_bf16 v[220:223], v[36:39], v[156:159], v[220:223]
    s_add_u32 s36, s30, 18432
    buffer_load_dwordx4 v[184:187], v1, s[4:7], s36 offen sc1
    s_waitcnt lgkmcnt(6)
    v_mfma_f32_16x16x32_bf16 v[224:227], v[40:43], v[152:155], v[224:227]
    ds_read_b128 v[32:35], v2 offset:32768
    v_mfma_f32_16x16x32_bf16 v[228:231], v[40:43], v[156:159], v[228:231]
    s_waitcnt lgkmcnt(6)
    v_mfma_f32_16x16x32_bf16 v[232:235], v[44:47], v[152:155], v[232:235]
    ds_read_b128 v[36:39], v2 offset:34816
    v_mfma_f32_16x16x32_bf16 v[236:239], v[44:47], v[156:159], v[236:239]
    s_add_u32 s36, s31, 18432
    buffer_load_dwordx4 v[188:191], v1, s[4:7], s36 offen sc1
    s_waitcnt lgkmcnt(3)
    v_cmp_gt_i32 vcc, v7, v8
    s_cbranch_vccnz SBs_148
SBb_149:
    s_setprio 1
    v_mfma_f32_16x16x32_bf16 v[48:51], v[16:19], v[152:155], v[48:51]
    ds_read_b128 v[40:43], v2 offset:36864
    v_mfma_f32_16x16x32_bf16 v[52:55], v[16:19], v[156:159], v[52:55]
    v_mfma_f32_16x16x32_bf16 v[56:59], v[20:23], v[152:155], v[56:59]
    ds_read_b128 v[44:47], v2 offset:38912
    v_mfma_f32_16x16x32_bf16 v[60:63], v[20:23], v[156:159], v[60:63]
    v_mfma_f32_16x16x32_bf16 v[64:67], v[24:27], v[152:155], v[64:67]
    ds_read_b128 v[16:19], v2 offset:24576
    v_mfma_f32_16x16x32_bf16 v[68:71], v[24:27], v[156:159], v[68:71]
    s_waitcnt lgkmcnt(5)
    v_mfma_f32_16x16x32_bf16 v[72:75], v[28:31], v[152:155], v[72:75]
    ds_read_b128 v[20:23], v2 offset:26624
    v_mfma_f32_16x16x32_bf16 v[76:79], v[28:31], v[156:159], v[76:79]
    s_add_u32 m0, s35, 139264
    s_add_u32 s41, s28, 640
    buffer_load_dwordx4 v6, s[12:15], s41 offen lds
    s_waitcnt vmcnt(9)
    s_mov_b32 m0, s46
    v_add_u32 v7, 1, v7
    ds_write_addtid_b32 v7
    s_setprio 0
    s_waitcnt lgkmcnt(6)
    v_mfma_f32_16x16x32_bf16 v[80:83], v[32:35], v[152:155], v[80:83]
    ds_read_b128 v[24:27], v2 offset:28672
    v_mfma_f32_16x16x32_bf16 v[84:87], v[32:35], v[156:159], v[84:87]
    s_waitcnt lgkmcnt(6)
    v_mfma_f32_16x16x32_bf16 v[88:91], v[36:39], v[152:155], v[88:91]
    ds_read_b128 v[28:31], v2 offset:30720
    v_mfma_f32_16x16x32_bf16 v[92:95], v[36:39], v[156:159], v[92:95]
    s_waitcnt lgkmcnt(6)
    v_mfma_f32_16x16x32_bf16 v[96:99], v[40:43], v[152:155], v[96:99]
    ds_read_b128 v[32:35], v2 offset:16384
    v_mfma_f32_16x16x32_bf16 v[100:103], v[40:43], v[156:159], v[100:103]
    s_waitcnt lgkmcnt(6)
    v_mfma_f32_16x16x32_bf16 v[104:107], v[44:47], v[152:155], v[104:107]
    ds_read_b128 v[36:39], v2 offset:18432
    v_mfma_f32_16x16x32_bf16 v[108:111], v[44:47], v[156:159], v[108:111]
    s_waitcnt lgkmcnt(6)
    v_mfma_f32_16x16x32_bf16 v[208:211], v[16:19], v[160:163], v[208:211]
    ds_read_b128 v[40:43], v2 offset:20480
    v_mfma_f32_16x16x32_bf16 v[212:215], v[16:19], v[164:167], v[212:215]
    ds_read_b32 v8, v9
    s_waitcnt lgkmcnt(7)
    v_mfma_f32_16x16x32_bf16 v[216:219], v[20:23], v[160:163], v[216:219]
    ds_read_b128 v[44:47], v2 offset:22528
    v_mfma_f32_16x16x32_bf16 v[220:223], v[20:23], v[164:167], v[220:223]
    s_add_u32 s36, s30, 20480
    buffer_load_dwordx4 v[192:195], v1, s[4:7], s36 offen sc1
    s_waitcnt lgkmcnt(6)
    v_mfma_f32_16x16x32_bf16 v[224:227], v[24:27], v[160:163], v[224:227]
    ds_read_b128 v[16:19], v4 offset:8192
    v_mfma_f32_16x16x32_bf16 v[228:231], v[24:27], v[164:167], v[228:231]
    s_waitcnt lgkmcnt(6)
    v_mfma_f32_16x16x32_bf16 v[232:235], v[28:31], v[160:163], v[232:235]
    ds_read_b128 v[20:23], v4 offset:10240
    v_mfma_f32_16x16x32_bf16 v[236:239], v[28:31], v[164:167], v[236:239]
    s_add_u32 s36, s31, 20480
    buffer_load_dwordx4 v[196:199], v1, s[4:7], s36 offen sc1
    s_waitcnt lgkmcnt(3)
    v_cmp_gt_i32 vcc, v7, v8
    s_cbranch_vccnz SBs_150
SBb_151:
    s_setprio 1
    v_mfma_f32_16x16x32_bf16 v[48:51], v[32:35], v[160:163], v[48:51]
    ds_read_b128 v[24:27], v4 offset:12288
    v_mfma_f32_16x16x32_bf16 v[52:55], v[32:35], v[164:167], v[52:55]
    v_mfma_f32_16x16x32_bf16 v[56:59], v[36:39], v[160:163], v[56:59]
    ds_read_b128 v[28:31], v4 offset:14336
    v_mfma_f32_16x16x32_bf16 v[60:63], v[36:39], v[164:167], v[60:63]
    v_mfma_f32_16x16x32_bf16 v[64:67], v[40:43], v[160:163], v[64:67]
    ds_read_b128 v[32:35], v4 offset:0
    v_mfma_f32_16x16x32_bf16 v[68:71], v[40:43], v[164:167], v[68:71]
    s_waitcnt lgkmcnt(5)
    v_mfma_f32_16x16x32_bf16 v[72:75], v[44:47], v[160:163], v[72:75]
    ds_read_b128 v[36:39], v4 offset:2048
    v_mfma_f32_16x16x32_bf16 v[76:79], v[44:47], v[164:167], v[76:79]
    s_add_u32 m0, s35, 131072
    s_add_u32 s41, s28, 74368
    buffer_load_dwordx4 v6, s[12:15], s41 offen lds
    s_waitcnt vmcnt(7)
    s_mov_b32 m0, s46
    v_add_u32 v7, 1, v7
    ds_write_addtid_b32 v7
    s_setprio 0
    s_waitcnt lgkmcnt(6)
    v_mfma_f32_16x16x32_bf16 v[208:211], v[16:19], v[168:171], v[208:211]
    ds_read_b128 v[40:43], v4 offset:4096
    v_mfma_f32_16x16x32_bf16 v[212:215], v[16:19], v[172:175], v[212:215]
    s_waitcnt lgkmcnt(6)
    v_mfma_f32_16x16x32_bf16 v[216:219], v[20:23], v[168:171], v[216:219]
    ds_read_b128 v[44:47], v4 offset:6144
    v_mfma_f32_16x16x32_bf16 v[220:223], v[20:23], v[172:175], v[220:223]
    s_add_u32 s36, s30, 22528
    buffer_load_dwordx4 v[200:203], v1, s[4:7], s36 offen sc1
    s_waitcnt lgkmcnt(6)
    v_mfma_f32_16x16x32_bf16 v[224:227], v[24:27], v[168:171], v[224:227]
    ds_read_b128 v[16:19], v3 offset:49152
    v_mfma_f32_16x16x32_bf16 v[228:231], v[24:27], v[172:175], v[228:231]
    s_waitcnt lgkmcnt(6)
    v_mfma_f32_16x16x32_bf16 v[232:235], v[28:31], v[168:171], v[232:235]
    ds_read_b128 v[20:23], v3 offset:51200
    v_mfma_f32_16x16x32_bf16 v[236:239], v[28:31], v[172:175], v[236:239]
    s_add_u32 s36, s31, 22528
    buffer_load_dwordx4 v[204:207], v1, s[4:7], s36 offen sc1
    s_waitcnt lgkmcnt(6)
    v_mfma_f32_16x16x32_bf16 v[48:51], v[32:35], v[168:171], v[48:51]
    ds_read_b128 v[24:27], v3 offset:53248
    v_mfma_f32_16x16x32_bf16 v[52:55], v[32:35], v[172:175], v[52:55]
    ds_read_b32 v8, v9
    s_waitcnt lgkmcnt(7)
    v_mfma_f32_16x16x32_bf16 v[56:59], v[36:39], v[168:171], v[56:59]
    ds_read_b128 v[28:31], v3 offset:55296
    v_mfma_f32_16x16x32_bf16 v[60:63], v[36:39], v[172:175], v[60:63]
    s_waitcnt lgkmcnt(6)
    v_mfma_f32_16x16x32_bf16 v[64:67], v[40:43], v[168:171], v[64:67]
    ds_read_b128 v[32:35], v2 offset:8192
    v_mfma_f32_16x16x32_bf16 v[68:71], v[40:43], v[172:175], v[68:71]
    s_waitcnt lgkmcnt(6)
    v_mfma_f32_16x16x32_bf16 v[72:75], v[44:47], v[168:171], v[72:75]
    ds_read_b128 v[36:39], v2 offset:10240
    v_mfma_f32_16x16x32_bf16 v[76:79], v[44:47], v[172:175], v[76:79]
    s_add_u32 m0, s35, 73728
    s_add_u32 s41, s28, 768
    buffer_load_dwordx4 v6, s[8:11], s41 offen lds
    s_waitcnt lgkmcnt(3)
    v_cmp_gt_i32 vcc, v7, v8
    s_cbranch_vccnz SBs_152
SBb_153:
    s_setprio 1
    v_mfma_f32_16x16x32_bf16 v[208:211], v[16:19], v[176:179], v[208:211]
    ds_read_b128 v[40:43], v2 offset:12288
    v_mfma_f32_16x16x32_bf16 v[212:215], v[16:19], v[180:183], v[212:215]
    v_mfma_f32_16x16x32_bf16 v[216:219], v[20:23], v[176:179], v[216:219]
    ds_read_b128 v[44:47], v2 offset:14336
    s_add_u32 s36, s30, 24576
    buffer_load_dwordx4 v[112:115], v1, s[4:7], s36 offen sc1
    v_mfma_f32_16x16x32_bf16 v[220:223], v[20:23], v[180:183], v[220:223]
    v_mfma_f32_16x16x32_bf16 v[224:227], v[24:27], v[176:179], v[224:227]
    ds_read_b128 v[16:19], v3 offset:40960
    v_mfma_f32_16x16x32_bf16 v[228:231], v[24:27], v[180:183], v[228:231]
    s_add_u32 s36, s31, 24576
    buffer_load_dwordx4 v[116:119], v1, s[4:7], s36 offen sc1
    s_waitcnt lgkmcnt(5)
    v_mfma_f32_16x16x32_bf16 v[232:235], v[28:31], v[176:179], v[232:235]
    ds_read_b128 v[20:23], v3 offset:43008
    v_mfma_f32_16x16x32_bf16 v[236:239], v[28:31], v[180:183], v[236:239]
    s_add_u32 m0, s35, 122880
    s_add_u32 s41, s28, 74496
    buffer_load_dwordx4 v6, s[8:11], s41 offen lds
    s_waitcnt vmcnt(6)
    s_mov_b32 m0, s46
    v_add_u32 v7, 1, v7
    ds_write_addtid_b32 v7
    s_setprio 0
    s_waitcnt lgkmcnt(6)
    v_mfma_f32_16x16x32_bf16 v[48:51], v[32:35], v[176:179], v[48:51]
    ds_read_b128 v[24:27], v3 offset:45056
    v_mfma_f32_16x16x32_bf16 v[52:55], v[32:35], v[180:183], v[52:55]
    s_waitcnt lgkmcnt(6)
    v_mfma_f32_16x16x32_bf16 v[56:59], v[36:39], v[176:179], v[56:59]
    ds_read_b128 v[28:31], v3 offset:47104
    v_mfma_f32_16x16x32_bf16 v[60:63], v[36:39], v[180:183], v[60:63]
    s_waitcnt lgkmcnt(6)
    v_mfma_f32_16x16x32_bf16 v[64:67], v[40:43], v[176:179], v[64:67]
    ds_read_b128 v[32:35], v3 offset:32768
    v_mfma_f32_16x16x32_bf16 v[68:71], v[40:43], v[180:183], v[68:71]
    s_waitcnt lgkmcnt(6)
    v_mfma_f32_16x16x32_bf16 v[72:75], v[44:47], v[176:179], v[72:75]
    ds_read_b128 v[36:39], v3 offset:34816
    v_mfma_f32_16x16x32_bf16 v[76:79], v[44:47], v[180:183], v[76:79]
    s_add_u32 m0, s35, 65536
    s_add_u32 s41, s28, 768
    buffer_load_dwordx4 v6, s[12:15], s41 offen lds
    s_waitcnt lgkmcnt(6)
    v_mfma_f32_16x16x32_bf16 v[208:211], v[16:19], v[184:187], v[208:211]
    ds_read_b128 v[40:43], v3 offset:36864
    v_mfma_f32_16x16x32_bf16 v[212:215], v[16:19], v[188:191], v[212:215]
    ds_read_b32 v8, v9
    s_waitcnt lgkmcnt(7)
    v_mfma_f32_16x16x32_bf16 v[216:219], v[20:23], v[184:187], v[216:219]
    ds_read_b128 v[44:47], v3 offset:38912
    s_add_u32 s36, s30, 26624
    buffer_load_dwordx4 v[120:123], v1, s[4:7], s36 offen sc1
    v_mfma_f32_16x16x32_bf16 v[220:223], v[20:23], v[188:191], v[220:223]
    s_waitcnt lgkmcnt(6)
    v_mfma_f32_16x16x32_bf16 v[224:227], v[24:27], v[184:187], v[224:227]
    ds_read_b128 v[16:19], v3 offset:24576
    v_mfma_f32_16x16x32_bf16 v[228:231], v[24:27], v[188:191], v[228:231]
    s_add_u32 s36, s31, 26624
    buffer_load_dwordx4 v[124:127], v1, s[4:7], s36 offen sc1
    s_waitcnt lgkmcnt(6)
    v_mfma_f32_16x16x32_bf16 v[232:235], v[28:31], v[184:187], v[232:235]
    ds_read_b128 v[20:23], v3 offset:26624
    v_mfma_f32_16x16x32_bf16 v[236:239], v[28:31], v[188:191], v[236:239]
    s_add_u32 m0, s35, 57344
    s_add_u32 s41, s28, 74496
    buffer_load_dwordx4 v6, s[12:15], s41 offen lds
    s_waitcnt lgkmcnt(3)
    v_cmp_gt_i32 vcc, v7, v8
    s_cbranch_vccnz SBs_154
SBb_155:
    s_setprio 1
    v_mfma_f32_16x16x32_bf16 v[48:51], v[32:35], v[184:187], v[48:51]
    ds_read_b128 v[24:27], v3 offset:28672
    v_mfma_f32_16x16x32_bf16 v[52:55], v[32:35], v[188:191], v[52:55]
    v_mfma_f32_16x16x32_bf16 v[56:59], v[36:39], v[184:187], v[56:59]
    ds_read_b128 v[28:31], v3 offset:30720
    v_mfma_f32_16x16x32_bf16 v[60:63], v[36:39], v[188:191], v[60:63]
    s_add_u32 m0, s35, 114688
    s_add_u32 s41, s28, 896
    buffer_load_dwordx4 v6, s[8:11], s41 offen lds
    v_mfma_f32_16x16x32_bf16 v[64:67], v[40:43], v[184:187], v[64:67]
    ds_read_b128 v[32:35], v4 offset:32768
    v_mfma_f32_16x16x32_bf16 v[68:71], v[40:43], v[188:191], v[68:71]
    s_waitcnt lgkmcnt(5)
    v_mfma_f32_16x16x32_bf16 v[72:75], v[44:47], v[184:187], v[72:75]
    ds_read_b128 v[36:39], v4 offset:34816
    v_mfma_f32_16x16x32_bf16 v[76:79], v[44:47], v[188:191], v[76:79]
    s_add_u32 m0, s35, 106496
    s_add_u32 s41, s28, 74624
    buffer_load_dwordx4 v6, s[8:11], s41 offen lds
    s_waitcnt vmcnt(5)
    s_mov_b32 m0, s46
    v_add_u32 v7, 1, v7
    ds_write_addtid_b32 v7
    s_setprio 0
    s_waitcnt lgkmcnt(6)
    v_mfma_f32_16x16x32_bf16 v[208:211], v[16:19], v[192:195], v[208:211]
    ds_read_b128 v[40:43], v4 offset:36864
    v_mfma_f32_16x16x32_bf16 v[212:215], v[16:19], v[196:199], v[212:215]
    s_waitcnt lgkmcnt(6)
    v_mfma_f32_16x16x32_bf16 v[216:219], v[20:23], v[192:195], v[216:219]
    ds_read_b128 v[44:47], v4 offset:38912
    v_mfma_f32_16x16x32_bf16 v[220:223], v[20:23], v[196:199], v[220:223]
    s_add_u32 s36, s30, 28672
    buffer_load_dwordx4 v[128:131], v1, s[4:7], s36 offen sc1
    s_waitcnt lgkmcnt(6)
    v_mfma_f32_16x16x32_bf16 v[224:227], v[24:27], v[192:195], v[224:227]
    ds_read_b128 v[16:19], v4 offset:24576
    v_mfma_f32_16x16x32_bf16 v[228:231], v[24:27], v[196:199], v[228:231]
    s_waitcnt lgkmcnt(6)
    v_mfma_f32_16x16x32_bf16 v[232:235], v[28:31], v[192:195], v[232:235]
    ds_read_b128 v[20:23], v4 offset:26624
    v_mfma_f32_16x16x32_bf16 v[236:239], v[28:31], v[196:199], v[236:239]
    s_add_u32 s36, s31, 28672
    buffer_load_dwordx4 v[132:135], v1, s[4:7], s36 offen sc1
    s_waitcnt lgkmcnt(6)
    v_mfma_f32_16x16x32_bf16 v[48:51], v[32:35], v[192:195], v[48:51]
    ds_read_b128 v[24:27], v4 offset:28672
    v_mfma_f32_16x16x32_bf16 v[52:55], v[32:35], v[196:199], v[52:55]
    ds_read_b32 v8, v9
    s_waitcnt lgkmcnt(7)
    v_mfma_f32_16x16x32_bf16 v[56:59], v[36:39], v[192:195], v[56:59]
    ds_read_b128 v[28:31], v4 offset:30720
    v_mfma_f32_16x16x32_bf16 v[60:63], v[36:39], v[196:199], v[60:63]
    s_waitcnt lgkmcnt(6)
    v_mfma_f32_16x16x32_bf16 v[64:67], v[40:43], v[192:195], v[64:67]
    ds_read_b128 v[32:35], v4 offset:16384
    v_mfma_f32_16x16x32_bf16 v[68:71], v[40:43], v[196:199], v[68:71]
    s_waitcnt lgkmcnt(6)
    v_mfma_f32_16x16x32_bf16 v[72:75], v[44:47], v[192:195], v[72:75]
    ds_read_b128 v[36:39], v4 offset:18432
    v_mfma_f32_16x16x32_bf16 v[76:79], v[44:47], v[196:199], v[76:79]
    s_add_u32 m0, s35, 49152
    s_add_u32 s41, s28, 896
    buffer_load_dwordx4 v6, s[12:15], s41 offen lds
    s_waitcnt lgkmcnt(3)
    v_cmp_gt_i32 vcc, v7, v8
    s_cbranch_vccnz SBs_156
SBb_157:
    s_setprio 1
    v_mfma_f32_16x16x32_bf16 v[208:211], v[16:19], v[200:203], v[208:211]
    ds_read_b128 v[40:43], v4 offset:20480
    v_mfma_f32_16x16x32_bf16 v[212:215], v[16:19], v[204:207], v[212:215]
    s_add_u32 s36, s30, 30720
    buffer_load_dwordx4 v[136:139], v1, s[4:7], s36 offen sc1
    v_mfma_f32_16x16x32_bf16 v[216:219], v[20:23], v[200:203], v[216:219]
    ds_read_b128 v[44:47], v4 offset:22528
    v_mfma_f32_16x16x32_bf16 v[220:223], v[20:23], v[204:207], v[220:223]
    s_add_u32 s36, s31, 30720
    buffer_load_dwordx4 v[140:143], v1, s[4:7], s36 offen sc1
    v_mfma_f32_16x16x32_bf16 v[224:227], v[24:27], v[200:203], v[224:227]
    ds_read_b128 v[16:19], v3 offset:16384
    v_mfma_f32_16x16x32_bf16 v[228:231], v[24:27], v[204:207], v[228:231]
    s_add_u32 m0, s35, 98304
    s_add_u32 s41, s28, 74624
    buffer_load_dwordx4 v6, s[12:15], s41 offen lds
    s_waitcnt lgkmcnt(5)
    v_mfma_f32_16x16x32_bf16 v[232:235], v[28:31], v[200:203], v[232:235]
    ds_read_b128 v[20:23], v3 offset:18432
    v_mfma_f32_16x16x32_bf16 v[236:239], v[28:31], v[204:207], v[236:239]
    s_add_u32 m0, s35, 90112
    s_add_u32 s41, s28, 1024
    buffer_load_dwordx4 v6, s[8:11], s41 offen lds
    s_waitcnt vmcnt(7)
    s_mov_b32 m0, s46
    v_add_u32 v7, 1, v7
    ds_write_addtid_b32 v7
    s_setprio 0
    s_waitcnt lgkmcnt(6)
    v_mfma_f32_16x16x32_bf16 v[48:51], v[32:35], v[200:203], v[48:51]
    ds_read_b128 v[24:27], v3 offset:20480
    v_mfma_f32_16x16x32_bf16 v[52:55], v[32:35], v[204:207], v[52:55]
    s_waitcnt lgkmcnt(6)
    v_mfma_f32_16x16x32_bf16 v[56:59], v[36:39], v[200:203], v[56:59]
    ds_read_b128 v[28:31], v3 offset:22528
    v_mfma_f32_16x16x32_bf16 v[60:63], v[36:39], v[204:207], v[60:63]
    s_add_u32 m0, s35, 0
    s_add_u32 s41, s28, 74752
    buffer_load_dwordx4 v6, s[8:11], s41 offen lds
    s_waitcnt lgkmcnt(6)
    v_mfma_f32_16x16x32_bf16 v[64:67], v[40:43], v[200:203], v[64:67]
    ds_read_b128 v[32:35], v4 offset:8192
    v_mfma_f32_16x16x32_bf16 v[68:71], v[40:43], v[204:207], v[68:71]
    s_waitcnt lgkmcnt(6)
    v_mfma_f32_16x16x32_bf16 v[72:75], v[44:47], v[200:203], v[72:75]
    ds_read_b128 v[36:39], v4 offset:10240
    v_mfma_f32_16x16x32_bf16 v[76:79], v[44:47], v[204:207], v[76:79]
    s_add_u32 m0, s35, 8192
    s_add_u32 s41, s28, 1024
    buffer_load_dwordx4 v6, s[12:15], s41 offen lds
    s_waitcnt lgkmcnt(6)
    v_mfma_f32_16x16x32_bf16 v[208:211], v[16:19], v[112:115], v[208:211]
    ds_read_b128 v[40:43], v4 offset:12288
    v_mfma_f32_16x16x32_bf16 v[212:215], v[16:19], v[116:119], v[212:215]
    s_add_u32 s36, s30, 32768
    buffer_load_dwordx4 v[144:147], v1, s[4:7], s36 offen sc1
    ds_read_b32 v8, v9
    s_waitcnt lgkmcnt(7)
    v_mfma_f32_16x16x32_bf16 v[216:219], v[20:23], v[112:115], v[216:219]
    ds_read_b128 v[44:47], v4 offset:14336
    v_mfma_f32_16x16x32_bf16 v[220:223], v[20:23], v[116:119], v[220:223]
    s_add_u32 s36, s31, 32768
    buffer_load_dwordx4 v[148:151], v1, s[4:7], s36 offen sc1
    s_waitcnt lgkmcnt(6)
    v_mfma_f32_16x16x32_bf16 v[224:227], v[24:27], v[112:115], v[224:227]
    ds_read_b128 v[16:19], v3 offset:8192
    v_mfma_f32_16x16x32_bf16 v[228:231], v[24:27], v[116:119], v[228:231]
    s_add_u32 m0, s35, 16384
    s_add_u32 s41, s28, 74752
    buffer_load_dwordx4 v6, s[12:15], s41 offen lds
    s_waitcnt lgkmcnt(6)
    v_mfma_f32_16x16x32_bf16 v[232:235], v[28:31], v[112:115], v[232:235]
    ds_read_b128 v[20:23], v3 offset:10240
    v_mfma_f32_16x16x32_bf16 v[236:239], v[28:31], v[116:119], v[236:239]
    s_add_u32 m0, s35, 24576
    s_add_u32 s41, s28, 147840
    buffer_load_dwordx4 v6, s[8:11], s41 offen lds
    s_waitcnt lgkmcnt(3)
    v_cmp_gt_i32 vcc, v7, v8
    s_cbranch_vccnz SBs_158
SBb_159:
    s_setprio 1
    v_mfma_f32_16x16x32_bf16 v[48:51], v[32:35], v[112:115], v[48:51]
    ds_read_b128 v[24:27], v3 offset:12288
    v_mfma_f32_16x16x32_bf16 v[52:55], v[32:35], v[116:119], v[52:55]
    v_mfma_f32_16x16x32_bf16 v[56:59], v[36:39], v[112:115], v[56:59]
    ds_read_b128 v[28:31], v3 offset:14336
    v_mfma_f32_16x16x32_bf16 v[60:63], v[36:39], v[116:119], v[60:63]
    s_add_u32 m0, s35, 32768
    s_add_u32 s41, s28, 147840
    buffer_load_dwordx4 v6, s[12:15], s41 offen lds
    v_mfma_f32_16x16x32_bf16 v[64:67], v[40:43], v[112:115], v[64:67]
    ds_read_b128 v[32:35], v3 offset:0
    v_mfma_f32_16x16x32_bf16 v[68:71], v[40:43], v[116:119], v[68:71]
    s_waitcnt lgkmcnt(5)
    v_mfma_f32_16x16x32_bf16 v[72:75], v[44:47], v[112:115], v[72:75]
    ds_read_b128 v[36:39], v3 offset:2048
    v_mfma_f32_16x16x32_bf16 v[76:79], v[44:47], v[116:119], v[76:79]
    s_add_u32 m0, s35, 40960
    s_add_u32 s41, s28, 147968
    buffer_load_dwordx4 v6, s[8:11], s41 offen lds
    s_waitcnt vmcnt(8)
    s_mov_b32 m0, s46
    v_add_u32 v7, 1, v7
    ds_write_addtid_b32 v7
    s_setprio 0
    s_waitcnt lgkmcnt(6)
    v_mfma_f32_16x16x32_bf16 v[208:211], v[16:19], v[120:123], v[208:211]
    ds_read_b128 v[40:43], v3 offset:4096
    v_mfma_f32_16x16x32_bf16 v[212:215], v[16:19], v[124:127], v[212:215]
    s_waitcnt lgkmcnt(6)
    v_mfma_f32_16x16x32_bf16 v[216:219], v[20:23], v[120:123], v[216:219]
    ds_read_b128 v[44:47], v3 offset:6144
    s_add_u32 s36, s30, 34816
    buffer_load_dwordx4 v[152:155], v1, s[4:7], s36 offen sc1
    v_mfma_f32_16x16x32_bf16 v[220:223], v[20:23], v[124:127], v[220:223]
    s_waitcnt lgkmcnt(6)
    v_mfma_f32_16x16x32_bf16 v[224:227], v[24:27], v[120:123], v[224:227]
    ds_read_b128 v[16:19], v4 offset:0
    v_mfma_f32_16x16x32_bf16 v[228:231], v[24:27], v[124:127], v[228:231]
    s_add_u32 s36, s31, 34816
    buffer_load_dwordx4 v[156:159], v1, s[4:7], s36 offen sc1
    s_waitcnt lgkmcnt(6)
    v_mfma_f32_16x16x32_bf16 v[232:235], v[28:31], v[120:123], v[232:235]
    ds_read_b128 v[20:23], v4 offset:2048
    v_mfma_f32_16x16x32_bf16 v[236:239], v[28:31], v[124:127], v[236:239]
    s_add_u32 m0, s35, 81920
    s_add_u32 s41, s28, 147968
    buffer_load_dwordx4 v6, s[12:15], s41 offen lds
    s_waitcnt lgkmcnt(6)
    v_mfma_f32_16x16x32_bf16 v[48:51], v[32:35], v[120:123], v[48:51]
    ds_read_b128 v[24:27], v4 offset:4096
    v_mfma_f32_16x16x32_bf16 v[52:55], v[32:35], v[124:127], v[52:55]
    ds_read_b32 v8, v9
    s_waitcnt lgkmcnt(7)
    v_mfma_f32_16x16x32_bf16 v[56:59], v[36:39], v[120:123], v[56:59]
    ds_read_b128 v[28:31], v4 offset:6144
    v_mfma_f32_16x16x32_bf16 v[60:63], v[36:39], v[124:127], v[60:63]
    s_waitcnt lgkmcnt(6)
    v_mfma_f32_16x16x32_bf16 v[64:67], v[40:43], v[120:123], v[64:67]
    ds_read_b128 v[32:35], v3 offset:49152
    v_mfma_f32_16x16x32_bf16 v[68:71], v[40:43], v[124:127], v[68:71]
    s_waitcnt lgkmcnt(6)
    v_mfma_f32_16x16x32_bf16 v[72:75], v[44:47], v[120:123], v[72:75]
    ds_read_b128 v[36:39], v3 offset:51200
    v_mfma_f32_16x16x32_bf16 v[76:79], v[44:47], v[124:127], v[76:79]
    s_waitcnt lgkmcnt(3)
    v_cmp_gt_i32 vcc, v7, v8
    s_cbranch_vccnz SBs_160
SBb_161:
    s_setprio 1
    v_mfma_f32_16x16x32_bf16 v[208:211], v[16:19], v[128:131], v[208:211]
    ds_read_b128 v[40:43], v3 offset:53248
    v_mfma_f32_16x16x32_bf16 v[212:215], v[16:19], v[132:135], v[212:215]
    v_mfma_f32_16x16x32_bf16 v[216:219], v[20:23], v[128:131], v[216:219]
    ds_read_b128 v[44:47], v3 offset:55296
    v_mfma_f32_16x16x32_bf16 v[220:223], v[20:23], v[132:135], v[220:223]
    s_add_u32 m0, s35, 65536
    s_add_u32 s41, s28, 148096
    buffer_load_dwordx4 v6, s[8:11], s41 offen lds
    v_mfma_f32_16x16x32_bf16 v[224:227], v[24:27], v[128:131], v[224:227]
    ds_read_b128 v[16:19], v2 offset:49152
    v_mfma_f32_16x16x32_bf16 v[228:231], v[24:27], v[132:135], v[228:231]
    s_waitcnt lgkmcnt(5)
    v_mfma_f32_16x16x32_bf16 v[232:235], v[28:31], v[128:131], v[232:235]
    ds_read_b128 v[20:23], v2 offset:51200
    v_mfma_f32_16x16x32_bf16 v[236:239], v[28:31], v[132:135], v[236:239]
    s_add_u32 m0, s35, 73728
    s_add_u32 s41, s28, 148096
    buffer_load_dwordx4 v6, s[12:15], s41 offen lds
    s_waitcnt vmcnt(8)
    s_mov_b32 m0, s46
    v_add_u32 v7, 1, v7
    ds_write_addtid_b32 v7
    s_setprio 0
    s_waitcnt lgkmcnt(6)
    v_mfma_f32_16x16x32_bf16 v[48:51], v[32:35], v[128:131], v[48:51]
    ds_read_b128 v[24:27], v2 offset:53248
    v_mfma_f32_16x16x32_bf16 v[52:55], v[32:35], v[132:135], v[52:55]
    s_waitcnt lgkmcnt(6)
    v_mfma_f32_16x16x32_bf16 v[56:59], v[36:39], v[128:131], v[56:59]
    ds_read_b128 v[28:31], v2 offset:55296
    v_mfma_f32_16x16x32_bf16 v[60:63], v[36:39], v[132:135], v[60:63]
    s_waitcnt lgkmcnt(6)
    v_mfma_f32_16x16x32_bf16 v[64:67], v[40:43], v[128:131], v[64:67]
    ds_read_b128 v[32:35], v3 offset:40960
    v_mfma_f32_16x16x32_bf16 v[68:71], v[40:43], v[132:135], v[68:71]
    s_waitcnt lgkmcnt(6)
    v_mfma_f32_16x16x32_bf16 v[72:75], v[44:47], v[128:131], v[72:75]
    ds_read_b128 v[36:39], v3 offset:43008
    v_mfma_f32_16x16x32_bf16 v[76:79], v[44:47], v[132:135], v[76:79]
    s_waitcnt lgkmcnt(6)
    v_mfma_f32_16x16x32_bf16 v[208:211], v[16:19], v[136:139], v[208:211]
    ds_read_b128 v[40:43], v3 offset:45056
    v_mfma_f32_16x16x32_bf16 v[212:215], v[16:19], v[140:143], v[212:215]
    ds_read_b32 v8, v9
    s_waitcnt lgkmcnt(7)
    v_mfma_f32_16x16x32_bf16 v[216:219], v[20:23], v[136:139], v[216:219]
    ds_read_b128 v[44:47], v3 offset:47104
    v_mfma_f32_16x16x32_bf16 v[220:223], v[20:23], v[140:143], v[220:223]
    s_waitcnt lgkmcnt(6)
    v_mfma_f32_16x16x32_bf16 v[224:227], v[24:27], v[136:139], v[224:227]
    ds_read_b128 v[16:19], v3 offset:32768
    v_mfma_f32_16x16x32_bf16 v[228:231], v[24:27], v[140:143], v[228:231]
    s_waitcnt lgkmcnt(6)
    v_mfma_f32_16x16x32_bf16 v[232:235], v[28:31], v[136:139], v[232:235]
    ds_read_b128 v[20:23], v3 offset:34816
    v_mfma_f32_16x16x32_bf16 v[236:239], v[28:31], v[140:143], v[236:239]
    s_waitcnt lgkmcnt(3)
    v_cmp_gt_i32 vcc, v7, v8
    s_cbranch_vccnz SBs_162
SBb_163:
    s_setprio 1
    v_mfma_f32_16x16x32_bf16 v[48:51], v[32:35], v[136:139], v[48:51]
    ds_read_b128 v[24:27], v3 offset:36864
    v_mfma_f32_16x16x32_bf16 v[52:55], v[32:35], v[140:143], v[52:55]
    v_mfma_f32_16x16x32_bf16 v[56:59], v[36:39], v[136:139], v[56:59]
    ds_read_b128 v[28:31], v3 offset:38912
    v_mfma_f32_16x16x32_bf16 v[60:63], v[36:39], v[140:143], v[60:63]
    v_mfma_f32_16x16x32_bf16 v[64:67], v[40:43], v[136:139], v[64:67]
    ds_read_b128 v[32:35], v2 offset:0
    v_mfma_f32_16x16x32_bf16 v[68:71], v[40:43], v[140:143], v[68:71]
    s_waitcnt lgkmcnt(5)
    v_mfma_f32_16x16x32_bf16 v[72:75], v[44:47], v[136:139], v[72:75]
    ds_read_b128 v[36:39], v2 offset:2048
    v_mfma_f32_16x16x32_bf16 v[76:79], v[44:47], v[140:143], v[76:79]
    s_add_u32 m0, s35, 57344
    s_add_u32 s41, s28, 148224
    buffer_load_dwordx4 v6, s[8:11], s41 offen lds
    s_waitcnt vmcnt(2)
    s_mov_b32 m0, s46
    v_add_u32 v7, 1, v7
    ds_write_addtid_b32 v7
    s_setprio 0
    s_waitcnt lgkmcnt(6)
    v_mfma_f32_16x16x32_bf16 v[208:211], v[16:19], v[144:147], v[208:211]
    ds_read_b128 v[40:43], v2 offset:4096
    v_mfma_f32_16x16x32_bf16 v[212:215], v[16:19], v[148:151], v[212:215]
    s_waitcnt lgkmcnt(6)
    v_mfma_f32_16x16x32_bf16 v[216:219], v[20:23], v[144:147], v[216:219]
    ds_read_b128 v[44:47], v2 offset:6144
    v_mfma_f32_16x16x32_bf16 v[220:223], v[20:23], v[148:151], v[220:223]
    s_waitcnt lgkmcnt(6)
    v_mfma_f32_16x16x32_bf16 v[224:227], v[24:27], v[144:147], v[224:227]
    ds_read_b128 v[16:19], v2 offset:8192
    v_mfma_f32_16x16x32_bf16 v[228:231], v[24:27], v[148:151], v[228:231]
    s_waitcnt lgkmcnt(6)
    v_mfma_f32_16x16x32_bf16 v[232:235], v[28:31], v[144:147], v[232:235]
    ds_read_b128 v[20:23], v2 offset:10240
    v_mfma_f32_16x16x32_bf16 v[236:239], v[28:31], v[148:151], v[236:239]
    s_waitcnt lgkmcnt(6)
    v_mfma_f32_16x16x32_bf16 v[48:51], v[32:35], v[144:147], v[48:51]
    ds_read_b128 v[24:27], v2 offset:12288
    v_mfma_f32_16x16x32_bf16 v[52:55], v[32:35], v[148:151], v[52:55]
    ds_read_b32 v8, v9
    s_waitcnt lgkmcnt(7)
    v_mfma_f32_16x16x32_bf16 v[56:59], v[36:39], v[144:147], v[56:59]
    ds_read_b128 v[28:31], v2 offset:14336
    v_mfma_f32_16x16x32_bf16 v[60:63], v[36:39], v[148:151], v[60:63]
    s_waitcnt lgkmcnt(6)
    v_mfma_f32_16x16x32_bf16 v[64:67], v[40:43], v[144:147], v[64:67]
    ds_read_b128 v[32:35], v2 offset:16384
    v_mfma_f32_16x16x32_bf16 v[68:71], v[40:43], v[148:151], v[68:71]
    s_waitcnt lgkmcnt(6)
    v_mfma_f32_16x16x32_bf16 v[72:75], v[44:47], v[144:147], v[72:75]
    ds_read_b128 v[36:39], v2 offset:18432
    v_mfma_f32_16x16x32_bf16 v[76:79], v[44:47], v[148:151], v[76:79]
    s_waitcnt lgkmcnt(3)
    v_cmp_gt_i32 vcc, v7, v8
    s_cbranch_vccnz SBs_164
SBb_165:
    s_setprio 1
    v_mfma_f32_16x16x32_bf16 v[208:211], v[16:19], v[152:155], v[208:211]
    ds_read_b128 v[40:43], v2 offset:20480
    v_mfma_f32_16x16x32_bf16 v[212:215], v[16:19], v[156:159], v[212:215]
    v_mfma_f32_16x16x32_bf16 v[216:219], v[20:23], v[152:155], v[216:219]
    ds_read_b128 v[44:47], v2 offset:22528
    v_mfma_f32_16x16x32_bf16 v[220:223], v[20:23], v[156:159], v[220:223]
    v_mfma_f32_16x16x32_bf16 v[224:227], v[24:27], v[152:155], v[224:227]
    ds_read_b128 v[16:19], v2 offset:24576
    v_mfma_f32_16x16x32_bf16 v[228:231], v[24:27], v[156:159], v[228:231]
    s_waitcnt lgkmcnt(5)
    v_mfma_f32_16x16x32_bf16 v[232:235], v[28:31], v[152:155], v[232:235]
    ds_read_b128 v[20:23], v2 offset:26624
    v_mfma_f32_16x16x32_bf16 v[236:239], v[28:31], v[156:159], v[236:239]
    s_add_u32 m0, s35, 49152
    s_add_u32 s41, s28, 148224
    buffer_load_dwordx4 v6, s[12:15], s41 offen lds
    s_waitcnt lgkmcnt(5)
    v_mfma_f32_16x16x32_bf16 v[48:51], v[32:35], v[152:155], v[48:51]
    ds_read_b128 v[24:27], v2 offset:28672
    v_mfma_f32_16x16x32_bf16 v[52:55], v[32:35], v[156:159], v[52:55]
    s_waitcnt lgkmcnt(5)
    v_mfma_f32_16x16x32_bf16 v[56:59], v[36:39], v[152:155], v[56:59]
    ds_read_b128 v[28:31], v2 offset:30720
    v_mfma_f32_16x16x32_bf16 v[60:63], v[36:39], v[156:159], v[60:63]
    s_waitcnt lgkmcnt(5)
    v_mfma_f32_16x16x32_bf16 v[64:67], v[40:43], v[152:155], v[64:67]
    ds_read_b128 v[32:35], v2 offset:32768
    v_mfma_f32_16x16x32_bf16 v[68:71], v[40:43], v[156:159], v[68:71]
    s_waitcnt lgkmcnt(5)
    v_mfma_f32_16x16x32_bf16 v[72:75], v[44:47], v[152:155], v[72:75]
    ds_read_b128 v[36:39], v2 offset:34816
    v_mfma_f32_16x16x32_bf16 v[76:79], v[44:47], v[156:159], v[76:79]
    s_cmp_eq_u32 s42, 1
    s_cbranch_scc1 K2_ssm_h1
    s_waitcnt vmcnt(2)
    s_mov_b32 m0, s46
    v_add_u32 v7, 1, v7
    ds_write_addtid_b32 v7
    s_setprio 0
    s_waitcnt lgkmcnt(6)
    v_mfma_f32_16x16x32_bf16 v[80:83], v[16:19], v[160:163], v[80:83]
    ds_read_b128 v[40:43], v2 offset:36864
    v_mfma_f32_16x16x32_bf16 v[84:87], v[16:19], v[164:167], v[84:87]
    ds_read_b32 v8, v9
    s_waitcnt lgkmcnt(7)
    v_mfma_f32_16x16x32_bf16 v[88:91], v[20:23], v[160:163], v[88:91]
    ds_read_b128 v[44:47], v2 offset:38912
    v_mfma_f32_16x16x32_bf16 v[92:95], v[20:23], v[164:167], v[92:95]
    ds_write_b128 v11, v[48:51] offset:0
    s_waitcnt lgkmcnt(8)
    v_mfma_f32_16x16x32_bf16 v[96:99], v[24:27], v[160:163], v[96:99]
    ds_read_b128 v[16:19], v2 offset:40960
    v_mfma_f32_16x16x32_bf16 v[100:103], v[24:27], v[164:167], v[100:103]
    ds_write_b128 v11, v[52:55] offset:1024
    s_waitcnt lgkmcnt(9)
    v_mfma_f32_16x16x32_bf16 v[104:107], v[28:31], v[160:163], v[104:107]
    ds_read_b128 v[20:23], v2 offset:43008
    ds_write_b128 v11, v[56:59] offset:2048
    v_mfma_f32_16x16x32_bf16 v[108:111], v[28:31], v[164:167], v[108:111]
    ds_write_b128 v11, v[60:63] offset:3072
    s_waitcnt lgkmcnt(7)
    v_cmp_gt_i32 vcc, v7, v8
    s_cbranch_vccnz SBs_166
SBb_167:
    s_setprio 1
    v_mfma_f32_16x16x32_bf16 v[80:83], v[32:35], v[168:171], v[80:83]
    ds_read_b128 v[24:27], v2 offset:45056
    v_mfma_f32_16x16x32_bf16 v[84:87], v[32:35], v[172:175], v[84:87]
    s_add_u32 m0, s35, 0
    s_add_u32 s41, s28, 148352
    buffer_load_dwordx4 v6, s[8:11], s41 offen lds
    v_mfma_f32_16x16x32_bf16 v[88:91], v[36:39], v[168:171], v[88:91]
    ds_read_b128 v[28:31], v2 offset:47104
    s_add_u32 m0, s35, 8192
    s_add_u32 s41, s28, 148352
    buffer_load_dwordx4 v6, s[12:15], s41 offen lds
    v_mfma_f32_16x16x32_bf16 v[92:95], v[36:39], v[172:175], v[92:95]
    ds_write_b128 v11, v[64:67] offset:4096
    v_mfma_f32_16x16x32_bf16 v[96:99], v[40:43], v[168:171], v[96:99]
    ds_read_b128 v[32:35], v3 offset:24576
    v_mfma_f32_16x16x32_bf16 v[100:103], v[40:43], v[172:175], v[100:103]
    ds_write_b128 v11, v[68:71] offset:5120
    s_waitcnt lgkmcnt(11)
    v_mfma_f32_16x16x32_bf16 v[104:107], v[44:47], v[168:171], v[104:107]
    ds_read_b128 v[36:39], v3 offset:26624
    ds_write_b128 v11, v[72:75] offset:6144
    v_mfma_f32_16x16x32_bf16 v[108:111], v[44:47], v[172:175], v[108:111]
    ds_write_b128 v11, v[76:79] offset:7168
    s_waitcnt vmcnt(1)
    s_mov_b32 m0, s46
    v_add_u32 v7, 1, v7
    ds_write_addtid_b32 v7
    s_setprio 0
    s_waitcnt lgkmcnt(13)
    v_mfma_f32_16x16x32_bf16 v[80:83], v[16:19], v[176:179], v[80:83]
    ds_read_b128 v[40:43], v3 offset:28672
    s_add_u32 m0, s35, 16384
    s_add_u32 s41, s28, 148480
    buffer_load_dwordx4 v6, s[8:11], s41 offen lds
    v_mfma_f32_16x16x32_bf16 v[84:87], v[16:19], v[180:183], v[84:87]
    s_add_u32 m0, s35, 24576
    s_add_u32 s41, s28, 148480
    buffer_load_dwordx4 v6, s[12:15], s41 offen lds
    ds_read_b32 v8, v9
    s_waitcnt lgkmcnt(13)
    v_mfma_f32_16x16x32_bf16 v[88:91], v[20:23], v[176:179], v[88:91]
    ds_read_b128 v[44:47], v3 offset:30720
    v_mov_b32 v160, 0
    v_mov_b32 v161, 0
    v_mfma_f32_16x16x32_bf16 v[92:95], v[20:23], v[180:183], v[92:95]
    v_mov_b32 v162, 0
    v_mov_b32 v163, 0
    v_mov_b32 v164, 0
    v_mov_b32 v165, 0
    s_waitcnt lgkmcnt(11)
    v_mfma_f32_16x16x32_bf16 v[96:99], v[24:27], v[176:179], v[96:99]
    ds_read_b128 v[16:19], v3 offset:8192
    v_mov_b32 v166, 0
    v_mov_b32 v167, 0
    v_mfma_f32_16x16x32_bf16 v[100:103], v[24:27], v[180:183], v[100:103]
    v_mov_b32 v168, 0
    v_mov_b32 v169, 0
    s_waitcnt lgkmcnt(11)
    v_mfma_f32_16x16x32_bf16 v[104:107], v[28:31], v[176:179], v[104:107]
    ds_read_b128 v[20:23], v3 offset:10240
    v_mov_b32 v170, 0
    v_mov_b32 v171, 0
    v_mfma_f32_16x16x32_bf16 v[108:111], v[28:31], v[180:183], v[108:111]
    v_mov_b32 v172, 0
    v_mov_b32 v173, 0
    v_mov_b32 v174, 0
    v_mov_b32 v175, 0
    s_waitcnt lgkmcnt(3)
    v_cmp_gt_i32 vcc, v7, v8
    s_cbranch_vccnz SBs_168
SBb_169:
    s_setprio 1
    v_mfma_f32_16x16x32_bf16 v[80:83], v[32:35], v[184:187], v[80:83]
    ds_read_b128 v[24:27], v3 offset:12288
    ds_read_b128 v[48:51], v12 offset:0
    v_mfma_f32_16x16x32_bf16 v[84:87], v[32:35], v[188:191], v[84:87]
    ds_read_b128 v[52:55], v12 offset:1024
    v_mfma_f32_16x16x32_bf16 v[88:91], v[36:39], v[184:187], v[88:91]
    ds_read_b128 v[28:31], v3 offset:14336
    ds_read_b128 v[56:59], v12 offset:2048
    v_mfma_f32_16x16x32_bf16 v[92:95], v[36:39], v[188:191], v[92:95]
    ds_read_b128 v[60:63], v12 offset:3072
    v_mfma_f32_16x16x32_bf16 v[96:99], v[40:43], v[184:187], v[96:99]
    ds_read_b128 v[32:35], v3 offset:16384
    ds_read_b128 v[64:67], v12 offset:4096
    v_mfma_f32_16x16x32_bf16 v[100:103], v[40:43], v[188:191], v[100:103]
    ds_read_b128 v[68:71], v12 offset:5120
    s_waitcnt lgkmcnt(11)
    v_mfma_f32_16x16x32_bf16 v[104:107], v[44:47], v[184:187], v[104:107]
    ds_read_b128 v[36:39], v3 offset:18432
    ds_read_b128 v[72:75], v12 offset:6144
    v_mfma_f32_16x16x32_bf16 v[108:111], v[44:47], v[188:191], v[108:111]
    ds_read_b128 v[76:79], v12 offset:7168
    s_load_dwordx2 s[52:53], s[0:1], 104
    s_load_dwordx2 s[28:29], s[0:1], 0
    s_load_dwordx2 s[30:31], s[0:1], 64
    s_waitcnt lgkmcnt(13)
    v_mfma_f32_16x16x32_bf16 v[80:83], v[16:19], v[192:195], v[80:83]
    ds_read_b128 v[40:43], v3 offset:20480
    s_waitcnt lgkmcnt(11)
    v_add_f32 v208, v208, v48
    v_add_f32 v209, v209, v49
    v_mfma_f32_16x16x32_bf16 v[84:87], v[16:19], v[196:199], v[84:87]
    v_add_f32 v210, v210, v50
    v_add_f32 v211, v211, v51
    v_mfma_f32_16x16x32_bf16 v[88:91], v[20:23], v[192:195], v[88:91]
    ds_read_b128 v[44:47], v3 offset:22528
    s_waitcnt lgkmcnt(11)
    v_add_f32 v212, v212, v52
    v_add_f32 v213, v213, v53
    v_mfma_f32_16x16x32_bf16 v[92:95], v[20:23], v[196:199], v[92:95]
    v_add_f32 v214, v214, v54
    v_add_f32 v215, v215, v55
    v_mfma_f32_16x16x32_bf16 v[96:99], v[24:27], v[192:195], v[96:99]
    ds_read_b128 v[16:19], v3 offset:0
    s_waitcnt lgkmcnt(10)
    v_add_f32 v216, v216, v56
    v_add_f32 v217, v217, v57
    v_mfma_f32_16x16x32_bf16 v[100:103], v[24:27], v[196:199], v[100:103]
    v_add_f32 v218, v218, v58
    v_add_f32 v219, v219, v59
    v_mfma_f32_16x16x32_bf16 v[104:107], v[28:31], v[192:195], v[104:107]
    ds_read_b128 v[20:23], v3 offset:2048
    s_waitcnt lgkmcnt(10)
    v_add_f32 v220, v220, v60
    v_add_f32 v221, v221, v61
    v_mfma_f32_16x16x32_bf16 v[108:111], v[28:31], v[196:199], v[108:111]
    v_add_f32 v222, v222, v62
    v_add_f32 v223, v223, v63
    s_waitcnt vmcnt(0)
    s_mov_b32 m0, s46
    v_add_u32 v7, 1, v7
    ds_write_addtid_b32 v7
    s_setprio 0
    s_waitcnt lgkmcnt(10)
    v_mfma_f32_16x16x32_bf16 v[80:83], v[32:35], v[200:203], v[80:83]
    ds_read_b128 v[24:27], v3 offset:4096
    v_mfma_f32_16x16x32_bf16 v[84:87], v[32:35], v[204:207], v[84:87]
    v_cvt_pk_bf16_f32 v48, v208, v209
    v_cvt_pk_bf16_f32 v49, v210, v211
    s_waitcnt lgkmcnt(8)
    v_mfma_f32_16x16x32_bf16 v[88:91], v[36:39], v[200:203], v[88:91]
    ds_read_b128 v[28:31], v3 offset:6144
    v_cvt_pk_bf16_f32 v50, v216, v217
    v_cvt_pk_bf16_f32 v51, v218, v219
    v_mfma_f32_16x16x32_bf16 v[92:95], v[36:39], v[204:207], v[92:95]
    s_cmp_eq_u32 s49, 0
    s_cselect_b32 s44, 0x7ff00000, s54
    buffer_store_dwordx4 v[48:51], v1, s[4:7], s44 offen offset:0 sc1
    s_cbranch_scc0 K2_nx_170
    v_add_f32 v160, v160, v208
    v_add_f32 v161, v161, v209
    v_add_f32 v162, v162, v210
    v_add_f32 v163, v163, v211
    v_add_f32 v164, v164, v216
    v_add_f32 v165, v165, v217
    v_add_f32 v166, v166, v218
    v_add_f32 v167, v167, v219
K2_nx_170:
    s_waitcnt lgkmcnt(6)
    v_mfma_f32_16x16x32_bf16 v[96:99], v[40:43], v[200:203], v[96:99]
    ds_read_b128 v[32:35], v2 offset:49152
    v_mfma_f32_16x16x32_bf16 v[100:103], v[40:43], v[204:207], v[100:103]
    v_cvt_pk_bf16_f32 v52, v212, v213
    v_cvt_pk_bf16_f32 v53, v214, v215
    s_waitcnt lgkmcnt(6)
    v_mfma_f32_16x16x32_bf16 v[104:107], v[44:47], v[200:203], v[104:107]
    ds_read_b128 v[36:39], v2 offset:51200
    v_cvt_pk_bf16_f32 v54, v220, v221
    v_cvt_pk_bf16_f32 v55, v222, v223
    v_mfma_f32_16x16x32_bf16 v[108:111], v[44:47], v[204:207], v[108:111]
    s_cmp_eq_u32 s49, 1
    s_cselect_b32 s44, 0x7ff00000, s54
    buffer_store_dwordx4 v[52:55], v1, s[4:7], s44 offen offset:1024 sc1
    s_cbranch_scc0 K2_nx_171
    v_add_f32 v160, v160, v212
    v_add_f32 v161, v161, v213
    v_add_f32 v162, v162, v214
    v_add_f32 v163, v163, v215
    v_add_f32 v164, v164, v220
    v_add_f32 v165, v165, v221
    v_add_f32 v166, v166, v222
    v_add_f32 v167, v167, v223
K2_nx_171:
    s_waitcnt lgkmcnt(6)
    v_mfma_f32_16x16x32_bf16 v[80:83], v[16:19], v[112:115], v[80:83]
    ds_read_b128 v[40:43], v2 offset:53248
    v_add_f32 v224, v224, v64
    v_add_f32 v225, v225, v65
    v_add_f32 v226, v226, v66
    v_add_f32 v227, v227, v67
    v_add_f32 v228, v228, v68
    v_add_f32 v229, v229, v69
    v_mfma_f32_16x16x32_bf16 v[84:87], v[16:19], v[116:119], v[84:87]
    v_add_f32 v230, v230, v70
    v_add_f32 v231, v231, v71
    v_add_f32 v232, v232, v72
    v_add_f32 v233, v233, v73
    v_add_f32 v234, v234, v74
    v_add_f32 v235, v235, v75
    ds_read_b32 v8, v9
    s_waitcnt lgkmcnt(7)
    v_mfma_f32_16x16x32_bf16 v[88:91], v[20:23], v[112:115], v[88:91]
    ds_read_b128 v[44:47], v2 offset:55296
    v_add_f32 v236, v236, v76
    v_add_f32 v237, v237, v77
    v_add_f32 v238, v238, v78
    v_add_f32 v239, v239, v79
    v_lshrrev_b32 v176, 1, v10
    v_mfma_f32_16x16x32_bf16 v[92:95], v[20:23], v[116:119], v[92:95]
    v_lshrrev_b32 v179, 4, v0
    v_lshlrev_b32 v177, 3, v179
    v_lshrrev_b32 v178, 1, v179
    v_lshlrev_b32 v178, 8, v178
    s_waitcnt lgkmcnt(6)
    v_mfma_f32_16x16x32_bf16 v[96:99], v[24:27], v[112:115], v[96:99]
    ds_read_b128 v[16:19], v2 offset:0
    v_and_b32 v180, 15, v0
    v_lshl_add_u32 v178, v180, 4, v178
    v_and_b32 v180, 1, v179
    v_mfma_f32_16x16x32_bf16 v[100:103], v[24:27], v[116:119], v[100:103]
    v_lshl_add_u32 v178, v180, 3, v178
    s_mul_i32 s32, s99, 6
    s_lshl_b32 s33, s42, 1
    s_waitcnt lgkmcnt(6)
    v_mfma_f32_16x16x32_bf16 v[104:107], v[28:31], v[112:115], v[104:107]
    ds_read_b128 v[20:23], v2 offset:2048
    s_add_u32 s34, s32, s33
    s_lshr_b32 s33, s49, 1
    s_add_u32 s34, s34, s33
    v_mfma_f32_16x16x32_bf16 v[108:111], v[28:31], v[116:119], v[108:111]
    s_add_u32 s35, s32, s42
    s_add_u32 s35, s35, 4
    s_lshl_b32 s32, s98, 2
    s_and_b32 s33, s16, 3
    s_waitcnt lgkmcnt(3)
    v_cmp_gt_i32 vcc, v7, v8
    s_cbranch_vccnz SBs_172
SBb_173:
    s_setprio 1
    v_mfma_f32_16x16x32_bf16 v[80:83], v[32:35], v[120:123], v[80:83]
    ds_read_b128 v[24:27], v2 offset:4096
    v_cvt_pk_bf16_f32 v64, v224, v225
    v_cvt_pk_bf16_f32 v65, v226, v227
    v_cvt_pk_bf16_f32 v66, v232, v233
    v_cvt_pk_bf16_f32 v67, v234, v235
    v_mfma_f32_16x16x32_bf16 v[84:87], v[32:35], v[124:127], v[84:87]
    s_cmp_eq_u32 s49, 2
    s_cselect_b32 s44, 0x7ff00000, s54
    buffer_store_dwordx4 v[64:67], v1, s[4:7], s44 offen offset:2048 sc1
    s_cbranch_scc0 K2_nx_174
    v_add_f32 v160, v160, v224
    v_add_f32 v161, v161, v225
    v_add_f32 v162, v162, v226
    v_add_f32 v163, v163, v227
    v_add_f32 v164, v164, v232
    v_add_f32 v165, v165, v233
    v_add_f32 v166, v166, v234
    v_add_f32 v167, v167, v235
K2_nx_174:
    v_cvt_pk_bf16_f32 v68, v228, v229
    v_cvt_pk_bf16_f32 v69, v230, v231
    v_cvt_pk_bf16_f32 v70, v236, v237
    v_cvt_pk_bf16_f32 v71, v238, v239
    v_mfma_f32_16x16x32_bf16 v[88:91], v[36:39], v[120:123], v[88:91]
    ds_read_b128 v[28:31], v2 offset:6144
    s_cmp_eq_u32 s49, 3
    s_cselect_b32 s44, 0x7ff00000, s55
    buffer_store_dwordx4 v[68:71], v1, s[4:7], s44 offen offset:0 sc1
    s_cbranch_scc0 K2_nx_175
    v_add_f32 v160, v160, v228
    v_add_f32 v161, v161, v229
    v_add_f32 v162, v162, v230
    v_add_f32 v163, v163, v231
    v_add_f32 v164, v164, v236
    v_add_f32 v165, v165, v237
    v_add_f32 v166, v166, v238
    v_add_f32 v167, v167, v239
K2_nx_175:
    s_add_u32 s32, s32, s33
    s_mul_i32 s32, s32, 36
    v_mfma_f32_16x16x32_bf16 v[92:95], v[36:39], v[124:127], v[92:95]
    s_and_b32 s33, s49, 1
    s_mul_i32 s33, s33, 18
    s_add_u32 s36, s32, s33
    v_mfma_f32_16x16x32_bf16 v[96:99], v[40:43], v[120:123], v[96:99]
    ds_read_b128 v[32:35], v2 offset:8192
    s_add_u32 s36, s36, s34
    s_lshl_b32 s36, s36, 10
    s_cmp_eq_u32 s49, 0
    s_cselect_b32 s33, 18, 0
    v_mfma_f32_16x16x32_bf16 v[100:103], v[40:43], v[124:127], v[100:103]
    s_add_u32 s37, s32, s33
    s_add_u32 s37, s37, s35
    s_lshl_b32 s37, s37, 10
    s_waitcnt lgkmcnt(5)
    v_mfma_f32_16x16x32_bf16 v[104:107], v[44:47], v[120:123], v[104:107]
    ds_read_b128 v[36:39], v2 offset:10240
    s_lshl_b32 s34, s34, 6
    s_lshl_b32 s35, s35, 6
    s_lshr_b32 s38, s60, 1
    v_mfma_f32_16x16x32_bf16 v[108:111], v[44:47], v[124:127], v[108:111]
    s_lshr_b32 s39, s61, 1
    s_cmp_eq_u32 s49, 4
    s_cselect_b32 s36, 0x7ff00000, s36
    s_and_b32 s33, s49, 3
    s_cselect_b32 s37, 0x7ff00000, s37
    s_waitcnt lgkmcnt(5)
    v_mfma_f32_16x16x32_bf16 v[80:83], v[16:19], v[128:131], v[80:83]
    ds_read_b128 v[40:43], v2 offset:12288
    v_mfma_f32_16x16x32_bf16 v[84:87], v[16:19], v[132:135], v[84:87]
    s_waitcnt lgkmcnt(0)
    s_mov_b32 s8, s52
    s_mov_b32 s9, s53
    s_mov_b32 s10, 4718592
    s_mov_b32 s11, 0x20000
    s_mov_b32 s12, s28
    s_mov_b32 s13, s29
    s_mov_b32 s14, 2359296
    s_mov_b32 s15, 0x20000
    s_mov_b32 s20, s30
    s_mov_b32 s21, s31
    s_mov_b32 s22, 1152
    s_mov_b32 s23, 0x20000
    v_mfma_f32_16x16x32_bf16 v[88:91], v[20:23], v[128:131], v[88:91]
    ds_read_b128 v[44:47], v2 offset:14336
    buffer_load_dwordx2 v[184:185], v176, s[12:15], s38 offen offset:0
    v_mfma_f32_16x16x32_bf16 v[92:95], v[20:23], v[132:135], v[92:95]
    buffer_load_dwordx2 v[186:187], v178, s[4:7], s36 offen offset:0 sc1
    v_mfma_f32_16x16x32_bf16 v[96:99], v[24:27], v[128:131], v[96:99]
    ds_read_b128 v[16:19], v2 offset:16384
    buffer_load_dwordx2 v[188:189], v177, s[20:23], s34 offen offset:0
    v_mfma_f32_16x16x32_bf16 v[100:103], v[24:27], v[132:135], v[100:103]
    buffer_load_dwordx2 v[190:191], v176, s[12:15], s38 offen offset:32
    v_mfma_f32_16x16x32_bf16 v[104:107], v[28:31], v[128:131], v[104:107]
    ds_read_b128 v[20:23], v2 offset:18432
    buffer_load_dwordx2 v[192:193], v178, s[4:7], s36 offen offset:512 sc1
    v_mfma_f32_16x16x32_bf16 v[108:111], v[28:31], v[132:135], v[108:111]
    buffer_load_dwordx2 v[194:195], v177, s[20:23], s34 offen offset:32
    v_mfma_f32_16x16x32_bf16 v[80:83], v[32:35], v[136:139], v[80:83]
    ds_read_b128 v[24:27], v2 offset:20480
    v_mfma_f32_16x16x32_bf16 v[84:87], v[32:35], v[140:143], v[84:87]
    buffer_load_dwordx2 v[196:197], v176, s[12:15], s39 offen offset:0
    v_mfma_f32_16x16x32_bf16 v[88:91], v[36:39], v[136:139], v[88:91]
    ds_read_b128 v[28:31], v2 offset:22528
    buffer_load_dwordx2 v[198:199], v178, s[4:7], s37 offen offset:0 sc1
    v_mfma_f32_16x16x32_bf16 v[92:95], v[36:39], v[140:143], v[92:95]
    buffer_load_dwordx2 v[200:201], v177, s[20:23], s35 offen offset:0
    v_mfma_f32_16x16x32_bf16 v[96:99], v[40:43], v[136:139], v[96:99]
    ds_read_b128 v[32:35], v2 offset:24576
    v_mfma_f32_16x16x32_bf16 v[100:103], v[40:43], v[140:143], v[100:103]
    buffer_load_dwordx2 v[202:203], v176, s[12:15], s39 offen offset:32
    s_waitcnt lgkmcnt(5)
    v_mfma_f32_16x16x32_bf16 v[104:107], v[44:47], v[136:139], v[104:107]
    ds_read_b128 v[36:39], v2 offset:26624
    buffer_load_dwordx2 v[204:205], v178, s[4:7], s37 offen offset:512 sc1
    v_mfma_f32_16x16x32_bf16 v[108:111], v[44:47], v[140:143], v[108:111]
    buffer_load_dwordx2 v[206:207], v177, s[20:23], s35 offen offset:32
    s_waitcnt lgkmcnt(5)
    v_mfma_f32_16x16x32_bf16 v[80:83], v[16:19], v[144:147], v[80:83]
    ds_read_b128 v[40:43], v2 offset:28672
    v_mfma_f32_16x16x32_bf16 v[84:87], v[16:19], v[148:151], v[84:87]
    s_waitcnt lgkmcnt(5)
    v_mfma_f32_16x16x32_bf16 v[88:91], v[20:23], v[144:147], v[88:91]
    ds_read_b128 v[44:47], v2 offset:30720
    v_mfma_f32_16x16x32_bf16 v[92:95], v[20:23], v[148:151], v[92:95]
    s_waitcnt lgkmcnt(5)
    v_mfma_f32_16x16x32_bf16 v[96:99], v[24:27], v[144:147], v[96:99]
    v_mfma_f32_16x16x32_bf16 v[100:103], v[24:27], v[148:151], v[100:103]
    s_waitcnt lgkmcnt(4)
    v_mfma_f32_16x16x32_bf16 v[104:107], v[28:31], v[144:147], v[104:107]
    v_mfma_f32_16x16x32_bf16 v[108:111], v[28:31], v[148:151], v[108:111]
    s_waitcnt lgkmcnt(3)
    v_mfma_f32_16x16x32_bf16 v[80:83], v[32:35], v[152:155], v[80:83]
    v_mfma_f32_16x16x32_bf16 v[84:87], v[32:35], v[156:159], v[84:87]
    s_waitcnt lgkmcnt(2)
    v_mfma_f32_16x16x32_bf16 v[88:91], v[36:39], v[152:155], v[88:91]
    v_mfma_f32_16x16x32_bf16 v[92:95], v[36:39], v[156:159], v[92:95]
    s_waitcnt lgkmcnt(1)
    v_mfma_f32_16x16x32_bf16 v[96:99], v[40:43], v[152:155], v[96:99]
    v_mfma_f32_16x16x32_bf16 v[100:103], v[40:43], v[156:159], v[100:103]
    s_waitcnt lgkmcnt(0)
    v_mfma_f32_16x16x32_bf16 v[104:107], v[44:47], v[152:155], v[104:107]
    v_mfma_f32_16x16x32_bf16 v[108:111], v[44:47], v[156:159], v[108:111]
    s_nop 7
    ds_write_b128 v11, v[96:99] offset:0
    ds_write_b128 v11, v[100:103] offset:1024
    ds_write_b128 v11, v[104:107] offset:2048
    ds_write_b128 v11, v[108:111] offset:3072
    s_waitcnt lgkmcnt(0)
    s_barrier
    ds_read_b128 v[96:99], v12 offset:0
    ds_read_b128 v[100:103], v12 offset:1024
    ds_read_b128 v[104:107], v12 offset:2048
    ds_read_b128 v[108:111], v12 offset:3072
    s_waitcnt lgkmcnt(3)
    v_add_f32 v80, v80, v96
    v_add_f32 v81, v81, v97
    v_add_f32 v82, v82, v98
    v_add_f32 v83, v83, v99
    s_waitcnt lgkmcnt(2)
    v_add_f32 v84, v84, v100
    v_add_f32 v85, v85, v101
    v_add_f32 v86, v86, v102
    v_add_f32 v87, v87, v103
    s_waitcnt lgkmcnt(1)
    v_add_f32 v88, v88, v104
    v_add_f32 v89, v89, v105
    v_add_f32 v90, v90, v106
    v_add_f32 v91, v91, v107
    s_waitcnt lgkmcnt(0)
    v_add_f32 v92, v92, v108
    v_add_f32 v93, v93, v109
    v_add_f32 v94, v94, v110
    v_add_f32 v95, v95, v111
    v_cvt_pk_bf16_f32 v96, v80, v81
    v_cvt_pk_bf16_f32 v97, v82, v83
    v_cvt_pk_bf16_f32 v98, v88, v89
    v_cvt_pk_bf16_f32 v99, v90, v91
    s_cmp_eq_u32 s49, 4
    s_cselect_b32 s44, 0x7ff00000, s55
    buffer_store_dwordx4 v[96:99], v1, s[4:7], s44 offen offset:1024 sc1
    s_cbranch_scc0 K2_nx_176
    v_add_f32 v168, v168, v80
    v_add_f32 v169, v169, v81
    v_add_f32 v170, v170, v82
    v_add_f32 v171, v171, v83
    v_add_f32 v172, v172, v88
    v_add_f32 v173, v173, v89
    v_add_f32 v174, v174, v90
    v_add_f32 v175, v175, v91
K2_nx_176:
    v_cvt_pk_bf16_f32 v100, v84, v85
    v_cvt_pk_bf16_f32 v101, v86, v87
    v_cvt_pk_bf16_f32 v102, v92, v93
    v_cvt_pk_bf16_f32 v103, v94, v95
    s_cmp_eq_u32 s49, 0
    s_cselect_b32 s44, 0x7ff00000, s55
    buffer_store_dwordx4 v[100:103], v1, s[4:7], s44 offen offset:2048 sc1
    s_cbranch_scc0 K2_nx_177
    v_add_f32 v168, v168, v84
    v_add_f32 v169, v169, v85
    v_add_f32 v170, v170, v86
    v_add_f32 v171, v171, v87
    v_add_f32 v172, v172, v92
    v_add_f32 v173, v173, v93
    v_add_f32 v174, v174, v94
    v_add_f32 v175, v175, v95
K2_nx_177:
    s_branch K2_fin
K2_ssm_h1:
    s_waitcnt vmcnt(2)
    s_mov_b32 m0, s46
    v_add_u32 v7, 1, v7
    ds_write_addtid_b32 v7
    s_setprio 0
    s_waitcnt lgkmcnt(6)
    v_mfma_f32_16x16x32_bf16 v[80:83], v[16:19], v[160:163], v[80:83]
    ds_read_b128 v[40:43], v2 offset:36864
    v_mfma_f32_16x16x32_bf16 v[84:87], v[16:19], v[164:167], v[84:87]
    ds_read_b32 v8, v9
    s_waitcnt lgkmcnt(7)
    v_mfma_f32_16x16x32_bf16 v[88:91], v[20:23], v[160:163], v[88:91]
    ds_read_b128 v[44:47], v2 offset:38912
    v_mfma_f32_16x16x32_bf16 v[92:95], v[20:23], v[164:167], v[92:95]
    ds_write_b128 v11, v[208:211] offset:0
    s_waitcnt lgkmcnt(8)
    v_mfma_f32_16x16x32_bf16 v[96:99], v[24:27], v[160:163], v[96:99]
    ds_read_b128 v[16:19], v2 offset:40960
    v_mfma_f32_16x16x32_bf16 v[100:103], v[24:27], v[164:167], v[100:103]
    ds_write_b128 v11, v[212:215] offset:1024
    s_waitcnt lgkmcnt(9)
    v_mfma_f32_16x16x32_bf16 v[104:107], v[28:31], v[160:163], v[104:107]
    ds_read_b128 v[20:23], v2 offset:43008
    ds_write_b128 v11, v[216:219] offset:2048
    v_mfma_f32_16x16x32_bf16 v[108:111], v[28:31], v[164:167], v[108:111]
    ds_write_b128 v11, v[220:223] offset:3072
    s_waitcnt lgkmcnt(7)
    v_cmp_gt_i32 vcc, v7, v8
    s_cbranch_vccnz SBs_178
SBb_179:
    s_setprio 1
    v_mfma_f32_16x16x32_bf16 v[80:83], v[32:35], v[168:171], v[80:83]
    ds_read_b128 v[24:27], v2 offset:45056
    v_mfma_f32_16x16x32_bf16 v[84:87], v[32:35], v[172:175], v[84:87]
    s_add_u32 m0, s35, 0
    s_add_u32 s41, s28, 148352
    buffer_load_dwordx4 v6, s[8:11], s41 offen lds
    v_mfma_f32_16x16x32_bf16 v[88:91], v[36:39], v[168:171], v[88:91]
    ds_read_b128 v[28:31], v2 offset:47104
    s_add_u32 m0, s35, 8192
    s_add_u32 s41, s28, 148352
    buffer_load_dwordx4 v6, s[12:15], s41 offen lds
    v_mfma_f32_16x16x32_bf16 v[92:95], v[36:39], v[172:175], v[92:95]
    ds_write_b128 v11, v[224:227] offset:4096
    v_mfma_f32_16x16x32_bf16 v[96:99], v[40:43], v[168:171], v[96:99]
    ds_read_b128 v[32:35], v3 offset:24576
    v_mfma_f32_16x16x32_bf16 v[100:103], v[40:43], v[172:175], v[100:103]
    ds_write_b128 v11, v[228:231] offset:5120
    s_waitcnt lgkmcnt(11)
    v_mfma_f32_16x16x32_bf16 v[104:107], v[44:47], v[168:171], v[104:107]
    ds_read_b128 v[36:39], v3 offset:26624
    ds_write_b128 v11, v[232:235] offset:6144
    v_mfma_f32_16x16x32_bf16 v[108:111], v[44:47], v[172:175], v[108:111]
    ds_write_b128 v11, v[236:239] offset:7168
    s_waitcnt vmcnt(1)
    s_mov_b32 m0, s46
    v_add_u32 v7, 1, v7
    ds_write_addtid_b32 v7
    s_setprio 0
    s_waitcnt lgkmcnt(13)
    v_mfma_f32_16x16x32_bf16 v[80:83], v[16:19], v[176:179], v[80:83]
    ds_read_b128 v[40:43], v3 offset:28672
    s_add_u32 m0, s35, 16384
    s_add_u32 s41, s28, 148480
    buffer_load_dwordx4 v6, s[8:11], s41 offen lds
    v_mfma_f32_16x16x32_bf16 v[84:87], v[16:19], v[180:183], v[84:87]
    s_add_u32 m0, s35, 24576
    s_add_u32 s41, s28, 148480
    buffer_load_dwordx4 v6, s[12:15], s41 offen lds
    ds_read_b32 v8, v9
    s_waitcnt lgkmcnt(13)
    v_mfma_f32_16x16x32_bf16 v[88:91], v[20:23], v[176:179], v[88:91]
    ds_read_b128 v[44:47], v3 offset:30720
    v_mov_b32 v160, 0
    v_mov_b32 v161, 0
    v_mfma_f32_16x16x32_bf16 v[92:95], v[20:23], v[180:183], v[92:95]
    v_mov_b32 v162, 0
    v_mov_b32 v163, 0
    v_mov_b32 v164, 0
    v_mov_b32 v165, 0
    s_waitcnt lgkmcnt(11)
    v_mfma_f32_16x16x32_bf16 v[96:99], v[24:27], v[176:179], v[96:99]
    ds_read_b128 v[16:19], v3 offset:8192
    v_mov_b32 v166, 0
    v_mov_b32 v167, 0
    v_mfma_f32_16x16x32_bf16 v[100:103], v[24:27], v[180:183], v[100:103]
    v_mov_b32 v168, 0
    v_mov_b32 v169, 0
    s_waitcnt lgkmcnt(11)
    v_mfma_f32_16x16x32_bf16 v[104:107], v[28:31], v[176:179], v[104:107]
    ds_read_b128 v[20:23], v3 offset:10240
    v_mov_b32 v170, 0
    v_mov_b32 v171, 0
    v_mfma_f32_16x16x32_bf16 v[108:111], v[28:31], v[180:183], v[108:111]
    v_mov_b32 v172, 0
    v_mov_b32 v173, 0
    v_mov_b32 v174, 0
    v_mov_b32 v175, 0
    s_waitcnt lgkmcnt(3)
    v_cmp_gt_i32 vcc, v7, v8
    s_cbranch_vccnz SBs_180
SBb_181:
    s_setprio 1
    v_mfma_f32_16x16x32_bf16 v[80:83], v[32:35], v[184:187], v[80:83]
    ds_read_b128 v[24:27], v3 offset:12288
    ds_read_b128 v[208:211], v12 offset:0
    v_mfma_f32_16x16x32_bf16 v[84:87], v[32:35], v[188:191], v[84:87]
    ds_read_b128 v[212:215], v12 offset:1024
    v_mfma_f32_16x16x32_bf16 v[88:91], v[36:39], v[184:187], v[88:91]
    ds_read_b128 v[28:31], v3 offset:14336
    ds_read_b128 v[216:219], v12 offset:2048
    v_mfma_f32_16x16x32_bf16 v[92:95], v[36:39], v[188:191], v[92:95]
    ds_read_b128 v[220:223], v12 offset:3072
    v_mfma_f32_16x16x32_bf16 v[96:99], v[40:43], v[184:187], v[96:99]
    ds_read_b128 v[32:35], v3 offset:16384
    ds_read_b128 v[224:227], v12 offset:4096
    v_mfma_f32_16x16x32_bf16 v[100:103], v[40:43], v[188:191], v[100:103]
    ds_read_b128 v[228:231], v12 offset:5120
    s_waitcnt lgkmcnt(11)
    v_mfma_f32_16x16x32_bf16 v[104:107], v[44:47], v[184:187], v[104:107]
    ds_read_b128 v[36:39], v3 offset:18432
    ds_read_b128 v[232:235], v12 offset:6144
    v_mfma_f32_16x16x32_bf16 v[108:111], v[44:47], v[188:191], v[108:111]
    ds_read_b128 v[236:239], v12 offset:7168
    s_load_dwordx2 s[52:53], s[0:1], 104
    s_load_dwordx2 s[28:29], s[0:1], 0
    s_load_dwordx2 s[30:31], s[0:1], 64
    s_waitcnt lgkmcnt(13)
    v_mfma_f32_16x16x32_bf16 v[80:83], v[16:19], v[192:195], v[80:83]
    ds_read_b128 v[40:43], v3 offset:20480
    s_waitcnt lgkmcnt(11)
    v_add_f32 v48, v48, v208
    v_add_f32 v49, v49, v209
    v_mfma_f32_16x16x32_bf16 v[84:87], v[16:19], v[196:199], v[84:87]
    v_add_f32 v50, v50, v210
    v_add_f32 v51, v51, v211
    v_mfma_f32_16x16x32_bf16 v[88:91], v[20:23], v[192:195], v[88:91]
    ds_read_b128 v[44:47], v3 offset:22528
    s_waitcnt lgkmcnt(11)
    v_add_f32 v52, v52, v212
    v_add_f32 v53, v53, v213
    v_mfma_f32_16x16x32_bf16 v[92:95], v[20:23], v[196:199], v[92:95]
    v_add_f32 v54, v54, v214
    v_add_f32 v55, v55, v215
    v_mfma_f32_16x16x32_bf16 v[96:99], v[24:27], v[192:195], v[96:99]
    ds_read_b128 v[16:19], v3 offset:0
    s_waitcnt lgkmcnt(10)
    v_add_f32 v56, v56, v216
    v_add_f32 v57, v57, v217
    v_mfma_f32_16x16x32_bf16 v[100:103], v[24:27], v[196:199], v[100:103]
    v_add_f32 v58, v58, v218
    v_add_f32 v59, v59, v219
    v_mfma_f32_16x16x32_bf16 v[104:107], v[28:31], v[192:195], v[104:107]
    ds_read_b128 v[20:23], v3 offset:2048
    s_waitcnt lgkmcnt(10)
    v_add_f32 v60, v60, v220
    v_add_f32 v61, v61, v221
    v_mfma_f32_16x16x32_bf16 v[108:111], v[28:31], v[196:199], v[108:111]
    v_add_f32 v62, v62, v222
    v_add_f32 v63, v63, v223
    s_waitcnt vmcnt(0)
    s_mov_b32 m0, s46
    v_add_u32 v7, 1, v7
    ds_write_addtid_b32 v7
    s_setprio 0
    s_waitcnt lgkmcnt(10)
    v_mfma_f32_16x16x32_bf16 v[80:83], v[32:35], v[200:203], v[80:83]
    ds_read_b128 v[24:27], v3 offset:4096
    v_mfma_f32_16x16x32_bf16 v[84:87], v[32:35], v[204:207], v[84:87]
    v_cvt_pk_bf16_f32 v208, v48, v49
    v_cvt_pk_bf16_f32 v209, v50, v51
    s_waitcnt lgkmcnt(8)
    v_mfma_f32_16x16x32_bf16 v[88:91], v[36:39], v[200:203], v[88:91]
    ds_read_b128 v[28:31], v3 offset:6144
    v_cvt_pk_bf16_f32 v210, v56, v57
    v_cvt_pk_bf16_f32 v211, v58, v59
    v_mfma_f32_16x16x32_bf16 v[92:95], v[36:39], v[204:207], v[92:95]
    s_cmp_eq_u32 s49, 0
    s_cselect_b32 s44, 0x7ff00000, s54
    buffer_store_dwordx4 v[208:211], v1, s[4:7], s44 offen offset:0 sc1
    s_cbranch_scc0 K2_nx_182
    v_add_f32 v160, v160, v48
    v_add_f32 v161, v161, v49
    v_add_f32 v162, v162, v50
    v_add_f32 v163, v163, v51
    v_add_f32 v164, v164, v56
    v_add_f32 v165, v165, v57
    v_add_f32 v166, v166, v58
    v_add_f32 v167, v167, v59
K2_nx_182:
    s_waitcnt lgkmcnt(6)
    v_mfma_f32_16x16x32_bf16 v[96:99], v[40:43], v[200:203], v[96:99]
    ds_read_b128 v[32:35], v2 offset:49152
    v_mfma_f32_16x16x32_bf16 v[100:103], v[40:43], v[204:207], v[100:103]
    v_cvt_pk_bf16_f32 v212, v52, v53
    v_cvt_pk_bf16_f32 v213, v54, v55
    s_waitcnt lgkmcnt(6)
    v_mfma_f32_16x16x32_bf16 v[104:107], v[44:47], v[200:203], v[104:107]
    ds_read_b128 v[36:39], v2 offset:51200
    v_cvt_pk_bf16_f32 v214, v60, v61
    v_cvt_pk_bf16_f32 v215, v62, v63
    v_mfma_f32_16x16x32_bf16 v[108:111], v[44:47], v[204:207], v[108:111]
    s_cmp_eq_u32 s49, 1
    s_cselect_b32 s44, 0x7ff00000, s54
    buffer_store_dwordx4 v[212:215], v1, s[4:7], s44 offen offset:1024 sc1
    s_cbranch_scc0 K2_nx_183
    v_add_f32 v160, v160, v52
    v_add_f32 v161, v161, v53
    v_add_f32 v162, v162, v54
    v_add_f32 v163, v163, v55
    v_add_f32 v164, v164, v60
    v_add_f32 v165, v165, v61
    v_add_f32 v166, v166, v62
    v_add_f32 v167, v167, v63
K2_nx_183:
    s_waitcnt lgkmcnt(6)
    v_mfma_f32_16x16x32_bf16 v[80:83], v[16:19], v[112:115], v[80:83]
    ds_read_b128 v[40:43], v2 offset:53248
    v_add_f32 v64, v64, v224
    v_add_f32 v65, v65, v225
    v_add_f32 v66, v66, v226
    v_add_f32 v67, v67, v227
    v_add_f32 v68, v68, v228
    v_add_f32 v69, v69, v229
    v_mfma_f32_16x16x32_bf16 v[84:87], v[16:19], v[116:119], v[84:87]
    v_add_f32 v70, v70, v230
    v_add_f32 v71, v71, v231
    v_add_f32 v72, v72, v232
    v_add_f32 v73, v73, v233
    v_add_f32 v74, v74, v234
    v_add_f32 v75, v75, v235
    ds_read_b32 v8, v9
    s_waitcnt lgkmcnt(7)
    v_mfma_f32_16x16x32_bf16 v[88:91], v[20:23], v[112:115], v[88:91]
    ds_read_b128 v[44:47], v2 offset:55296
    v_add_f32 v76, v76, v236
    v_add_f32 v77, v77, v237
    v_add_f32 v78, v78, v238
    v_add_f32 v79, v79, v239
    v_lshrrev_b32 v176, 1, v10
    v_mfma_f32_16x16x32_bf16 v[92:95], v[20:23], v[116:119], v[92:95]
    v_lshrrev_b32 v179, 4, v0
    v_lshlrev_b32 v177, 3, v179
    v_lshrrev_b32 v178, 1, v179
    v_lshlrev_b32 v178, 8, v178
    s_waitcnt lgkmcnt(6)
    v_mfma_f32_16x16x32_bf16 v[96:99], v[24:27], v[112:115], v[96:99]
    ds_read_b128 v[16:19], v2 offset:0
    v_and_b32 v180, 15, v0
    v_lshl_add_u32 v178, v180, 4, v178
    v_and_b32 v180, 1, v179
    v_mfma_f32_16x16x32_bf16 v[100:103], v[24:27], v[116:119], v[100:103]
    v_lshl_add_u32 v178, v180, 3, v178
    s_mul_i32 s32, s99, 6
    s_lshl_b32 s33, s42, 1
    s_waitcnt lgkmcnt(6)
    v_mfma_f32_16x16x32_bf16 v[104:107], v[28:31], v[112:115], v[104:107]
    ds_read_b128 v[20:23], v2 offset:2048
    s_add_u32 s34, s32, s33
    s_lshr_b32 s33, s49, 1
    s_add_u32 s34, s34, s33
    v_mfma_f32_16x16x32_bf16 v[108:111], v[28:31], v[116:119], v[108:111]
    s_add_u32 s35, s32, s42
    s_add_u32 s35, s35, 4
    s_lshl_b32 s32, s98, 2
    s_and_b32 s33, s16, 3
    s_waitcnt lgkmcnt(3)
    v_cmp_gt_i32 vcc, v7, v8
    s_cbranch_vccnz SBs_184
SBb_185:
    s_setprio 1
    v_mfma_f32_16x16x32_bf16 v[80:83], v[32:35], v[120:123], v[80:83]
    ds_read_b128 v[24:27], v2 offset:4096
    v_cvt_pk_bf16_f32 v224, v64, v65
    v_cvt_pk_bf16_f32 v225, v66, v67
    v_cvt_pk_bf16_f32 v226, v72, v73
    v_cvt_pk_bf16_f32 v227, v74, v75
    v_mfma_f32_16x16x32_bf16 v[84:87], v[32:35], v[124:127], v[84:87]
    s_cmp_eq_u32 s49, 2
    s_cselect_b32 s44, 0x7ff00000, s54
    buffer_store_dwordx4 v[224:227], v1, s[4:7], s44 offen offset:2048 sc1
    s_cbranch_scc0 K2_nx_186
    v_add_f32 v160, v160, v64
    v_add_f32 v161, v161, v65
    v_add_f32 v162, v162, v66
    v_add_f32 v163, v163, v67
    v_add_f32 v164, v164, v72
    v_add_f32 v165, v165, v73
    v_add_f32 v166, v166, v74
    v_add_f32 v167, v167, v75
K2_nx_186:
    v_cvt_pk_bf16_f32 v228, v68, v69
    v_cvt_pk_bf16_f32 v229, v70, v71
    v_cvt_pk_bf16_f32 v230, v76, v77
    v_cvt_pk_bf16_f32 v231, v78, v79
    v_mfma_f32_16x16x32_bf16 v[88:91], v[36:39], v[120:123], v[88:91]
    ds_read_b128 v[28:31], v2 offset:6144
    s_cmp_eq_u32 s49, 3
    s_cselect_b32 s44, 0x7ff00000, s55
    buffer_store_dwordx4 v[228:231], v1, s[4:7], s44 offen offset:0 sc1
    s_cbranch_scc0 K2_nx_187
    v_add_f32 v160, v160, v68
    v_add_f32 v161, v161, v69
    v_add_f32 v162, v162, v70
    v_add_f32 v163, v163, v71
    v_add_f32 v164, v164, v76
    v_add_f32 v165, v165, v77
    v_add_f32 v166, v166, v78
    v_add_f32 v167, v167, v79
K2_nx_187:
    s_add_u32 s32, s32, s33
    s_mul_i32 s32, s32, 36
    v_mfma_f32_16x16x32_bf16 v[92:95], v[36:39], v[124:127], v[92:95]
    s_and_b32 s33, s49, 1
    s_mul_i32 s33, s33, 18
    s_add_u32 s36, s32, s33
    v_mfma_f32_16x16x32_bf16 v[96:99], v[40:43], v[120:123], v[96:99]
    ds_read_b128 v[32:35], v2 offset:8192
    s_add_u32 s36, s36, s34
    s_lshl_b32 s36, s36, 10
    s_cmp_eq_u32 s49, 0
    s_cselect_b32 s33, 18, 0
    v_mfma_f32_16x16x32_bf16 v[100:103], v[40:43], v[124:127], v[100:103]
    s_add_u32 s37, s32, s33
    s_add_u32 s37, s37, s35
    s_lshl_b32 s37, s37, 10
    s_waitcnt lgkmcnt(5)
    v_mfma_f32_16x16x32_bf16 v[104:107], v[44:47], v[120:123], v[104:107]
    ds_read_b128 v[36:39], v2 offset:10240
    s_lshl_b32 s34, s34, 6
    s_lshl_b32 s35, s35, 6
    s_lshr_b32 s38, s60, 1
    v_mfma_f32_16x16x32_bf16 v[108:111], v[44:47], v[124:127], v[108:111]
    s_lshr_b32 s39, s61, 1
    s_cmp_eq_u32 s49, 4
    s_cselect_b32 s36, 0x7ff00000, s36
    s_and_b32 s33, s49, 3
    s_cselect_b32 s37, 0x7ff00000, s37
    s_waitcnt lgkmcnt(5)
    v_mfma_f32_16x16x32_bf16 v[80:83], v[16:19], v[128:131], v[80:83]
    ds_read_b128 v[40:43], v2 offset:12288
    v_mfma_f32_16x16x32_bf16 v[84:87], v[16:19], v[132:135], v[84:87]
    s_waitcnt lgkmcnt(0)
    s_mov_b32 s8, s52
    s_mov_b32 s9, s53
    s_mov_b32 s10, 4718592
    s_mov_b32 s11, 0x20000
    s_mov_b32 s12, s28
    s_mov_b32 s13, s29
    s_mov_b32 s14, 2359296
    s_mov_b32 s15, 0x20000
    s_mov_b32 s20, s30
    s_mov_b32 s21, s31
    s_mov_b32 s22, 1152
    s_mov_b32 s23, 0x20000
    v_mfma_f32_16x16x32_bf16 v[88:91], v[20:23], v[128:131], v[88:91]
    ds_read_b128 v[44:47], v2 offset:14336
    buffer_load_dwordx2 v[184:185], v176, s[12:15], s38 offen offset:0
    v_mfma_f32_16x16x32_bf16 v[92:95], v[20:23], v[132:135], v[92:95]
    buffer_load_dwordx2 v[186:187], v178, s[4:7], s36 offen offset:0 sc1
    v_mfma_f32_16x16x32_bf16 v[96:99], v[24:27], v[128:131], v[96:99]
    ds_read_b128 v[16:19], v2 offset:16384
    buffer_load_dwordx2 v[188:189], v177, s[20:23], s34 offen offset:0
    v_mfma_f32_16x16x32_bf16 v[100:103], v[24:27], v[132:135], v[100:103]
    buffer_load_dwordx2 v[190:191], v176, s[12:15], s38 offen offset:32
    v_mfma_f32_16x16x32_bf16 v[104:107], v[28:31], v[128:131], v[104:107]
    ds_read_b128 v[20:23], v2 offset:18432
    buffer_load_dwordx2 v[192:193], v178, s[4:7], s36 offen offset:512 sc1
    v_mfma_f32_16x16x32_bf16 v[108:111], v[28:31], v[132:135], v[108:111]
    buffer_load_dwordx2 v[194:195], v177, s[20:23], s34 offen offset:32
    v_mfma_f32_16x16x32_bf16 v[80:83], v[32:35], v[136:139], v[80:83]
    ds_read_b128 v[24:27], v2 offset:20480
    v_mfma_f32_16x16x32_bf16 v[84:87], v[32:35], v[140:143], v[84:87]
    buffer_load_dwordx2 v[196:197], v176, s[12:15], s39 offen offset:0
    v_mfma_f32_16x16x32_bf16 v[88:91], v[36:39], v[136:139], v[88:91]
    ds_read_b128 v[28:31], v2 offset:22528
    buffer_load_dwordx2 v[198:199], v178, s[4:7], s37 offen offset:0 sc1
    v_mfma_f32_16x16x32_bf16 v[92:95], v[36:39], v[140:143], v[92:95]
    buffer_load_dwordx2 v[200:201], v177, s[20:23], s35 offen offset:0
    v_mfma_f32_16x16x32_bf16 v[96:99], v[40:43], v[136:139], v[96:99]
    ds_read_b128 v[32:35], v2 offset:24576
    v_mfma_f32_16x16x32_bf16 v[100:103], v[40:43], v[140:143], v[100:103]
    buffer_load_dwordx2 v[202:203], v176, s[12:15], s39 offen offset:32
    s_waitcnt lgkmcnt(5)
    v_mfma_f32_16x16x32_bf16 v[104:107], v[44:47], v[136:139], v[104:107]
    ds_read_b128 v[36:39], v2 offset:26624
    buffer_load_dwordx2 v[204:205], v178, s[4:7], s37 offen offset:512 sc1
    v_mfma_f32_16x16x32_bf16 v[108:111], v[44:47], v[140:143], v[108:111]
    buffer_load_dwordx2 v[206:207], v177, s[20:23], s35 offen offset:32
    s_waitcnt lgkmcnt(5)
    v_mfma_f32_16x16x32_bf16 v[80:83], v[16:19], v[144:147], v[80:83]
    ds_read_b128 v[40:43], v2 offset:28672
    v_mfma_f32_16x16x32_bf16 v[84:87], v[16:19], v[148:151], v[84:87]
    s_waitcnt lgkmcnt(5)
    v_mfma_f32_16x16x32_bf16 v[88:91], v[20:23], v[144:147], v[88:91]
    ds_read_b128 v[44:47], v2 offset:30720
    v_mfma_f32_16x16x32_bf16 v[92:95], v[20:23], v[148:151], v[92:95]
    s_waitcnt lgkmcnt(5)
    v_mfma_f32_16x16x32_bf16 v[96:99], v[24:27], v[144:147], v[96:99]
    v_mfma_f32_16x16x32_bf16 v[100:103], v[24:27], v[148:151], v[100:103]
    s_waitcnt lgkmcnt(4)
    v_mfma_f32_16x16x32_bf16 v[104:107], v[28:31], v[144:147], v[104:107]
    v_mfma_f32_16x16x32_bf16 v[108:111], v[28:31], v[148:151], v[108:111]
    s_waitcnt lgkmcnt(3)
    v_mfma_f32_16x16x32_bf16 v[80:83], v[32:35], v[152:155], v[80:83]
    v_mfma_f32_16x16x32_bf16 v[84:87], v[32:35], v[156:159], v[84:87]
    s_waitcnt lgkmcnt(2)
    v_mfma_f32_16x16x32_bf16 v[88:91], v[36:39], v[152:155], v[88:91]
    v_mfma_f32_16x16x32_bf16 v[92:95], v[36:39], v[156:159], v[92:95]
    s_waitcnt lgkmcnt(1)
    v_mfma_f32_16x16x32_bf16 v[96:99], v[40:43], v[152:155], v[96:99]
    v_mfma_f32_16x16x32_bf16 v[100:103], v[40:43], v[156:159], v[100:103]
    s_waitcnt lgkmcnt(0)
    v_mfma_f32_16x16x32_bf16 v[104:107], v[44:47], v[152:155], v[104:107]
    v_mfma_f32_16x16x32_bf16 v[108:111], v[44:47], v[156:159], v[108:111]
    s_nop 7
    ds_write_b128 v11, v[80:83] offset:0
    ds_write_b128 v11, v[84:87] offset:1024
    ds_write_b128 v11, v[88:91] offset:2048
    ds_write_b128 v11, v[92:95] offset:3072
    s_waitcnt lgkmcnt(0)
    s_barrier
    ds_read_b128 v[80:83], v12 offset:0
    ds_read_b128 v[84:87], v12 offset:1024
    ds_read_b128 v[88:91], v12 offset:2048
    ds_read_b128 v[92:95], v12 offset:3072
    s_waitcnt lgkmcnt(3)
    v_add_f32 v96, v96, v80
    v_add_f32 v97, v97, v81
    v_add_f32 v98, v98, v82
    v_add_f32 v99, v99, v83
    s_waitcnt lgkmcnt(2)
    v_add_f32 v100, v100, v84
    v_add_f32 v101, v101, v85
    v_add_f32 v102, v102, v86
    v_add_f32 v103, v103, v87
    s_waitcnt lgkmcnt(1)
    v_add_f32 v104, v104, v88
    v_add_f32 v105, v105, v89
    v_add_f32 v106, v106, v90
    v_add_f32 v107, v107, v91
    s_waitcnt lgkmcnt(0)
    v_add_f32 v108, v108, v92
    v_add_f32 v109, v109, v93
    v_add_f32 v110, v110, v94
    v_add_f32 v111, v111, v95
    v_cvt_pk_bf16_f32 v80, v96, v97
    v_cvt_pk_bf16_f32 v81, v98, v99
    v_cvt_pk_bf16_f32 v82, v104, v105
    v_cvt_pk_bf16_f32 v83, v106, v107
    s_cmp_eq_u32 s49, 4
    s_cselect_b32 s44, 0x7ff00000, s55
    buffer_store_dwordx4 v[80:83], v1, s[4:7], s44 offen offset:1024 sc1
    s_cbranch_scc0 K2_nx_188
    v_add_f32 v168, v168, v96
    v_add_f32 v169, v169, v97
    v_add_f32 v170, v170, v98
    v_add_f32 v171, v171, v99
    v_add_f32 v172, v172, v104
    v_add_f32 v173, v173, v105
    v_add_f32 v174, v174, v106
    v_add_f32 v175, v175, v107
K2_nx_188:
    v_cvt_pk_bf16_f32 v84, v100, v101
    v_cvt_pk_bf16_f32 v85, v102, v103
    v_cvt_pk_bf16_f32 v86, v108, v109
    v_cvt_pk_bf16_f32 v87, v110, v111
    s_cmp_eq_u32 s49, 0
    s_cselect_b32 s44, 0x7ff00000, s55
    buffer_store_dwordx4 v[84:87], v1, s[4:7], s44 offen offset:2048 sc1
    s_cbranch_scc0 K2_nx_189
    v_add_f32 v168, v168, v100
    v_add_f32 v169, v169, v101
    v_add_f32 v170, v170, v102
    v_add_f32 v171, v171, v103
    v_add_f32 v172, v172, v108
    v_add_f32 v173, v173, v109
    v_add_f32 v174, v174, v110
    v_add_f32 v175, v175, v111
K2_nx_189:
    s_branch K2_fin
SBs_138:
    s_sleep 1
    ds_read_b32 v8, v9
    s_waitcnt lgkmcnt(0)
    v_cmp_gt_i32 vcc, v7, v8
    s_cbranch_vccnz SBs_138
    s_branch SBb_139
SBs_140:
    s_sleep 1
    ds_read_b32 v8, v9
    s_waitcnt lgkmcnt(0)
    v_cmp_gt_i32 vcc, v7, v8
    s_cbranch_vccnz SBs_140
    s_branch SBb_141
SBs_142:
    s_sleep 1
    ds_read_b32 v8, v9
    s_waitcnt lgkmcnt(0)
    v_cmp_gt_i32 vcc, v7, v8
    s_cbranch_vccnz SBs_142
    s_branch SBb_143
SBs_144:
    s_sleep 1
    ds_read_b32 v8, v9
    s_waitcnt lgkmcnt(0)
    v_cmp_gt_i32 vcc, v7, v8
    s_cbranch_vccnz SBs_144
    s_branch SBb_145
SBs_146:
    s_sleep 1
    ds_read_b32 v8, v9
    s_waitcnt lgkmcnt(0)
    v_cmp_gt_i32 vcc, v7, v8
    s_cbranch_vccnz SBs_146
    s_branch SBb_147
SBs_148:
    s_sleep 1
    ds_read_b32 v8, v9
    s_waitcnt lgkmcnt(0)
    v_cmp_gt_i32 vcc, v7, v8
    s_cbranch_vccnz SBs_148
    s_branch SBb_149
SBs_150:
    s_sleep 1
    ds_read_b32 v8, v9
    s_waitcnt lgkmcnt(0)
    v_cmp_gt_i32 vcc, v7, v8
    s_cbranch_vccnz SBs_150
    s_branch SBb_151
SBs_152:
    s_sleep 1
    ds_read_b32 v8, v9
    s_waitcnt lgkmcnt(0)
    v_cmp_gt_i32 vcc, v7, v8
    s_cbranch_vccnz SBs_152
    s_branch SBb_153
SBs_154:
    s_sleep 1
    ds_read_b32 v8, v9
    s_waitcnt lgkmcnt(0)
    v_cmp_gt_i32 vcc, v7, v8
    s_cbranch_vccnz SBs_154
    s_branch SBb_155
SBs_156:
    s_sleep 1
    ds_read_b32 v8, v9
    s_waitcnt lgkmcnt(0)
    v_cmp_gt_i32 vcc, v7, v8
    s_cbranch_vccnz SBs_156
    s_branch SBb_157
SBs_158:
    s_sleep 1
    ds_read_b32 v8, v9
    s_waitcnt lgkmcnt(0)
    v_cmp_gt_i32 vcc, v7, v8
    s_cbranch_vccnz SBs_158
    s_branch SBb_159
SBs_160:
    s_sleep 1
    ds_read_b32 v8, v9
    s_waitcnt lgkmcnt(0)
    v_cmp_gt_i32 vcc, v7, v8
    s_cbranch_vccnz SBs_160
    s_branch SBb_161
SBs_162:
    s_sleep 1
    ds_read_b32 v8, v9
    s_waitcnt lgkmcnt(0)
    v_cmp_gt_i32 vcc, v7, v8
    s_cbranch_vccnz SBs_162
    s_branch SBb_163
SBs_164:
    s_sleep 1
    ds_read_b32 v8, v9
    s_waitcnt lgkmcnt(0)
    v_cmp_gt_i32 vcc, v7, v8
    s_cbranch_vccnz SBs_164
    s_branch SBb_165
SBs_166:
    s_sleep 1
    ds_read_b32 v8, v9
    s_waitcnt lgkmcnt(0)
    v_cmp_gt_i32 vcc, v7, v8
    s_cbranch_vccnz SBs_166
    s_branch SBb_167
SBs_168:
    s_sleep 1
    ds_read_b32 v8, v9
    s_waitcnt lgkmcnt(0)
    v_cmp_gt_i32 vcc, v7, v8
    s_cbranch_vccnz SBs_168
    s_branch SBb_169
SBs_172:
    s_sleep 1
    ds_read_b32 v8, v9
    s_waitcnt lgkmcnt(0)
    v_cmp_gt_i32 vcc, v7, v8
    s_cbranch_vccnz SBs_172
    s_branch SBb_173
SBs_178:
    s_sleep 1
    ds_read_b32 v8, v9
    s_waitcnt lgkmcnt(0)
    v_cmp_gt_i32 vcc, v7, v8
    s_cbranch_vccnz SBs_178
    s_branch SBb_179
SBs_180:
    s_sleep 1
    ds_read_b32 v8, v9
    s_waitcnt lgkmcnt(0)
    v_cmp_gt_i32 vcc, v7, v8
    s_cbranch_vccnz SBs_180
    s_branch SBb_181
SBs_184:
    s_sleep 1
    ds_read_b32 v8, v9
    s_waitcnt lgkmcnt(0)
    v_cmp_gt_i32 vcc, v7, v8
    s_cbranch_vccnz SBs_184
    s_branch SBb_185
ASs_134:
    s_mov_b32 s47, 0
ASl_190:
    s_sleep 4
    buffer_load_dword v160, v161, s[24:27], 0 offen offset:128 sc1
    s_waitcnt vmcnt(0)
    v_cmp_ne_u32 vcc, 1, v160
    s_cbranch_vccz ASb_135
    s_add_u32 s47, s47, 1
    s_cmp_lt_u32 s47, 0x40000
    s_cbranch_scc1 ASl_190
    s_branch ASb_135
PLs_136:
    s_mov_b32 s47, 0
PLl_191:
    s_sleep 1
    buffer_load_dword v248, v13, s[4:7], s57 offen sc1
    s_waitcnt vmcnt(0)
    v_cmp_gt_u32 vcc, 3, v248
    s_cbranch_vccz PLb_137
    s_add_u32 s47, s47, 1
    s_cmp_lt_u32 s47, 0x40000
    s_cbranch_scc1 PLl_191
    s_branch PLb_137
K2_fin:
    s_lshl_b32 s41, s97, 2
    s_add_u32 s40, s48, s41
    v_mov_b32 v3, 1
    v_min_u32 v4, 4, v0
    v_lshlrev_b32 v4, 2, v4
    s_mov_b32 s47, 0
    v_min_u32 v4, 3, v0
    v_add3_u32 v4, v4, s97, 1
    v_subrev_u32 v12, 5, v4
    v_min_u32 v4, v4, v12
    v_lshlrev_b32 v4, 2, v4
    s_waitcnt vmcnt(0)
    s_barrier
    s_cmp_lg_u32 s16, 0
    s_cbranch_scc1 K2_w1
    s_mov_b64 exec, 1
    buffer_store_dword v3, v1, s[4:7], s40 offen sc1
    s_mov_b64 exec, -1
    s_branch K2_go
K2_w1:
    s_cmp_lg_u32 s16, 1
    s_cbranch_scc1 K2_go
    buffer_load_dword v5, v4, s[4:7], s48 offen sc1
K2_poll:
    s_sleep 3
    buffer_load_dword v6, v4, s[4:7], s48 offen sc1
    s_waitcnt vmcnt(1)
    v_cmp_ne_u32 vcc, 1, v5
    s_cbranch_vccz K2_go
    s_sleep 3
    buffer_load_dword v5, v4, s[4:7], s48 offen sc1
    s_waitcnt vmcnt(1)
    v_cmp_ne_u32 vcc, 1, v6
    s_cbranch_vccz K2_go
    s_add_u32 s47, s47, 1
    s_cmp_lt_u32 s47, 0x20000
    s_cbranch_scc1 K2_poll
K2_go:
    s_barrier
    s_mov_b32 s45, s97
    s_add_u32 s45, s45, 1
    s_cmp_eq_u32 s45, 5
    s_cselect_b32 s45, 0, s45
    s_mul_i32 s46, s45, 2359296
    s_add_u32 s47, s46, s62
    s_add_u32 s46, s46, s63
    buffer_load_dwordx4 v[48:51], v1, s[4:7], s47 offen sc1
    buffer_load_dwordx4 v[52:55], v1, s[4:7], s46 offen sc1
    s_add_u32 s45, s45, 1
    s_cmp_eq_u32 s45, 5
    s_cselect_b32 s45, 0, s45
    s_mul_i32 s46, s45, 2359296
    s_add_u32 s47, s46, s62
    s_add_u32 s46, s46, s63
    buffer_load_dwordx4 v[56:59], v1, s[4:7], s47 offen sc1
    buffer_load_dwordx4 v[60:63], v1, s[4:7], s46 offen sc1
    s_add_u32 s45, s45, 1
    s_cmp_eq_u32 s45, 5
    s_cselect_b32 s45, 0, s45
    s_mul_i32 s46, s45, 2359296
    s_add_u32 s47, s46, s62
    s_add_u32 s46, s46, s63
    buffer_load_dwordx4 v[64:67], v1, s[4:7], s47 offen sc1
    buffer_load_dwordx4 v[68:71], v1, s[4:7], s46 offen sc1
    s_add_u32 s45, s45, 1
    s_cmp_eq_u32 s45, 5
    s_cselect_b32 s45, 0, s45
    s_mul_i32 s46, s45, 2359296
    s_add_u32 s47, s46, s62
    s_add_u32 s46, s46, s63
    buffer_load_dwordx4 v[72:75], v1, s[4:7], s47 offen sc1
    buffer_load_dwordx4 v[76:79], v1, s[4:7], s46 offen sc1
    v_mov_b32 v3, 0xffff0000
    v_lshlrev_b32 v7, 16, v184
    v_and_b32 v8, v3, v184
    v_add_f32 v160, v160, v7
    v_add_f32 v161, v161, v8
    v_lshlrev_b32 v7, 16, v186
    v_and_b32 v8, v3, v186
    v_lshlrev_b32 v12, 16, v188
    v_and_b32 v13, v3, v188
    v_fmac_f32 v160, v7, v12
    v_fmac_f32 v161, v8, v13
    v_lshlrev_b32 v7, 16, v185
    v_and_b32 v8, v3, v185
    v_add_f32 v162, v162, v7
    v_add_f32 v163, v163, v8
    v_lshlrev_b32 v7, 16, v187
    v_and_b32 v8, v3, v187
    v_lshlrev_b32 v12, 16, v189
    v_and_b32 v13, v3, v189
    v_fmac_f32 v162, v7, v12
    v_fmac_f32 v163, v8, v13
    v_lshlrev_b32 v7, 16, v190
    v_and_b32 v8, v3, v190
    v_add_f32 v164, v164, v7
    v_add_f32 v165, v165, v8
    v_lshlrev_b32 v7, 16, v192
    v_and_b32 v8, v3, v192
    v_lshlrev_b32 v12, 16, v194
    v_and_b32 v13, v3, v194
    v_fmac_f32 v164, v7, v12
    v_fmac_f32 v165, v8, v13
    v_lshlrev_b32 v7, 16, v191
    v_and_b32 v8, v3, v191
    v_add_f32 v166, v166, v7
    v_add_f32 v167, v167, v8
    v_lshlrev_b32 v7, 16, v193
    v_and_b32 v8, v3, v193
    v_lshlrev_b32 v12, 16, v195
    v_and_b32 v13, v3, v195
    v_fmac_f32 v166, v7, v12
    v_fmac_f32 v167, v8, v13
    v_lshlrev_b32 v7, 16, v196
    v_and_b32 v8, v3, v196
    v_add_f32 v168, v168, v7
    v_add_f32 v169, v169, v8
    v_lshlrev_b32 v7, 16, v198
    v_and_b32 v8, v3, v198
    v_lshlrev_b32 v12, 16, v200
    v_and_b32 v13, v3, v200
    v_fmac_f32 v168, v7, v12
    v_fmac_f32 v169, v8, v13
    v_lshlrev_b32 v7, 16, v197
    v_and_b32 v8, v3, v197
    v_add_f32 v170, v170, v7
    v_add_f32 v171, v171, v8
    v_lshlrev_b32 v7, 16, v199
    v_and_b32 v8, v3, v199
    v_lshlrev_b32 v12, 16, v201
    v_and_b32 v13, v3, v201
    v_fmac_f32 v170, v7, v12
    v_fmac_f32 v171, v8, v13
    v_lshlrev_b32 v7, 16, v202
    v_and_b32 v8, v3, v202
    v_add_f32 v172, v172, v7
    v_add_f32 v173, v173, v8
    v_lshlrev_b32 v7, 16, v204
    v_and_b32 v8, v3, v204
    v_lshlrev_b32 v12, 16, v206
    v_and_b32 v13, v3, v206
    v_fmac_f32 v172, v7, v12
    v_fmac_f32 v173, v8, v13
    v_lshlrev_b32 v7, 16, v203
    v_and_b32 v8, v3, v203
    v_add_f32 v174, v174, v7
    v_add_f32 v175, v175, v8
    v_lshlrev_b32 v7, 16, v205
    v_and_b32 v8, v3, v205
    v_lshlrev_b32 v12, 16, v207
    v_and_b32 v13, v3, v207
    v_fmac_f32 v174, v7, v12
    v_fmac_f32 v175, v8, v13
    s_waitcnt vmcnt(7)
    v_lshlrev_b32 v5, 16, v48
    v_and_b32 v6, v3, v48
    v_add_f32 v160, v160, v5
    v_add_f32 v161, v161, v6
    v_lshlrev_b32 v5, 16, v49
    v_and_b32 v6, v3, v49
    v_add_f32 v162, v162, v5
    v_add_f32 v163, v163, v6
    v_lshlrev_b32 v5, 16, v50
    v_and_b32 v6, v3, v50
    v_add_f32 v164, v164, v5
    v_add_f32 v165, v165, v6
    v_lshlrev_b32 v5, 16, v51
    v_and_b32 v6, v3, v51
    v_add_f32 v166, v166, v5
    v_add_f32 v167, v167, v6
    s_waitcnt vmcnt(6)
    v_lshlrev_b32 v5, 16, v52
    v_and_b32 v6, v3, v52
    v_add_f32 v168, v168, v5
    v_add_f32 v169, v169, v6
    v_lshlrev_b32 v5, 16, v53
    v_and_b32 v6, v3, v53
    v_add_f32 v170, v170, v5
    v_add_f32 v171, v171, v6
    v_lshlrev_b32 v5, 16, v54
    v_and_b32 v6, v3, v54
    v_add_f32 v172, v172, v5
    v_add_f32 v173, v173, v6
    v_lshlrev_b32 v5, 16, v55
    v_and_b32 v6, v3, v55
    v_add_f32 v174, v174, v5
    v_add_f32 v175, v175, v6
    s_waitcnt vmcnt(5)
    v_lshlrev_b32 v5, 16, v56
    v_and_b32 v6, v3, v56
    v_add_f32 v160, v160, v5
    v_add_f32 v161, v161, v6
    v_lshlrev_b32 v5, 16, v57
    v_and_b32 v6, v3, v57
    v_add_f32 v162, v162, v5
    v_add_f32 v163, v163, v6
    v_lshlrev_b32 v5, 16, v58
    v_and_b32 v6, v3, v58
    v_add_f32 v164, v164, v5
    v_add_f32 v165, v165, v6
    v_lshlrev_b32 v5, 16, v59
    v_and_b32 v6, v3, v59
    v_add_f32 v166, v166, v5
    v_add_f32 v167, v167, v6
    s_waitcnt vmcnt(4)
    v_lshlrev_b32 v5, 16, v60
    v_and_b32 v6, v3, v60
    v_add_f32 v168, v168, v5
    v_add_f32 v169, v169, v6
    v_lshlrev_b32 v5, 16, v61
    v_and_b32 v6, v3, v61
    v_add_f32 v170, v170, v5
    v_add_f32 v171, v171, v6
    v_lshlrev_b32 v5, 16, v62
    v_and_b32 v6, v3, v62
    v_add_f32 v172, v172, v5
    v_add_f32 v173, v173, v6
    v_lshlrev_b32 v5, 16, v63
    v_and_b32 v6, v3, v63
    v_add_f32 v174, v174, v5
    v_add_f32 v175, v175, v6
    s_waitcnt vmcnt(3)
    v_lshlrev_b32 v5, 16, v64
    v_and_b32 v6, v3, v64
    v_add_f32 v160, v160, v5
    v_add_f32 v161, v161, v6
    v_lshlrev_b32 v5, 16, v65
    v_and_b32 v6, v3, v65
    v_add_f32 v162, v162, v5
    v_add_f32 v163, v163, v6
    v_lshlrev_b32 v5, 16, v66
    v_and_b32 v6, v3, v66
    v_add_f32 v164, v164, v5
    v_add_f32 v165, v165, v6
    v_lshlrev_b32 v5, 16, v67
    v_and_b32 v6, v3, v67
    v_add_f32 v166, v166, v5
    v_add_f32 v167, v167, v6
    s_waitcnt vmcnt(2)
    v_lshlrev_b32 v5, 16, v68
    v_and_b32 v6, v3, v68
    v_add_f32 v168, v168, v5
    v_add_f32 v169, v169, v6
    v_lshlrev_b32 v5, 16, v69
    v_and_b32 v6, v3, v69
    v_add_f32 v170, v170, v5
    v_add_f32 v171, v171, v6
    v_lshlrev_b32 v5, 16, v70
    v_and_b32 v6, v3, v70
    v_add_f32 v172, v172, v5
    v_add_f32 v173, v173, v6
    v_lshlrev_b32 v5, 16, v71
    v_and_b32 v6, v3, v71
    v_add_f32 v174, v174, v5
    v_add_f32 v175, v175, v6
    s_waitcnt vmcnt(1)
    v_lshlrev_b32 v5, 16, v72
    v_and_b32 v6, v3, v72
    v_add_f32 v160, v160, v5
    v_add_f32 v161, v161, v6
    v_lshlrev_b32 v5, 16, v73
    v_and_b32 v6, v3, v73
    v_add_f32 v162, v162, v5
    v_add_f32 v163, v163, v6
    v_lshlrev_b32 v5, 16, v74
    v_and_b32 v6, v3, v74
    v_add_f32 v164, v164, v5
    v_add_f32 v165, v165, v6
    v_lshlrev_b32 v5, 16, v75
    v_and_b32 v6, v3, v75
    v_add_f32 v166, v166, v5
    v_add_f32 v167, v167, v6
    s_waitcnt vmcnt(0)
    v_lshlrev_b32 v5, 16, v76
    v_and_b32 v6, v3, v76
    v_add_f32 v168, v168, v5
    v_add_f32 v169, v169, v6
    v_lshlrev_b32 v5, 16, v77
    v_and_b32 v6, v3, v77
    v_add_f32 v170, v170, v5
    v_add_f32 v171, v171, v6
    v_lshlrev_b32 v5, 16, v78
    v_and_b32 v6, v3, v78
    v_add_f32 v172, v172, v5
    v_add_f32 v173, v173, v6
    v_lshlrev_b32 v5, 16, v79
    v_and_b32 v6, v3, v79
    v_add_f32 v174, v174, v5
    v_add_f32 v175, v175, v6
    buffer_store_dwordx4 v[160:163], v10, s[8:11], s60 offen
    buffer_store_dwordx4 v[164:167], v10, s[8:11], s60 offen offset:64
    buffer_store_dwordx4 v[168:171], v10, s[8:11], s61 offen
    buffer_store_dwordx4 v[172:175], v10, s[8:11], s61 offen offset:64
K1_done:
K1_end:
    s_endpgm
CODE_END:
.section .rodata,"a"
.p2align 6
.amdhsa_kernel parallel_sum__ssm_conv_s5__glu_gated_bilinear__prompt_kernel
  .amdhsa_next_free_vgpr 256
  .amdhsa_next_free_sgpr 102
  .amdhsa_accum_offset 256
  .amdhsa_group_segment_fixed_size 0
  .amdhsa_kernarg_size 128
  .amdhsa_user_sgpr_count 2
  .amdhsa_user_sgpr_kernarg_segment_ptr 1
  .amdhsa_system_sgpr_workgroup_id_x 1
  .amdhsa_float_denorm_mode_32 3
  .amdhsa_float_denorm_mode_16_64 3
.end_amdhsa_kernel
```
